```python
import torch

def _softmax(x, axis=-1):
    return torch.softmax(x, dim=axis)

def _gelu(x):
    return torch.nn.functional.gelu(x, approximate='tanh')

def _silu(x):
    return torch.nn.functional.silu(x)

def _sigmoid(x):
    return torch.sigmoid(x)

def _layernorm(x, axis=-1, eps=1e-05):
    m = x.mean(dim=axis, keepdim=True)
    v = x.var(dim=axis, keepdim=True, unbiased=False)
    return (x - m) / torch.sqrt(v + eps)

def _scatter_add(tgt, idx, src, axis=0):
    return tgt.clone().index_add_(axis, idx, src)

def _segment_sum(src, seg, n):
    out = torch.zeros((n,) + src.shape[1:], dtype=src.dtype)
    return out.index_add_(0, seg, src)

def _pad(x, pw):
    flat = tuple((v for pair in reversed(pw) for v in pair))
    return torch.nn.functional.pad(x, flat)
kernel_name = 'adaLN_cond__grouped_kv_mqa__dense_activation_silu__prompt'

def setup_inputs():

    _w = lambda a: (lambda t: t.to(torch.bfloat16) if t.is_floating_point() else t)(torch.as_tensor(a))

    def _A_setup():
        B, S, D, H = (1, 2048, 512, 32)
        Dh = D // H
        return {'x': _w((lambda *s: torch.randn(*s, dtype=torch.bfloat16) * 0.05)(B, S, D)), 'wq': _w((lambda *s: torch.randn(*s, dtype=torch.bfloat16) * 0.05)(D, H * Dh)), 'wk': _w((lambda *s: torch.randn(*s, dtype=torch.bfloat16) * 0.05)(D, Dh)), 'wv': _w((lambda *s: torch.randn(*s, dtype=torch.bfloat16) * 0.05)(D, Dh)), 'wo': _w((lambda *s: torch.randn(*s, dtype=torch.bfloat16) * 0.05)(H * Dh, D))}
    _A_in = _A_setup()

    def _B_setup():
        B, S, D, F = (1, 2048, 512, 1792)
        return {'x': _w((lambda *s: torch.randn(*s, dtype=torch.bfloat16) * 0.05)(B, S, D)), 'w1': _w((lambda *s: torch.randn(*s, dtype=torch.bfloat16) * 6.4)(D, F) * D ** (-0.5)), 'w2': _w((lambda *s: torch.randn(*s, dtype=torch.bfloat16) * 0.2)(F, D) * F ** (-0.5))}
    _B_in = _B_setup()
    return {'A_x': _A_in['x'], 'A_wq': _A_in['wq'], 'A_wk': _A_in['wk'], 'A_wv': _A_in['wv'], 'A_wo': _A_in['wo'], 'B_x': _B_in['x'], 'B_w1': _B_in['w1'], 'B_w2': _B_in['w2'], 'c': _w((lambda *s: torch.randn(*s, dtype=torch.bfloat16) * 0.1)(1, 512) * 8.0), 'w_mod': _w((lambda *s: torch.randn(*s, dtype=torch.bfloat16) * 0.1)(512, 6 * 512) * 512 ** (-0.5) * 8.0)}

def reference(A_x, A_wq, A_wk, A_wv, A_wo, B_x, B_w1, B_w2, c, w_mod):

    def _A_ref(x, wq, wk, wv, wo):
        B, S, D = x.shape
        H = 32
        Dh = D // H
        q = (lambda x, *d: x.permute(*d))((x @ wq).reshape(B, S, H, Dh), 0, 2, 1, 3)
        k = x @ wk
        v = x @ wv
        scores = torch.einsum('bhqd,bkd->bhqk', q, k) * Dh ** (-0.5)
        p = _softmax(scores, axis=-1)
        o = torch.einsum('bhqk,bkd->bhqd', p, v)
        return (lambda x, *d: x.permute(*d))(o, 0, 2, 1, 3).reshape(B, S, H * Dh) @ wo

    def _B_ref(x, w1, w2):
        h = torch.einsum('bsd,df->bsf', x, w1)
        h = _silu(h)
        out = torch.einsum('bsf,fd->bsd', h, w2)
        return out
    x = A_x
    mod = (_silu(c) @ w_mod).reshape(c.shape[0], 6, 1, -1)
    sa, ca, ga, sb, cb, gb = (mod[:, 0].clone(), mod[:, 1].clone(), mod[:, 2].clone(), mod[:, 3].clone(), mod[:, 4].clone(), mod[:, 5].clone())
    h = _layernorm(x, axis=-1) * (1 + ca) + sa
    x = x + ga * _A_ref(h, A_wq, A_wk, A_wv, A_wo)
    h = _layernorm(x, axis=-1) * (1 + cb) + sb
    x = x + gb * _B_ref(h, B_w1, B_w2)
    return x
```

```asm
; @launch grid=(256,1,1) block=(256,1,1) lds=163840
.amdgcn_target "amdgcn-amd-amdhsa--gfx950"
.text
.p2align 8
.globl adaLN_cond__grouped_kv_mqa__dense_activation_silu__prompt_kernel
.type adaLN_cond__grouped_kv_mqa__dense_activation_silu__prompt_kernel,@function
adaLN_cond__grouped_kv_mqa__dense_activation_silu__prompt_kernel:
    s_cmp_ge_u32 s2, 256
    s_cbranch_scc1 adaLN_cond__grouped_kv_mqa__dense_activation_silu__prompt_kernel_end1
    s_load_dwordx8 s[20:27], s[0:1], 64
    s_load_dwordx16 s[4:19], s[0:1], 0
    s_load_dwordx2 s[28:29], s[0:1], 96
    s_getpc_b64 s[32:33]
LPC0:
    s_mov_b32 s34, LPCEND-LPC0
    s_mov_b32 s35, 0x20000
    s_lshr_b32 s54, s2, 3
    s_and_b32 s55, s54, 3
    s_lshl_b32 s56, s54, 11
    v_lshl_add_u32 v13, v0, 3, s56
    buffer_load_dword v63, v13, s[32:35], 0 offen
    s_lshr_b32 s45, s54, 2
    s_and_b32 s46, s2, 7
    s_lshl2_add_u32 s46, s46, s55
    v_lshrrev_b32 v16, 3, v0
    v_and_b32 v17, 7, v0
    v_lshlrev_b32 v17, 4, v17
    v_and_b32 v1, 63, v0
    v_lshrrev_b32 v15, 6, v0
    v_lshlrev_b32 v2, 4, v1
    v_readfirstlane_b32 s44, v15
    v_lshrrev_b32 v13, 4, v1
    v_and_b32 v15, 15, v1
    v_xor_b32 v15, v15, v13
    v_lshlrev_b32 v15, 4, v15
    v_lshl_add_u32 v13, v13, 13, v15
    s_and_b32 s47, s45, 1
    s_mul_i32 s48, s44, 33792
    s_lshl_b32 s31, s46, 16
    s_lshl_b32 s55, s44, 8
    s_add_u32 s31, s31, s55
    s_lshl_b32 s55, s47, 15
    s_add_u32 s31, s31, s55
    s_lshl_b32 s30, s45, 6
    s_mov_b32 s43, s30
    s_mov_b32 s62, s30
    s_mov_b32 s34, 2097152
    s_cmp_ge_u32 s2, 64
    s_cbranch_scc1 adaLN_cond__grouped_kv_mqa__dense_activation_silu__prompt_kernel_nprod3
    s_and_b32 s54, s2, 3
    s_lshr_b32 s55, s2, 2
    s_mul_i32 s56, s54, 786432
    s_lshl_b32 s55, s55, 7
    s_add_u32 s56, s56, s55
    s_addk_i32 s56, 3072
    s_movk_i32 s57, 24576
    v_mad_u32_u24 v18, v16, s57, v17
    v_add_u32 v18, s56, v18
    v_add_u32 v19, 12288, v18
    s_lshl_b32 s54, s54, 8
    v_lshl_add_u32 v16, v16, 3, s54
    v_mov_b32 v28, -1
    v_mov_b32 v29, -1
    v_mov_b32 v30, -1
    v_mov_b32 v31, -1
    s_and_b32 s56, s2, 1
    s_mul_i32 s56, s56, 12288
    s_lshr_b32 s57, s2, 1
    s_lshl_b32 s57, s57, 8
    s_add_u32 s56, s56, s57
    s_addk_i32 s56, 4096
    s_lshl_b32 s57, s2, 8
    s_add_u32 s57, s57, 48896
    s_lshl1_add_u32 s58, s2, s44
    s_lshl_b32 s58, s58, 10
    s_add_u32 s58, s58, 65536
    s_cmp_lt_u32 s44, 2
    s_cselect_b32 s56, s58, s56
    s_cselect_b32 s57, s58, s57
    s_cselect_b32 s59, -1, 0
    v_mov_b32 v15, s56
    v_mov_b32 v22, s57
    v_cmp_gt_u32 vcc, 16, v1
    s_nop 1
    v_cndmask_b32 v15, v22, v15, vcc
    v_add_u32 v15, v15, v2
    s_add_u32 s43, s30, 192
    s_and_b32 s43, s43, 0x1ff
    s_waitcnt lgkmcnt(0)
    global_load_dwordx4 v[32:35], v18, s[22:23] offset:-3072
    global_load_dwordx4 v[36:39], v18, s[22:23] offset:3072
    global_load_dwordx4 v[40:43], v19, s[22:23] offset:-3072
    global_load_dwordx4 v[44:47], v19, s[22:23] offset:3072
    global_load_dwordx2 v[48:49], v16, s[20:21]
    s_mov_b32 exec_hi, s59
    global_store_dwordx4 v15, v[28:31], s[28:29] sc1
    s_mov_b64 exec, -1
    s_memrealtime s[100:101]
adaLN_cond__grouped_kv_mqa__dense_activation_silu__prompt_kernel_nprod3:
    s_waitcnt lgkmcnt(0)
    s_mov_b32 s32, s4
    s_mov_b32 s33, s5
adaLN_cond__grouped_kv_mqa__dense_activation_silu__prompt_kernel_xl4:
    s_mul_i32 s54, s30, 17
    s_add_u32 m0, s54, s48
    s_lshl4_add_u32 s55, s30, s31
    buffer_load_dwordx4 v13, s[32:35], s55 offen lds
    s_add_u32 m0, m0, 8704
    s_xor_b32 s55, s55, 0x8000
    buffer_load_dwordx4 v13, s[32:35], s55 offen lds
    s_add_u32 s30, s30, 64
    s_and_b32 s30, s30, 0x1ff
    s_cmp_lg_u32 s30, s43
    s_cbranch_scc1 adaLN_cond__grouped_kv_mqa__dense_activation_silu__prompt_kernel_xl4
    s_mul_i32 s49, s44, 7168
    s_add_u32 s49, s49, 135168
    s_and_b32 s54, s2, 1
    s_lshl_b32 s54, s54, 9
    v_lshl_add_u32 v61, v16, 4, s54
    s_sub_u32 s54, s45, 2
    s_cmp_ge_u32 s54, 4
    s_cbranch_scc1 adaLN_cond__grouped_kv_mqa__dense_activation_silu__prompt_kernel_nkv5
    s_cmp_lt_u32 s45, 4
    s_cselect_b32 s56, s8, s10
    s_cselect_b32 s57, s9, s11
    s_mov_b32 m0, s49
    s_lshl_b32 s54, s44, 12
    v_add_u32 v60, s54, v2
    global_load_lds_dwordx4 v60, s[56:57] offset:0
    global_load_lds_dwordx4 v60, s[56:57] offset:1024
    global_load_lds_dwordx4 v60, s[56:57] offset:2048
    global_load_lds_dwordx4 v60, s[56:57] offset:3072
adaLN_cond__grouped_kv_mqa__dense_activation_silu__prompt_kernel_nkv5:
    s_cmp_lt_u32 s2, 192
    s_cbranch_scc1 adaLN_cond__grouped_kv_mqa__dense_activation_silu__prompt_kernel_nslab6
    global_load_dwordx4 v[28:31], v61, s[20:21]
    s_and_b32 s54, s2, 1
    s_sub_u32 s55, s2, 192
    s_lshr_b32 s55, s55, 1
    s_mul_i32 s56, s54, 1572864
    s_lshl_b32 s55, s55, 7
    s_add_u32 s56, s56, s55
    s_add_u32 s56, s56, 5120
    s_mov_b32 s57, 49152
    v_mad_u32_u24 v62, v16, s57, v17
    v_add_u32 v62, s56, v62
    global_load_dwordx4 a[128:131], v62, s[22:23] offset:-3072
    global_load_dwordx4 a[132:135], v62, s[22:23] offset:3072
    v_add_u32 v62, 12288, v62
    global_load_dwordx4 a[136:139], v62, s[22:23] offset:-3072
    global_load_dwordx4 a[140:143], v62, s[22:23] offset:3072
    v_add_u32 v62, 12288, v62
    global_load_dwordx4 a[144:147], v62, s[22:23] offset:-3072
    global_load_dwordx4 a[148:151], v62, s[22:23] offset:3072
    v_add_u32 v62, 12288, v62
    global_load_dwordx4 a[152:155], v62, s[22:23] offset:-3072
    global_load_dwordx4 a[156:159], v62, s[22:23] offset:3072
adaLN_cond__grouped_kv_mqa__dense_activation_silu__prompt_kernel_nslab6:
    v_lshrrev_b32 v4, 3, v1
    v_lshlrev_b32 v4, 10, v4
    v_and_b32 v15, 7, v1
    v_lshrrev_b32 v18, 2, v1
    v_and_b32 v18, 4, v18
    v_xor_b32 v15, v15, v18
    v_lshl_add_u32 v4, v15, 4, v4
    s_lshl_b32 s98, s44, 17
    s_lshl_b32 s55, s45, 7
    s_add_u32 s98, s98, s55
    s_add_u32 s63, s48, 17408
    s_and_b32 s99, s46, 3
    s_lshl_b32 s99, s99, 12
    s_mov_b32 s96, 0
    s_mov_b32 s97, 0
    s_and_b32 s54, s44, 1
    s_lshl_b32 s54, s54, 8
    v_xor_b32 v3, s54, v2
    s_xor_b32 s54, s44, 0
    s_mul_i32 s54, s54, 7168
    s_add_u32 s54, s54, 135168
    v_add_u32 v9, s54, v2
    s_xor_b32 s54, s44, 1
    s_mul_i32 s54, s54, 7168
    s_add_u32 s54, s54, 135168
    v_add_u32 v10, s54, v2
    s_xor_b32 s54, s44, 2
    s_mul_i32 s54, s54, 7168
    s_add_u32 s54, s54, 135168
    v_add_u32 v11, s54, v2
    s_xor_b32 s54, s44, 3
    s_mul_i32 s54, s54, 7168
    s_add_u32 s54, s54, 135168
    v_add_u32 v12, s54, v2
    s_lshl_b32 s54, s46, 19
    s_add_u32 s54, s54, 1048576
    s_add_u32 s50, s28, s54
    s_addc_u32 s51, s29, 0
    s_lshl_b32 s54, s44, 15
    s_add_u32 s54, s54, 65536
    s_add_u32 s52, s28, s54
    s_addc_u32 s53, s29, 0
    v_lshrrev_b32 v16, 5, v1
    v_bfe_u32 v17, v1, 4, 1
    v_lshl_add_u32 v17, v16, 3, v17
    s_lshl_b32 s54, s44, 1
    v_add_u32 v17, s54, v17
    v_lshlrev_b32 v6, 4, v17
    v_and_b32 v5, 0xf0, v2
    v_lshl_add_u32 v5, v17, 10, v5
    v_add_u32 v5, 24576, v5
    v_lshrrev_b32 v24, 5, v1
    v_bfe_u32 v21, v3, 8, 1
    v_bfe_u32 v26, v1, 2, 2
    v_and_b32 v27, 1, v1
    v_lshlrev_b32 v27, 1, v27
    v_bfe_u32 v20, v1, 1, 1
    v_or_b32 v27, v27, v20
    v_lshl_add_u32 v24, v24, 3, v26
    s_lshr_b32 s54, s44, 1
    s_lshl_b32 s54, s54, 2
    s_add_u32 s55, s48, 17408
    v_lshrrev_b32 v18, 1, v27
    v_lshl_add_u32 v18, v21, 1, v18
    v_add_u32 v18, s54, v18
    v_lshrrev_b32 v19, 1, v26
    v_lshlrev_b32 v19, 2, v19
    v_xor_b32 v18, v18, v19
    v_lshlrev_b32 v18, 4, v18
    v_lshl_add_u32 v18, v24, 7, v18
    v_and_b32 v19, 1, v27
    v_lshl_add_u32 v18, v19, 3, v18
    v_xor_b32 v19, 64, v18
    v_add_u32 v18, s55, v18
    v_add_u32 v19, s55, v19
    v_lshlrev_b32 v0, 5, v24
    v_lshl_add_u32 v0, v27, 3, v0
    v_add_u32 v0, s49, v0
    v_bfe_u32 v20, v1, 4, 1
    v_lshlrev_b32 v15, 6, v24
    v_lshl_add_u32 v15, v20, 5, v15
    v_lshl_add_u32 v15, v27, 3, v15
    v_add_u32 v15, s49, v15
    s_lshl2_add_u32 s54, s46, s44
    s_movk_i32 s59, 64
    s_movk_i32 s60, 16384
    s_movk_i32 s61, 1024
    s_movk_i32 s42, 1024
    s_mov_b32 s41, 32768
    s_cmp_ge_u32 s54, 72
    s_cbranch_scc1 adaLN_cond__grouped_kv_mqa__dense_activation_silu__prompt_kernel_pw29
    s_cmp_ge_u32 s54, 16
    s_cbranch_scc1 adaLN_cond__grouped_kv_mqa__dense_activation_silu__prompt_kernel_pw17
    s_mov_b32 s36, s12
    s_mov_b32 s37, s13
    s_mov_b32 s38, 524288
    s_mov_b32 s39, 0x20000
    s_lshl_b32 s58, s54, 15
    s_lshl_b32 s55, s45, 7
    s_add_u32 s58, s58, s55
    s_lshl_b32 s40, s45, 16
    s_lshl_b32 s54, s54, 11
    s_add_u32 s40, s40, s54
    s_add_u32 s40, s40, 17825792
    s_branch adaLN_cond__grouped_kv_mqa__dense_activation_silu__prompt_kernel_pdone10
adaLN_cond__grouped_kv_mqa__dense_activation_silu__prompt_kernel_pw29:
    s_mov_b32 s36, s18
    s_mov_b32 s37, s19
    s_mov_b32 s38, 1835008
    s_mov_b32 s39, 0x20000
    s_sub_u32 s54, s54, 72
    s_lshl_b32 s58, s54, 15
    s_lshl_b32 s55, s45, 7
    s_add_u32 s58, s58, s55
    s_mul_i32 s40, s45, 229376
    s_lshl_b32 s54, s54, 11
    s_add_u32 s40, s40, s54
    s_add_u32 s40, s40, 20971520
    s_mov_b32 s41, 114688
    s_branch adaLN_cond__grouped_kv_mqa__dense_activation_silu__prompt_kernel_pdone10
adaLN_cond__grouped_kv_mqa__dense_activation_silu__prompt_kernel_pw17:
    s_mov_b32 s36, s16
    s_mov_b32 s37, s17
    s_mov_b32 s38, 1835008
    s_mov_b32 s39, 0x20000
    s_movk_i32 s61, 3584
    s_mov_b32 s60, 57344
    s_sub_u32 s54, s54, 16
    s_cmp_ge_u32 s54, 48
    s_cbranch_scc1 adaLN_cond__grouped_kv_mqa__dense_activation_silu__prompt_kernel_pw1s8
    s_lshr_b32 s55, s54, 4
    s_lshl1_add_u32 s55, s55, s47
    s_and_b32 s54, s54, 15
    s_lshl_b32 s54, s54, 1
    s_branch adaLN_cond__grouped_kv_mqa__dense_activation_silu__prompt_kernel_pw1j11
adaLN_cond__grouped_kv_mqa__dense_activation_silu__prompt_kernel_pw1s8:
    s_sub_u32 s54, s54, 48
    s_lshl_b32 s54, s54, 2
    s_cmp_eq_u32 s47, 0
    s_cselect_b32 s55, 6, 0
    s_mov_b32 s59, 57344
    s_mov_b32 s60, 114688
    s_movk_i32 s41, 1024
    s_movk_i32 s42, 2048
adaLN_cond__grouped_kv_mqa__dense_activation_silu__prompt_kernel_pw1j11:
    s_mul_i32 s56, s45, 7
    s_add_u32 s55, s55, s56
    s_mul_i32 s58, s54, 57344
    s_lshl_b32 s56, s55, 6
    s_add_u32 s58, s58, s56
    s_lshl_b32 s40, s55, 15
    s_lshl_b32 s54, s54, 10
    s_add_u32 s40, s40, s54
    s_add_u32 s40, s40, 18874368
adaLN_cond__grouped_kv_mqa__dense_activation_silu__prompt_kernel_pdone10:
    v_lshrrev_b32 v16, 2, v1
    v_and_b32 v17, 3, v1
    v_lshlrev_b32 v17, 4, v17
    v_mad_u32_u24 v14, v16, s61, v17
    v_and_b32 v16, 7, v1
    v_bfe_u32 v17, v1, 3, 2
    v_lshrrev_b32 v20, 5, v1
    v_mul_u32_u24 v16, 1088, v16
    v_lshl_add_u32 v16, v17, 8, v16
    v_add_u32 v16, s48, v16
    v_xor_b32 v20, v20, v17
    v_xor_b32 v21, 2, v20
    v_lshl_add_u32 v17, v21, 4, v16
    v_lshl_add_u32 v16, v20, 4, v16
    v_mov_b32 v24, 0x3f803f80
    v_mov_b32 v20, 0
    v_mov_b32 v21, 0
    v_mov_b32 v22, 0
    v_mov_b32 v23, 0
    s_cmp_ge_u32 s2, 64
    s_cbranch_scc1 adaLN_cond__grouped_kv_mqa__dense_activation_silu__prompt_kernel_nprod212
    v_lshrrev_b32 v100, 4, v1
    v_and_b32 v101, 15, v1
    v_mul_u32_u24 v102, 7168, v100
    v_lshl_add_u32 v102, v101, 4, v102
    v_add_u32 v102, 135168, v102
    v_lshlrev_b32 v101, 4, v101
    v_lshl_add_u32 v100, v100, 2, v101
    s_or_b32 s100, s100, 1
    v_lshrrev_b32 v104, 4, v1
    v_lshlrev_b32 v104, 3, v104
    v_lshrrev_b32 v104, v104, s100
    v_mov_b32 v105, 0xff
    s_and_b32 s54, s2, 3
    s_lshl_b32 s54, s54, 8
    s_lshr_b32 s55, s2, 2
    s_lshl_b32 s55, s55, 10
    s_add_u32 s54, s54, s55
    s_add_u32 s54, s54, 24576
    v_add_u32 v100, s54, v100
    s_lshl_b32 s54, s2, 2
    v_mov_b32 v106, s54
    v_mov_b32 v107, s100
    s_waitcnt vmcnt(7)
    v_lshlrev_b32 v64, 16, v48
    v_and_b32 v65, 0xffff0000, v48
    v_lshlrev_b32 v66, 16, v49
    v_and_b32 v67, 0xffff0000, v49
    v_mul_f32 v72, 0xbfb8aa3b, v64
    v_mul_f32 v73, 0xbfb8aa3b, v65
    v_mul_f32 v74, 0xbfb8aa3b, v66
    v_mul_f32 v75, 0xbfb8aa3b, v67
    v_exp_f32 v72, v72
    v_exp_f32 v73, v73
    v_exp_f32 v74, v74
    v_exp_f32 v75, v75
    v_add_f32 v72, 1.0, v72
    v_add_f32 v73, 1.0, v73
    v_add_f32 v74, 1.0, v74
    v_add_f32 v75, 1.0, v75
    v_rcp_f32 v72, v72
    v_rcp_f32 v73, v73
    v_rcp_f32 v74, v74
    v_rcp_f32 v75, v75
    v_mul_f32 v64, v64, v72
    v_mul_f32 v65, v65, v73
    v_mul_f32 v66, v66, v74
    v_mul_f32 v67, v67, v75
    v_cvt_pk_bf16_f32 v48, v64, v65
    v_cvt_pk_bf16_f32 v49, v66, v67
    s_mov_b32 s54, 0x05040100
    s_mov_b32 s55, 0x07060302
    v_and_b32 v72, 7, v1
    v_lshrrev_b32 v73, 4, v1
    v_lshlrev_b32 v72, 5, v72
    v_lshl_add_u32 v72, v73, 3, v72
    v_add_u32 v72, s49, v72
    v_perm_b32 v64, v36, v32, s54
    v_perm_b32 v65, v36, v32, s55
    v_perm_b32 v66, v37, v33, s54
    v_perm_b32 v67, v37, v33, s55
    v_perm_b32 v68, v38, v34, s54
    v_perm_b32 v69, v38, v34, s55
    v_perm_b32 v70, v39, v35, s54
    v_perm_b32 v71, v39, v35, s55
    v_dot2_f32_bf16 v80, v64, v48, 0
    v_dot2_f32_bf16 v81, v65, v48, 0
    v_dot2_f32_bf16 v82, v66, v48, 0
    v_dot2_f32_bf16 v83, v67, v48, 0
    v_dot2_f32_bf16 v84, v68, v48, 0
    v_dot2_f32_bf16 v85, v69, v48, 0
    v_dot2_f32_bf16 v86, v70, v48, 0
    v_dot2_f32_bf16 v87, v71, v48, 0
    v_perm_b32 v64, v44, v40, s54
    v_perm_b32 v65, v44, v40, s55
    v_perm_b32 v66, v45, v41, s54
    v_perm_b32 v67, v45, v41, s55
    v_perm_b32 v68, v46, v42, s54
    v_perm_b32 v69, v46, v42, s55
    v_perm_b32 v70, v47, v43, s54
    v_perm_b32 v71, v47, v43, s55
    v_dot2_f32_bf16 v80, v64, v49, v80
    v_dot2_f32_bf16 v81, v65, v49, v81
    v_dot2_f32_bf16 v82, v66, v49, v82
    v_dot2_f32_bf16 v83, v67, v49, v83
    v_dot2_f32_bf16 v84, v68, v49, v84
    v_dot2_f32_bf16 v85, v69, v49, v85
    v_dot2_f32_bf16 v86, v70, v49, v86
    v_dot2_f32_bf16 v87, v71, v49, v87
    v_permlane32_swap_b32 v80, v84
    v_permlane32_swap_b32 v81, v85
    v_permlane32_swap_b32 v82, v86
    v_permlane32_swap_b32 v83, v87
    v_add_f32 v80, v80, v84
    v_add_f32 v81, v81, v85
    v_add_f32 v82, v82, v86
    v_add_f32 v83, v83, v87
    s_nop 0
    v_permlane16_swap_b32 v80, v82
    v_permlane16_swap_b32 v81, v83
    v_add_f32 v80, v80, v82
    v_add_f32 v81, v81, v83
    s_nop 0
    v_add_f32_dpp v80, v80, v80 row_ror:8 row_mask:0xf bank_mask:0xf
    v_add_f32_dpp v81, v81, v81 row_ror:8 row_mask:0xf bank_mask:0xf
    ds_write_b64 v72, v[80:81] offset:6144
    s_waitcnt vmcnt(6)
    s_waitcnt lgkmcnt(0)
    s_barrier
    s_cmp_lg_u32 s44, 0
    s_cbranch_scc1 adaLN_cond__grouped_kv_mqa__dense_activation_silu__prompt_kernel_nprod313
    ds_read_b128 v[96:99], v102 offset:6144
    s_waitcnt lgkmcnt(0)
    v_permlane32_swap_b32 v96, v98
    v_permlane32_swap_b32 v97, v99
    v_add_f32 v96, v96, v98
    v_add_f32 v97, v97, v99
    s_nop 1
    v_permlane16_swap_b32 v96, v97
    v_add_f32 v96, v96, v97
    v_bfi_b32 v96, v105, v104, v96
    global_store_dword v100, v96, s[28:29] sc1
    s_mov_b64 exec, 1
    global_store_dword v106, v107, s[26:27] sc1
    s_mov_b64 exec, -1
adaLN_cond__grouped_kv_mqa__dense_activation_silu__prompt_kernel_nprod313:
adaLN_cond__grouped_kv_mqa__dense_activation_silu__prompt_kernel_xl14:
    s_mul_i32 s54, s30, 17
    s_add_u32 m0, s54, s48
    s_lshl4_add_u32 s55, s30, s31
    buffer_load_dwordx4 v13, s[32:35], s55 offen lds
    s_add_u32 m0, m0, 8704
    s_xor_b32 s55, s55, 0x8000
    buffer_load_dwordx4 v13, s[32:35], s55 offen lds
    s_add_u32 s30, s30, 64
    s_and_b32 s30, s30, 0x1ff
    s_cmp_lg_u32 s30, s62
    s_cbranch_scc1 adaLN_cond__grouped_kv_mqa__dense_activation_silu__prompt_kernel_xl14
adaLN_cond__grouped_kv_mqa__dense_activation_silu__prompt_kernel_nprod212:
    s_mov_b32 s32, s6
    s_mov_b32 s33, s7
    s_mov_b32 s34, 524288
    s_mov_b32 s35, 0x20000
    s_add_u32 m0, s99, s63
    s_lshl3_add_u32 s54, s99, s98
    buffer_load_dwordx4 v4, s[32:35], s54 offen lds
    s_add_u32 s99, s99, 1024
    s_and_b32 s99, s99, 0x3fff
    s_add_u32 m0, s99, s63
    s_lshl3_add_u32 s54, s99, s98
    buffer_load_dwordx4 v4, s[32:35], s54 offen lds
    s_add_u32 s99, s99, 1024
    s_and_b32 s99, s99, 0x3fff
    s_add_u32 m0, s99, s63
    s_lshl3_add_u32 s54, s99, s98
    buffer_load_dwordx4 v4, s[32:35], s54 offen lds
    s_add_u32 s99, s99, 1024
    s_and_b32 s99, s99, 0x3fff
    s_add_u32 m0, s99, s63
    s_lshl3_add_u32 s54, s99, s98
    buffer_load_dwordx4 v4, s[32:35], s54 offen lds
    s_add_u32 s99, s99, 1024
    s_and_b32 s99, s99, 0x3fff
    s_add_u32 m0, s99, s63
    s_lshl3_add_u32 s54, s99, s98
    buffer_load_dwordx4 v4, s[32:35], s54 offen lds
    s_add_u32 s99, s99, 1024
    s_and_b32 s99, s99, 0x3fff
    s_add_u32 m0, s99, s63
    s_lshl3_add_u32 s54, s99, s98
    buffer_load_dwordx4 v4, s[32:35], s54 offen lds
    s_add_u32 s99, s99, 1024
    s_and_b32 s99, s99, 0x3fff
    s_cmp_ge_u32 s45, 6
    s_cbranch_scc1 adaLN_cond__grouped_kv_mqa__dense_activation_silu__prompt_kernel_wx16
    s_cmp_ge_u32 s45, 2
    s_cbranch_scc1 adaLN_cond__grouped_kv_mqa__dense_activation_silu__prompt_kernel_wx15
    s_waitcnt vmcnt(6)
adaLN_cond__grouped_kv_mqa__dense_activation_silu__prompt_kernel_wx15:
    s_waitcnt vmcnt(10)
adaLN_cond__grouped_kv_mqa__dense_activation_silu__prompt_kernel_wx16:
    s_waitcnt vmcnt(15)
    ds_read_b128 v[64:67], v16 offset:0
    ds_read_b128 v[96:99], v16 offset:8704
    ds_read_b128 v[68:71], v17 offset:0
    ds_read_b128 v[100:103], v17 offset:8704
    ds_read_b128 v[72:75], v16 offset:64
    ds_read_b128 v[104:107], v16 offset:8768
    ds_read_b128 v[76:79], v17 offset:64
    ds_read_b128 v[108:111], v17 offset:8768
    ds_read_b128 v[80:83], v16 offset:128
    ds_read_b128 v[112:115], v16 offset:8832
    ds_read_b128 v[84:87], v17 offset:128
    ds_read_b128 v[116:119], v17 offset:8832
    ds_read_b128 v[88:91], v16 offset:192
    ds_read_b128 v[120:123], v16 offset:8896
    ds_read_b128 v[92:95], v17 offset:192
    ds_read_b128 v[124:127], v17 offset:8896
    s_waitcnt lgkmcnt(14)
    v_dot2c_f32_bf16 v20, v64, v24
    v_dot2c_f32_bf16 v21, v64, v64
    v_dot2c_f32_bf16 v22, v96, v24
    v_dot2c_f32_bf16 v23, v96, v96
    v_dot2c_f32_bf16 v20, v65, v24
    v_dot2c_f32_bf16 v21, v65, v65
    v_dot2c_f32_bf16 v22, v97, v24
    v_dot2c_f32_bf16 v23, v97, v97
    v_dot2c_f32_bf16 v20, v66, v24
    v_dot2c_f32_bf16 v21, v66, v66
    v_dot2c_f32_bf16 v22, v98, v24
    v_dot2c_f32_bf16 v23, v98, v98
    v_dot2c_f32_bf16 v20, v67, v24
    v_dot2c_f32_bf16 v21, v67, v67
    v_dot2c_f32_bf16 v22, v99, v24
    v_dot2c_f32_bf16 v23, v99, v99
    s_add_u32 m0, s99, s63
    s_lshl3_add_u32 s54, s99, s98
    buffer_load_dwordx4 v4, s[32:35], s54 offen lds
    s_add_u32 s99, s99, 1024
    s_and_b32 s99, s99, 0x3fff
    s_waitcnt lgkmcnt(12)
    v_dot2c_f32_bf16 v20, v68, v24
    v_dot2c_f32_bf16 v21, v68, v68
    v_dot2c_f32_bf16 v22, v100, v24
    v_dot2c_f32_bf16 v23, v100, v100
    v_dot2c_f32_bf16 v20, v69, v24
    v_dot2c_f32_bf16 v21, v69, v69
    v_dot2c_f32_bf16 v22, v101, v24
    v_dot2c_f32_bf16 v23, v101, v101
    v_dot2c_f32_bf16 v20, v70, v24
    v_dot2c_f32_bf16 v21, v70, v70
    v_dot2c_f32_bf16 v22, v102, v24
    v_dot2c_f32_bf16 v23, v102, v102
    v_dot2c_f32_bf16 v20, v71, v24
    v_dot2c_f32_bf16 v21, v71, v71
    v_dot2c_f32_bf16 v22, v103, v24
    v_dot2c_f32_bf16 v23, v103, v103
    s_waitcnt lgkmcnt(10)
    v_dot2c_f32_bf16 v20, v72, v24
    v_dot2c_f32_bf16 v21, v72, v72
    v_dot2c_f32_bf16 v22, v104, v24
    v_dot2c_f32_bf16 v23, v104, v104
    v_dot2c_f32_bf16 v20, v73, v24
    v_dot2c_f32_bf16 v21, v73, v73
    v_dot2c_f32_bf16 v22, v105, v24
    v_dot2c_f32_bf16 v23, v105, v105
    v_dot2c_f32_bf16 v20, v74, v24
    v_dot2c_f32_bf16 v21, v74, v74
    v_dot2c_f32_bf16 v22, v106, v24
    v_dot2c_f32_bf16 v23, v106, v106
    v_dot2c_f32_bf16 v20, v75, v24
    v_dot2c_f32_bf16 v21, v75, v75
    v_dot2c_f32_bf16 v22, v107, v24
    v_dot2c_f32_bf16 v23, v107, v107
    s_add_u32 m0, s99, s63
    s_lshl3_add_u32 s54, s99, s98
    buffer_load_dwordx4 v4, s[32:35], s54 offen lds
    s_add_u32 s99, s99, 1024
    s_and_b32 s99, s99, 0x3fff
    s_waitcnt lgkmcnt(8)
    v_dot2c_f32_bf16 v20, v76, v24
    v_dot2c_f32_bf16 v21, v76, v76
    v_dot2c_f32_bf16 v22, v108, v24
    v_dot2c_f32_bf16 v23, v108, v108
    v_dot2c_f32_bf16 v20, v77, v24
    v_dot2c_f32_bf16 v21, v77, v77
    v_dot2c_f32_bf16 v22, v109, v24
    v_dot2c_f32_bf16 v23, v109, v109
    v_dot2c_f32_bf16 v20, v78, v24
    v_dot2c_f32_bf16 v21, v78, v78
    v_dot2c_f32_bf16 v22, v110, v24
    v_dot2c_f32_bf16 v23, v110, v110
    v_dot2c_f32_bf16 v20, v79, v24
    v_dot2c_f32_bf16 v21, v79, v79
    v_dot2c_f32_bf16 v22, v111, v24
    v_dot2c_f32_bf16 v23, v111, v111
    s_waitcnt lgkmcnt(6)
    v_dot2c_f32_bf16 v20, v80, v24
    v_dot2c_f32_bf16 v21, v80, v80
    v_dot2c_f32_bf16 v22, v112, v24
    v_dot2c_f32_bf16 v23, v112, v112
    v_dot2c_f32_bf16 v20, v81, v24
    v_dot2c_f32_bf16 v21, v81, v81
    v_dot2c_f32_bf16 v22, v113, v24
    v_dot2c_f32_bf16 v23, v113, v113
    v_dot2c_f32_bf16 v20, v82, v24
    v_dot2c_f32_bf16 v21, v82, v82
    v_dot2c_f32_bf16 v22, v114, v24
    v_dot2c_f32_bf16 v23, v114, v114
    v_dot2c_f32_bf16 v20, v83, v24
    v_dot2c_f32_bf16 v21, v83, v83
    v_dot2c_f32_bf16 v22, v115, v24
    v_dot2c_f32_bf16 v23, v115, v115
    s_add_u32 m0, s99, s63
    s_lshl3_add_u32 s54, s99, s98
    buffer_load_dwordx4 v4, s[32:35], s54 offen lds
    s_add_u32 s99, s99, 1024
    s_and_b32 s99, s99, 0x3fff
    s_waitcnt lgkmcnt(4)
    v_dot2c_f32_bf16 v20, v84, v24
    v_dot2c_f32_bf16 v21, v84, v84
    v_dot2c_f32_bf16 v22, v116, v24
    v_dot2c_f32_bf16 v23, v116, v116
    v_dot2c_f32_bf16 v20, v85, v24
    v_dot2c_f32_bf16 v21, v85, v85
    v_dot2c_f32_bf16 v22, v117, v24
    v_dot2c_f32_bf16 v23, v117, v117
    v_dot2c_f32_bf16 v20, v86, v24
    v_dot2c_f32_bf16 v21, v86, v86
    v_dot2c_f32_bf16 v22, v118, v24
    v_dot2c_f32_bf16 v23, v118, v118
    v_dot2c_f32_bf16 v20, v87, v24
    v_dot2c_f32_bf16 v21, v87, v87
    v_dot2c_f32_bf16 v22, v119, v24
    v_dot2c_f32_bf16 v23, v119, v119
    s_waitcnt lgkmcnt(2)
    v_dot2c_f32_bf16 v20, v88, v24
    v_dot2c_f32_bf16 v21, v88, v88
    v_dot2c_f32_bf16 v22, v120, v24
    v_dot2c_f32_bf16 v23, v120, v120
    v_dot2c_f32_bf16 v20, v89, v24
    v_dot2c_f32_bf16 v21, v89, v89
    v_dot2c_f32_bf16 v22, v121, v24
    v_dot2c_f32_bf16 v23, v121, v121
    v_dot2c_f32_bf16 v20, v90, v24
    v_dot2c_f32_bf16 v21, v90, v90
    v_dot2c_f32_bf16 v22, v122, v24
    v_dot2c_f32_bf16 v23, v122, v122
    v_dot2c_f32_bf16 v20, v91, v24
    v_dot2c_f32_bf16 v21, v91, v91
    v_dot2c_f32_bf16 v22, v123, v24
    v_dot2c_f32_bf16 v23, v123, v123
    s_add_u32 m0, s99, s63
    s_lshl3_add_u32 s54, s99, s98
    buffer_load_dwordx4 v4, s[32:35], s54 offen lds
    s_add_u32 s99, s99, 1024
    s_and_b32 s99, s99, 0x3fff
    s_waitcnt lgkmcnt(0)
    v_dot2c_f32_bf16 v20, v92, v24
    v_dot2c_f32_bf16 v21, v92, v92
    v_dot2c_f32_bf16 v22, v124, v24
    v_dot2c_f32_bf16 v23, v124, v124
    v_dot2c_f32_bf16 v20, v93, v24
    v_dot2c_f32_bf16 v21, v93, v93
    v_dot2c_f32_bf16 v22, v125, v24
    v_dot2c_f32_bf16 v23, v125, v125
    v_dot2c_f32_bf16 v20, v94, v24
    v_dot2c_f32_bf16 v21, v94, v94
    v_dot2c_f32_bf16 v22, v126, v24
    v_dot2c_f32_bf16 v23, v126, v126
    v_dot2c_f32_bf16 v20, v95, v24
    v_dot2c_f32_bf16 v21, v95, v95
    v_dot2c_f32_bf16 v22, v127, v24
    v_dot2c_f32_bf16 v23, v127, v127
    s_nop 2
    ds_write_b128 v9, v[20:23] offset:5120
    v_add_u32 v16, 135168, v2
    s_waitcnt lgkmcnt(0)
    s_barrier
    ds_read_b128 v[128:131], v16 offset:5120
    ds_read_b128 v[132:135], v16 offset:12288
    ds_read_b128 v[136:139], v16 offset:19456
    ds_read_b128 v[140:143], v16 offset:26624
    global_load_dwordx4 v[48:51], v6, s[26:27] sc1
    global_load_dwordx4 v[32:35], v5, s[28:29] offset:0 sc1
    global_load_dwordx4 v[36:39], v5, s[28:29] offset:256 sc1
    global_load_dwordx4 v[40:43], v5, s[28:29] offset:512 sc1
    global_load_dwordx4 v[44:47], v5, s[28:29] offset:768 sc1
    s_waitcnt lgkmcnt(0)
    v_add_f32 v128, v128, v132
    v_add_f32 v136, v136, v140
    v_add_f32 v129, v129, v133
    v_add_f32 v137, v137, v141
    v_add_f32 v130, v130, v134
    v_add_f32 v138, v138, v142
    v_add_f32 v131, v131, v135
    v_add_f32 v139, v139, v143
    v_add_f32 v128, v128, v136
    v_add_f32 v129, v129, v137
    v_add_f32 v130, v130, v138
    v_add_f32 v131, v131, v139
    s_nop 0
    v_permlane32_swap_b32 v128, v130
    v_permlane32_swap_b32 v129, v131
    v_add_f32 v128, v128, v130
    v_add_f32 v129, v129, v131
    v_mul_f32 v128, 0x3b000000, v128
    v_mul_f32 v129, 0x3b000000, v129
    v_fma_f32 v129, -v128, v128, v129
    v_max_f32 v129, 0, v129
    v_add_f32 v129, 0x3727c5ac, v129
    v_rsq_f32 v20, v129
    v_mov_b32 v7, v128
    v_mov_b32 v8, v128
    v_mul_f32 v24, v128, v20
    v_sub_f32 v24, 0, v24
    v_mov_b32 v22, v20
    v_mov_b32 v26, v24
    s_nop 0
    v_permlane32_swap_b32 v20, v22
    v_permlane32_swap_b32 v24, v26
    v_permlane32_swap_b32 v7, v8
    v_lshlrev_b32 v128, 16, v64
    v_and_b32 v129, 0xffff0000, v64
    v_pk_fma_f32 v[128:129], v[128:129], v[20:21], v[24:25] op_sel_hi:[1,0,0]
    v_lshlrev_b32 v130, 16, v65
    v_and_b32 v131, 0xffff0000, v65
    v_pk_fma_f32 v[130:131], v[130:131], v[20:21], v[24:25] op_sel_hi:[1,0,0]
    s_add_u32 m0, s99, s63
    s_lshl3_add_u32 s54, s99, s98
    buffer_load_dwordx4 v4, s[32:35], s54 offen lds
    s_add_u32 s99, s99, 1024
    s_and_b32 s99, s99, 0x3fff
    v_lshlrev_b32 v132, 16, v66
    v_and_b32 v133, 0xffff0000, v66
    v_pk_fma_f32 v[132:133], v[132:133], v[20:21], v[24:25] op_sel_hi:[1,0,0]
    v_lshlrev_b32 v134, 16, v67
    v_and_b32 v135, 0xffff0000, v67
    v_pk_fma_f32 v[134:135], v[134:135], v[20:21], v[24:25] op_sel_hi:[1,0,0]
    v_lshlrev_b32 v136, 16, v68
    v_and_b32 v137, 0xffff0000, v68
    v_pk_fma_f32 v[136:137], v[136:137], v[20:21], v[24:25] op_sel_hi:[1,0,0]
    v_lshlrev_b32 v138, 16, v69
    v_and_b32 v139, 0xffff0000, v69
    v_pk_fma_f32 v[138:139], v[138:139], v[20:21], v[24:25] op_sel_hi:[1,0,0]
    v_lshlrev_b32 v140, 16, v70
    v_and_b32 v141, 0xffff0000, v70
    v_pk_fma_f32 v[140:141], v[140:141], v[20:21], v[24:25] op_sel_hi:[1,0,0]
    s_add_u32 m0, s99, s63
    s_lshl3_add_u32 s54, s99, s98
    buffer_load_dwordx4 v4, s[32:35], s54 offen lds
    s_add_u32 s99, s99, 1024
    s_and_b32 s99, s99, 0x3fff
    v_lshlrev_b32 v142, 16, v71
    v_and_b32 v143, 0xffff0000, v71
    v_pk_fma_f32 v[142:143], v[142:143], v[20:21], v[24:25] op_sel_hi:[1,0,0]
    v_lshlrev_b32 v144, 16, v72
    v_and_b32 v145, 0xffff0000, v72
    v_pk_fma_f32 v[144:145], v[144:145], v[20:21], v[24:25] op_sel_hi:[1,0,0]
    v_lshlrev_b32 v146, 16, v73
    v_and_b32 v147, 0xffff0000, v73
    v_pk_fma_f32 v[146:147], v[146:147], v[20:21], v[24:25] op_sel_hi:[1,0,0]
    v_lshlrev_b32 v148, 16, v74
    v_and_b32 v149, 0xffff0000, v74
    v_pk_fma_f32 v[148:149], v[148:149], v[20:21], v[24:25] op_sel_hi:[1,0,0]
    v_lshlrev_b32 v150, 16, v75
    v_and_b32 v151, 0xffff0000, v75
    v_pk_fma_f32 v[150:151], v[150:151], v[20:21], v[24:25] op_sel_hi:[1,0,0]
    s_add_u32 m0, s99, s63
    s_lshl3_add_u32 s54, s99, s98
    buffer_load_dwordx4 v4, s[32:35], s54 offen lds
    s_add_u32 s99, s99, 1024
    s_and_b32 s99, s99, 0x3fff
    v_lshlrev_b32 v152, 16, v76
    v_and_b32 v153, 0xffff0000, v76
    v_pk_fma_f32 v[152:153], v[152:153], v[20:21], v[24:25] op_sel_hi:[1,0,0]
    v_lshlrev_b32 v154, 16, v77
    v_and_b32 v155, 0xffff0000, v77
    v_pk_fma_f32 v[154:155], v[154:155], v[20:21], v[24:25] op_sel_hi:[1,0,0]
    v_lshlrev_b32 v156, 16, v78
    v_and_b32 v157, 0xffff0000, v78
    v_pk_fma_f32 v[156:157], v[156:157], v[20:21], v[24:25] op_sel_hi:[1,0,0]
    v_lshlrev_b32 v158, 16, v79
    v_and_b32 v159, 0xffff0000, v79
    v_pk_fma_f32 v[158:159], v[158:159], v[20:21], v[24:25] op_sel_hi:[1,0,0]
    v_lshlrev_b32 v160, 16, v80
    v_and_b32 v161, 0xffff0000, v80
    v_pk_fma_f32 v[160:161], v[160:161], v[20:21], v[24:25] op_sel_hi:[1,0,0]
    s_add_u32 m0, s99, s63
    s_lshl3_add_u32 s54, s99, s98
    buffer_load_dwordx4 v4, s[32:35], s54 offen lds
    s_add_u32 s99, s99, 1024
    s_and_b32 s99, s99, 0x3fff
    s_waitcnt vmcnt(19)
    v_lshlrev_b32 v162, 16, v81
    v_and_b32 v163, 0xffff0000, v81
    v_pk_fma_f32 v[162:163], v[162:163], v[20:21], v[24:25] op_sel_hi:[1,0,0]
    ds_read_b64_tr_b16 a[64:65], v0 offset:0
    v_lshlrev_b32 v164, 16, v82
    v_and_b32 v165, 0xffff0000, v82
    v_pk_fma_f32 v[164:165], v[164:165], v[20:21], v[24:25] op_sel_hi:[1,0,0]
    v_lshlrev_b32 v166, 16, v83
    v_and_b32 v167, 0xffff0000, v83
    v_pk_fma_f32 v[166:167], v[166:167], v[20:21], v[24:25] op_sel_hi:[1,0,0]
    ds_read_b64_tr_b16 a[66:67], v0 offset:128
    v_lshlrev_b32 v168, 16, v84
    v_and_b32 v169, 0xffff0000, v84
    v_pk_fma_f32 v[168:169], v[168:169], v[20:21], v[24:25] op_sel_hi:[1,0,0]
    v_lshlrev_b32 v170, 16, v85
    v_and_b32 v171, 0xffff0000, v85
    v_pk_fma_f32 v[170:171], v[170:171], v[20:21], v[24:25] op_sel_hi:[1,0,0]
    s_add_u32 m0, s99, s63
    s_lshl3_add_u32 s54, s99, s98
    buffer_load_dwordx4 v4, s[32:35], s54 offen lds
    s_add_u32 s99, s99, 1024
    s_and_b32 s99, s99, 0x3fff
    ds_read_b64_tr_b16 a[68:69], v0 offset:512
    v_lshlrev_b32 v172, 16, v86
    v_and_b32 v173, 0xffff0000, v86
    v_pk_fma_f32 v[172:173], v[172:173], v[20:21], v[24:25] op_sel_hi:[1,0,0]
    v_lshlrev_b32 v174, 16, v87
    v_and_b32 v175, 0xffff0000, v87
    v_pk_fma_f32 v[174:175], v[174:175], v[20:21], v[24:25] op_sel_hi:[1,0,0]
    ds_read_b64_tr_b16 a[70:71], v0 offset:640
    v_lshlrev_b32 v176, 16, v88
    v_and_b32 v177, 0xffff0000, v88
    v_pk_fma_f32 v[176:177], v[176:177], v[20:21], v[24:25] op_sel_hi:[1,0,0]
    v_lshlrev_b32 v178, 16, v89
    v_and_b32 v179, 0xffff0000, v89
    v_pk_fma_f32 v[178:179], v[178:179], v[20:21], v[24:25] op_sel_hi:[1,0,0]
    ds_read_b64_tr_b16 a[72:73], v0 offset:1024
    v_lshlrev_b32 v180, 16, v90
    v_and_b32 v181, 0xffff0000, v90
    v_pk_fma_f32 v[180:181], v[180:181], v[20:21], v[24:25] op_sel_hi:[1,0,0]
    s_add_u32 m0, s99, s63
    s_lshl3_add_u32 s54, s99, s98
    buffer_load_dwordx4 v4, s[32:35], s54 offen lds
    s_add_u32 s99, s99, 1024
    s_and_b32 s99, s99, 0x3fff
    v_lshlrev_b32 v182, 16, v91
    v_and_b32 v183, 0xffff0000, v91
    v_pk_fma_f32 v[182:183], v[182:183], v[20:21], v[24:25] op_sel_hi:[1,0,0]
    ds_read_b64_tr_b16 a[74:75], v0 offset:1152
    v_lshlrev_b32 v184, 16, v92
    v_and_b32 v185, 0xffff0000, v92
    v_pk_fma_f32 v[184:185], v[184:185], v[20:21], v[24:25] op_sel_hi:[1,0,0]
    v_lshlrev_b32 v186, 16, v93
    v_and_b32 v187, 0xffff0000, v93
    v_pk_fma_f32 v[186:187], v[186:187], v[20:21], v[24:25] op_sel_hi:[1,0,0]
    ds_read_b64_tr_b16 a[76:77], v0 offset:1536
    v_lshlrev_b32 v188, 16, v94
    v_and_b32 v189, 0xffff0000, v94
    v_pk_fma_f32 v[188:189], v[188:189], v[20:21], v[24:25] op_sel_hi:[1,0,0]
    v_lshlrev_b32 v190, 16, v95
    v_and_b32 v191, 0xffff0000, v95
    v_pk_fma_f32 v[190:191], v[190:191], v[20:21], v[24:25] op_sel_hi:[1,0,0]
    ds_read_b64_tr_b16 a[78:79], v0 offset:1664
    v_lshlrev_b32 v192, 16, v96
    v_and_b32 v193, 0xffff0000, v96
    v_pk_fma_f32 v[192:193], v[192:193], v[22:23], v[26:27] op_sel_hi:[1,0,0]
    v_lshlrev_b32 v194, 16, v97
    v_and_b32 v195, 0xffff0000, v97
    v_pk_fma_f32 v[194:195], v[194:195], v[22:23], v[26:27] op_sel_hi:[1,0,0]
    ds_read_b64_tr_b16 a[80:81], v0 offset:2048
    v_lshlrev_b32 v196, 16, v98
    v_and_b32 v197, 0xffff0000, v98
    v_pk_fma_f32 v[196:197], v[196:197], v[22:23], v[26:27] op_sel_hi:[1,0,0]
    v_lshlrev_b32 v198, 16, v99
    v_and_b32 v199, 0xffff0000, v99
    v_pk_fma_f32 v[198:199], v[198:199], v[22:23], v[26:27] op_sel_hi:[1,0,0]
    ds_read_b64_tr_b16 a[82:83], v0 offset:2176
    v_lshlrev_b32 v200, 16, v100
    v_and_b32 v201, 0xffff0000, v100
    v_pk_fma_f32 v[200:201], v[200:201], v[22:23], v[26:27] op_sel_hi:[1,0,0]
    v_lshlrev_b32 v202, 16, v101
    v_and_b32 v203, 0xffff0000, v101
    v_pk_fma_f32 v[202:203], v[202:203], v[22:23], v[26:27] op_sel_hi:[1,0,0]
    ds_read_b64_tr_b16 a[84:85], v0 offset:2560
    v_lshlrev_b32 v204, 16, v102
    v_and_b32 v205, 0xffff0000, v102
    v_pk_fma_f32 v[204:205], v[204:205], v[22:23], v[26:27] op_sel_hi:[1,0,0]
    v_lshlrev_b32 v206, 16, v103
    v_and_b32 v207, 0xffff0000, v103
    v_pk_fma_f32 v[206:207], v[206:207], v[22:23], v[26:27] op_sel_hi:[1,0,0]
    ds_read_b64_tr_b16 a[86:87], v0 offset:2688
    v_lshlrev_b32 v208, 16, v104
    v_and_b32 v209, 0xffff0000, v104
    v_pk_fma_f32 v[208:209], v[208:209], v[22:23], v[26:27] op_sel_hi:[1,0,0]
    v_lshlrev_b32 v210, 16, v105
    v_and_b32 v211, 0xffff0000, v105
    v_pk_fma_f32 v[210:211], v[210:211], v[22:23], v[26:27] op_sel_hi:[1,0,0]
    ds_read_b64_tr_b16 a[88:89], v0 offset:3072
    v_lshlrev_b32 v212, 16, v106
    v_and_b32 v213, 0xffff0000, v106
    v_pk_fma_f32 v[212:213], v[212:213], v[22:23], v[26:27] op_sel_hi:[1,0,0]
    v_lshlrev_b32 v214, 16, v107
    v_and_b32 v215, 0xffff0000, v107
    v_pk_fma_f32 v[214:215], v[214:215], v[22:23], v[26:27] op_sel_hi:[1,0,0]
    ds_read_b64_tr_b16 a[90:91], v0 offset:3200
    v_lshlrev_b32 v216, 16, v108
    v_and_b32 v217, 0xffff0000, v108
    v_pk_fma_f32 v[216:217], v[216:217], v[22:23], v[26:27] op_sel_hi:[1,0,0]
    v_lshlrev_b32 v218, 16, v109
    v_and_b32 v219, 0xffff0000, v109
    v_pk_fma_f32 v[218:219], v[218:219], v[22:23], v[26:27] op_sel_hi:[1,0,0]
    ds_read_b64_tr_b16 a[92:93], v0 offset:3584
    v_lshlrev_b32 v220, 16, v110
    v_and_b32 v221, 0xffff0000, v110
    v_pk_fma_f32 v[220:221], v[220:221], v[22:23], v[26:27] op_sel_hi:[1,0,0]
    v_lshlrev_b32 v222, 16, v111
    v_and_b32 v223, 0xffff0000, v111
    v_pk_fma_f32 v[222:223], v[222:223], v[22:23], v[26:27] op_sel_hi:[1,0,0]
    ds_read_b64_tr_b16 a[94:95], v0 offset:3712
    v_lshlrev_b32 v224, 16, v112
    v_and_b32 v225, 0xffff0000, v112
    v_pk_fma_f32 v[224:225], v[224:225], v[22:23], v[26:27] op_sel_hi:[1,0,0]
    v_lshlrev_b32 v226, 16, v113
    v_and_b32 v227, 0xffff0000, v113
    v_pk_fma_f32 v[226:227], v[226:227], v[22:23], v[26:27] op_sel_hi:[1,0,0]
    v_lshlrev_b32 v228, 16, v114
    v_and_b32 v229, 0xffff0000, v114
    v_pk_fma_f32 v[228:229], v[228:229], v[22:23], v[26:27] op_sel_hi:[1,0,0]
    v_lshlrev_b32 v230, 16, v115
    v_and_b32 v231, 0xffff0000, v115
    v_pk_fma_f32 v[230:231], v[230:231], v[22:23], v[26:27] op_sel_hi:[1,0,0]
    v_lshlrev_b32 v232, 16, v116
    v_and_b32 v233, 0xffff0000, v116
    v_pk_fma_f32 v[232:233], v[232:233], v[22:23], v[26:27] op_sel_hi:[1,0,0]
    v_lshlrev_b32 v234, 16, v117
    v_and_b32 v235, 0xffff0000, v117
    v_pk_fma_f32 v[234:235], v[234:235], v[22:23], v[26:27] op_sel_hi:[1,0,0]
    v_lshlrev_b32 v236, 16, v118
    v_and_b32 v237, 0xffff0000, v118
    v_pk_fma_f32 v[236:237], v[236:237], v[22:23], v[26:27] op_sel_hi:[1,0,0]
    v_lshlrev_b32 v238, 16, v119
    v_and_b32 v239, 0xffff0000, v119
    v_pk_fma_f32 v[238:239], v[238:239], v[22:23], v[26:27] op_sel_hi:[1,0,0]
    v_lshlrev_b32 v240, 16, v120
    v_and_b32 v241, 0xffff0000, v120
    v_pk_fma_f32 v[240:241], v[240:241], v[22:23], v[26:27] op_sel_hi:[1,0,0]
    v_lshlrev_b32 v242, 16, v121
    v_and_b32 v243, 0xffff0000, v121
    v_pk_fma_f32 v[242:243], v[242:243], v[22:23], v[26:27] op_sel_hi:[1,0,0]
    v_lshlrev_b32 v244, 16, v122
    v_and_b32 v245, 0xffff0000, v122
    v_pk_fma_f32 v[244:245], v[244:245], v[22:23], v[26:27] op_sel_hi:[1,0,0]
    v_lshlrev_b32 v246, 16, v123
    v_and_b32 v247, 0xffff0000, v123
    v_pk_fma_f32 v[246:247], v[246:247], v[22:23], v[26:27] op_sel_hi:[1,0,0]
    v_lshlrev_b32 v248, 16, v124
    v_and_b32 v249, 0xffff0000, v124
    v_pk_fma_f32 v[248:249], v[248:249], v[22:23], v[26:27] op_sel_hi:[1,0,0]
    v_lshlrev_b32 v250, 16, v125
    v_and_b32 v251, 0xffff0000, v125
    v_pk_fma_f32 v[250:251], v[250:251], v[22:23], v[26:27] op_sel_hi:[1,0,0]
    v_lshlrev_b32 v252, 16, v126
    v_and_b32 v253, 0xffff0000, v126
    v_pk_fma_f32 v[252:253], v[252:253], v[22:23], v[26:27] op_sel_hi:[1,0,0]
    v_lshlrev_b32 v254, 16, v127
    v_and_b32 v255, 0xffff0000, v127
    v_pk_fma_f32 v[254:255], v[254:255], v[22:23], v[26:27] op_sel_hi:[1,0,0]
    s_cmp_eq_u32 s47, 0
    s_cbranch_scc1 adaLN_cond__grouped_kv_mqa__dense_activation_silu__prompt_kernel_nsw18
    v_swap_b32 v7, v8
adaLN_cond__grouped_kv_mqa__dense_activation_silu__prompt_kernel_nsw18:
    v_lshrrev_b32 v16, 5, v1
    v_cvt_f32_u32 v22, v16
    v_lshl_add_u32 v23, v16, 5, s49
    s_waitcnt lgkmcnt(0)
    s_mov_b32 m0, s49
    s_add_u32 s54, s58, s59
    buffer_load_dwordx4 v14, s[36:39], s58 offen lds
    s_add_u32 m0, m0, 1024
    s_add_u32 s55, s58, s60
    buffer_load_dwordx4 v14, s[36:39], s54 offen lds
    s_add_u32 m0, m0, 1024
    s_add_u32 s54, s54, s60
    buffer_load_dwordx4 v14, s[36:39], s55 offen lds
    s_add_u32 m0, m0, 1024
    s_nop 0
    buffer_load_dwordx4 v14, s[36:39], s54 offen lds
    s_mov_b32 s54, 0x0c0c0400
    s_mov_b32 s55, 0x04000c0c
    s_cmp_lt_u32 s2, 192
    s_cselect_b32 s99, 1, 0
    s_branch adaLN_cond__grouped_kv_mqa__dense_activation_silu__prompt_kernel_pmodw23
adaLN_cond__grouped_kv_mqa__dense_activation_silu__prompt_kernel_pmod21:
    global_load_dwordx4 v[48:51], v6, s[26:27] sc1
    global_load_dwordx4 v[32:35], v5, s[28:29] offset:0 sc1
    global_load_dwordx4 v[36:39], v5, s[28:29] offset:256 sc1
    global_load_dwordx4 v[40:43], v5, s[28:29] offset:512 sc1
    global_load_dwordx4 v[44:47], v5, s[28:29] offset:768 sc1
    s_cmp_eq_u32 s99, 0
    s_mov_b32 s99, 1
    s_cbranch_scc1 adaLN_cond__grouped_kv_mqa__dense_activation_silu__prompt_kernel_rb19
adaLN_cond__grouped_kv_mqa__dense_activation_silu__prompt_kernel_rr20:
    s_mov_b32 s54, 0x0c0c0400
    s_mov_b32 s55, 0x04000c0c
    s_waitcnt vmcnt(0)
adaLN_cond__grouped_kv_mqa__dense_activation_silu__prompt_kernel_pmodw23:
    s_waitcnt vmcnt(10)
adaLN_cond__grouped_kv_mqa__dense_activation_silu__prompt_kernel_pmodc22:
    v_perm_b32 v52, v33, v32, s54
    v_perm_b32 v56, v35, v34, s55
    v_perm_b32 v53, v37, v36, s54
    v_perm_b32 v57, v39, v38, s55
    v_perm_b32 v54, v41, v40, s54
    v_perm_b32 v58, v43, v42, s55
    v_perm_b32 v55, v45, v44, s54
    v_perm_b32 v59, v47, v46, s55
    v_xor_b32 v52, v52, v48
    v_xor_b32 v53, v53, v49
    v_xor_b32 v54, v54, v50
    v_xor_b32 v55, v55, v51
    v_min3_u32 v48, v48, v49, v50
    v_min_u32 v48, v48, v51
    v_xor_b32 v52, v52, v56
    v_xor_b32 v53, v53, v57
    v_xor_b32 v54, v54, v58
    v_xor_b32 v55, v55, v59
    v_or3_b32 v52, v52, v53, v54
    v_cmp_eq_u32 vcc, 0, v48
    v_or_b32 v52, v52, v55
    v_cmp_ne_u32 s[56:57], 0, v52
    v_add_f32 v32, v32, v36
    v_add_f32 v40, v40, v44
    v_add_f32 v33, v33, v37
    v_add_f32 v41, v41, v45
    v_add_f32 v34, v34, v38
    v_add_f32 v42, v42, v46
    v_add_f32 v35, v35, v39
    v_add_f32 v43, v43, v47
    s_or_b64 vcc, vcc, s[56:57]
    s_cbranch_vccz adaLN_cond__grouped_kv_mqa__dense_activation_silu__prompt_kernel_ok24
    s_add_u32 s96, s96, 1
    s_cmp_lt_u32 s96, 131072
    s_cbranch_scc1 adaLN_cond__grouped_kv_mqa__dense_activation_silu__prompt_kernel_pmod21
adaLN_cond__grouped_kv_mqa__dense_activation_silu__prompt_kernel_ok24:
    v_add_f32 v32, v32, v40
    v_add_f32 v33, v33, v41
    v_add_f32 v34, v34, v42
    v_add_f32 v35, v35, v43
    v_cvt_pk_bf16_f32 v36, v32, v33
    v_cvt_pk_bf16_f32 v37, v34, v35
    v_lshlrev_b32 v32, 16, v36
    v_and_b32 v33, 0xffff0000, v36
    v_lshlrev_b32 v34, 16, v37
    v_and_b32 v35, 0xffff0000, v37
    v_add_f32 v32, v22, v32
    v_add_f32 v33, v22, v33
    v_add_f32 v34, v22, v34
    v_add_f32 v35, v22, v35
    v_cvt_pk_bf16_f32 v36, v32, v33
    v_cvt_pk_bf16_f32 v37, v34, v35
    v_lshlrev_b32 v32, 16, v36
    v_and_b32 v33, 0xffff0000, v36
    v_lshlrev_b32 v34, 16, v37
    v_and_b32 v35, 0xffff0000, v37
    ds_write_b128 v9, v[32:35] offset:4096
    v_add_u32 v16, s48, v2
    s_cmp_lg_u32 s99, 0
    s_cbranch_scc1 adaLN_cond__grouped_kv_mqa__dense_activation_silu__prompt_kernel_nrb25
adaLN_cond__grouped_kv_mqa__dense_activation_silu__prompt_kernel_rb19:
    v_lshlrev_b32 v64, 16, v28
    v_and_b32 v65, 0xffff0000, v28
    v_lshlrev_b32 v66, 16, v29
    v_and_b32 v67, 0xffff0000, v29
    v_lshlrev_b32 v68, 16, v30
    v_and_b32 v69, 0xffff0000, v30
    v_lshlrev_b32 v70, 16, v31
    v_and_b32 v71, 0xffff0000, v31
    v_mul_f32 v72, 0xbfb8aa3b, v64
    v_mul_f32 v73, 0xbfb8aa3b, v65
    v_mul_f32 v74, 0xbfb8aa3b, v66
    v_mul_f32 v75, 0xbfb8aa3b, v67
    v_mul_f32 v76, 0xbfb8aa3b, v68
    v_mul_f32 v77, 0xbfb8aa3b, v69
    v_mul_f32 v78, 0xbfb8aa3b, v70
    v_mul_f32 v79, 0xbfb8aa3b, v71
    v_exp_f32 v72, v72
    v_exp_f32 v73, v73
    v_exp_f32 v74, v74
    v_exp_f32 v75, v75
    v_exp_f32 v76, v76
    v_exp_f32 v77, v77
    v_exp_f32 v78, v78
    v_exp_f32 v79, v79
    v_add_f32 v72, 1.0, v72
    v_add_f32 v73, 1.0, v73
    v_add_f32 v74, 1.0, v74
    v_add_f32 v75, 1.0, v75
    v_add_f32 v76, 1.0, v76
    v_add_f32 v77, 1.0, v77
    v_add_f32 v78, 1.0, v78
    v_add_f32 v79, 1.0, v79
    v_rcp_f32 v72, v72
    v_rcp_f32 v73, v73
    v_rcp_f32 v74, v74
    v_rcp_f32 v75, v75
    v_rcp_f32 v76, v76
    v_rcp_f32 v77, v77
    v_rcp_f32 v78, v78
    v_rcp_f32 v79, v79
    v_mul_f32 v64, v64, v72
    v_mul_f32 v65, v65, v73
    v_mul_f32 v66, v66, v74
    v_mul_f32 v67, v67, v75
    v_mul_f32 v68, v68, v76
    v_mul_f32 v69, v69, v77
    v_mul_f32 v70, v70, v78
    v_mul_f32 v71, v71, v79
    v_cvt_pk_bf16_f32 v28, v64, v65
    v_cvt_pk_bf16_f32 v29, v66, v67
    v_cvt_pk_bf16_f32 v30, v68, v69
    v_cvt_pk_bf16_f32 v31, v70, v71
    v_accvgpr_read_b32 v96, a128
    v_accvgpr_read_b32 v97, a129
    v_accvgpr_read_b32 v98, a130
    v_accvgpr_read_b32 v99, a131
    v_accvgpr_read_b32 v100, a132
    v_accvgpr_read_b32 v101, a133
    v_accvgpr_read_b32 v102, a134
    v_accvgpr_read_b32 v103, a135
    v_accvgpr_read_b32 v104, a136
    v_accvgpr_read_b32 v105, a137
    v_accvgpr_read_b32 v106, a138
    v_accvgpr_read_b32 v107, a139
    v_accvgpr_read_b32 v108, a140
    v_accvgpr_read_b32 v109, a141
    v_accvgpr_read_b32 v110, a142
    v_accvgpr_read_b32 v111, a143
    v_accvgpr_read_b32 v112, a144
    v_accvgpr_read_b32 v113, a145
    v_accvgpr_read_b32 v114, a146
    v_accvgpr_read_b32 v115, a147
    v_accvgpr_read_b32 v116, a148
    v_accvgpr_read_b32 v117, a149
    v_accvgpr_read_b32 v118, a150
    v_accvgpr_read_b32 v119, a151
    v_accvgpr_read_b32 v120, a152
    v_accvgpr_read_b32 v121, a153
    v_accvgpr_read_b32 v122, a154
    v_accvgpr_read_b32 v123, a155
    v_accvgpr_read_b32 v124, a156
    v_accvgpr_read_b32 v125, a157
    v_accvgpr_read_b32 v126, a158
    v_accvgpr_read_b32 v127, a159
    s_mov_b32 s54, 0x05040100
    s_mov_b32 s55, 0x07060302
    v_and_b32 v72, 7, v1
    v_lshrrev_b32 v73, 4, v1
    v_lshlrev_b32 v72, 5, v72
    v_lshl_add_u32 v72, v73, 3, v72
    v_add_u32 v72, s49, v72
    v_perm_b32 v64, v100, v96, s54
    v_perm_b32 v65, v100, v96, s55
    v_perm_b32 v66, v101, v97, s54
    v_perm_b32 v67, v101, v97, s55
    v_perm_b32 v68, v102, v98, s54
    v_perm_b32 v69, v102, v98, s55
    v_perm_b32 v70, v103, v99, s54
    v_perm_b32 v71, v103, v99, s55
    v_dot2_f32_bf16 v80, v64, v28, 0
    v_dot2_f32_bf16 v81, v65, v28, 0
    v_dot2_f32_bf16 v82, v66, v28, 0
    v_dot2_f32_bf16 v83, v67, v28, 0
    v_dot2_f32_bf16 v84, v68, v28, 0
    v_dot2_f32_bf16 v85, v69, v28, 0
    v_dot2_f32_bf16 v86, v70, v28, 0
    v_dot2_f32_bf16 v87, v71, v28, 0
    v_perm_b32 v64, v108, v104, s54
    v_perm_b32 v65, v108, v104, s55
    v_perm_b32 v66, v109, v105, s54
    v_perm_b32 v67, v109, v105, s55
    v_perm_b32 v68, v110, v106, s54
    v_perm_b32 v69, v110, v106, s55
    v_perm_b32 v70, v111, v107, s54
    v_perm_b32 v71, v111, v107, s55
    v_dot2_f32_bf16 v80, v64, v29, v80
    v_dot2_f32_bf16 v81, v65, v29, v81
    v_dot2_f32_bf16 v82, v66, v29, v82
    v_dot2_f32_bf16 v83, v67, v29, v83
    v_dot2_f32_bf16 v84, v68, v29, v84
    v_dot2_f32_bf16 v85, v69, v29, v85
    v_dot2_f32_bf16 v86, v70, v29, v86
    v_dot2_f32_bf16 v87, v71, v29, v87
    v_perm_b32 v64, v116, v112, s54
    v_perm_b32 v65, v116, v112, s55
    v_perm_b32 v66, v117, v113, s54
    v_perm_b32 v67, v117, v113, s55
    v_perm_b32 v68, v118, v114, s54
    v_perm_b32 v69, v118, v114, s55
    v_perm_b32 v70, v119, v115, s54
    v_perm_b32 v71, v119, v115, s55
    v_dot2_f32_bf16 v80, v64, v30, v80
    v_dot2_f32_bf16 v81, v65, v30, v81
    v_dot2_f32_bf16 v82, v66, v30, v82
    v_dot2_f32_bf16 v83, v67, v30, v83
    v_dot2_f32_bf16 v84, v68, v30, v84
    v_dot2_f32_bf16 v85, v69, v30, v85
    v_dot2_f32_bf16 v86, v70, v30, v86
    v_dot2_f32_bf16 v87, v71, v30, v87
    v_perm_b32 v64, v124, v120, s54
    v_perm_b32 v65, v124, v120, s55
    v_perm_b32 v66, v125, v121, s54
    v_perm_b32 v67, v125, v121, s55
    v_perm_b32 v68, v126, v122, s54
    v_perm_b32 v69, v126, v122, s55
    v_perm_b32 v70, v127, v123, s54
    v_perm_b32 v71, v127, v123, s55
    v_dot2_f32_bf16 v80, v64, v31, v80
    v_dot2_f32_bf16 v81, v65, v31, v81
    v_dot2_f32_bf16 v82, v66, v31, v82
    v_dot2_f32_bf16 v83, v67, v31, v83
    v_dot2_f32_bf16 v84, v68, v31, v84
    v_dot2_f32_bf16 v85, v69, v31, v85
    v_dot2_f32_bf16 v86, v70, v31, v86
    v_dot2_f32_bf16 v87, v71, v31, v87
    v_permlane32_swap_b32 v80, v84
    v_permlane32_swap_b32 v81, v85
    v_permlane32_swap_b32 v82, v86
    v_permlane32_swap_b32 v83, v87
    v_add_f32 v80, v80, v84
    v_add_f32 v81, v81, v85
    v_add_f32 v82, v82, v86
    v_add_f32 v83, v83, v87
    s_nop 0
    v_permlane16_swap_b32 v80, v82
    v_permlane16_swap_b32 v81, v83
    v_add_f32 v80, v80, v82
    v_add_f32 v81, v81, v83
    s_nop 0
    v_add_f32_dpp v80, v80, v80 row_ror:8 row_mask:0xf bank_mask:0xf
    v_add_f32_dpp v81, v81, v81 row_ror:8 row_mask:0xf bank_mask:0xf
    ds_write_b64 v72, v[80:81] offset:6144
    v_lshrrev_b32 v100, 4, v1
    v_and_b32 v101, 15, v1
    v_mul_u32_u24 v102, 7168, v100
    v_lshl_add_u32 v102, v101, 4, v102
    v_add_u32 v102, 135168, v102
    v_lshlrev_b32 v101, 4, v101
    v_lshl_add_u32 v100, v100, 2, v101
    s_and_b32 s54, s2, 1
    s_mul_i32 s54, s54, 12288
    s_sub_u32 s55, s2, 192
    s_lshr_b32 s55, s55, 1
    s_lshl_b32 s55, s55, 8
    s_add_u32 s54, s54, s55
    s_addk_i32 s54, 4096
    v_add_u32 v100, s54, v100
    s_cmp_lg_u32 s99, 0
    s_cbranch_scc1 adaLN_cond__grouped_kv_mqa__dense_activation_silu__prompt_kernel_rr20
adaLN_cond__grouped_kv_mqa__dense_activation_silu__prompt_kernel_nrb25:
    s_sub_u32 s54, s45, 2
    s_cmp_ge_u32 s54, 4
    s_cbranch_scc1 adaLN_cond__grouped_kv_mqa__dense_activation_silu__prompt_kernel_hn27
    s_cmp_ge_u32 s54, 2
    s_cbranch_scc1 adaLN_cond__grouped_kv_mqa__dense_activation_silu__prompt_kernel_hv26
    ds_read_b128 v[32:35], v23 offset:4096
    ds_read_b128 v[40:43], v23 offset:4608
    ds_read_b128 v[36:39], v23 offset:4112
    ds_read_b128 v[44:47], v23 offset:4624
    ds_read_b128 v[48:51], v23 offset:4160
    ds_read_b128 v[56:59], v23 offset:4672
    ds_read_b128 v[52:55], v23 offset:4176
    ds_read_b128 v[60:63], v23 offset:4688
    s_waitcnt lgkmcnt(4)
    v_pk_fma_f32 v[128:129], v[128:129], v[40:41], v[32:33]
    v_pk_fma_f32 v[130:131], v[130:131], v[42:43], v[34:35]
    v_pk_fma_f32 v[132:133], v[132:133], v[44:45], v[36:37]
    v_pk_fma_f32 v[134:135], v[134:135], v[46:47], v[38:39]
    ds_read_b128 v[32:35], v23 offset:4224
    ds_read_b128 v[40:43], v23 offset:4736
    ds_read_b128 v[36:39], v23 offset:4240
    ds_read_b128 v[44:47], v23 offset:4752
    v_cvt_pk_bf16_f32 v64, v128, v129
    v_cvt_pk_bf16_f32 v65, v130, v131
    v_cvt_pk_bf16_f32 v66, v132, v133
    v_cvt_pk_bf16_f32 v67, v134, v135
    s_waitcnt lgkmcnt(4)
    v_pk_fma_f32 v[136:137], v[136:137], v[56:57], v[48:49]
    v_pk_fma_f32 v[138:139], v[138:139], v[58:59], v[50:51]
    v_pk_fma_f32 v[140:141], v[140:141], v[60:61], v[52:53]
    v_pk_fma_f32 v[142:143], v[142:143], v[62:63], v[54:55]
    v_mfma_f32_32x32x16_bf16 a[96:111], a[64:67], v[64:67], 0
    ds_read_b128 v[48:51], v23 offset:4288
    ds_read_b128 v[56:59], v23 offset:4800
    ds_read_b128 v[52:55], v23 offset:4304
    ds_read_b128 v[60:63], v23 offset:4816
    v_cvt_pk_bf16_f32 v68, v136, v137
    v_cvt_pk_bf16_f32 v69, v138, v139
    v_cvt_pk_bf16_f32 v70, v140, v141
    v_cvt_pk_bf16_f32 v71, v142, v143
    s_waitcnt lgkmcnt(4)
    v_pk_fma_f32 v[144:145], v[144:145], v[40:41], v[32:33]
    v_pk_fma_f32 v[146:147], v[146:147], v[42:43], v[34:35]
    v_pk_fma_f32 v[148:149], v[148:149], v[44:45], v[36:37]
    v_pk_fma_f32 v[150:151], v[150:151], v[46:47], v[38:39]
    v_mfma_f32_32x32x16_bf16 a[96:111], a[68:71], v[68:71], a[96:111]
    ds_read_b128 v[32:35], v23 offset:4352
    ds_read_b128 v[40:43], v23 offset:4864
    ds_read_b128 v[36:39], v23 offset:4368
    ds_read_b128 v[44:47], v23 offset:4880
    v_cvt_pk_bf16_f32 v72, v144, v145
    v_cvt_pk_bf16_f32 v73, v146, v147
    v_cvt_pk_bf16_f32 v74, v148, v149
    v_cvt_pk_bf16_f32 v75, v150, v151
    s_waitcnt lgkmcnt(4)
    v_pk_fma_f32 v[152:153], v[152:153], v[56:57], v[48:49]
    v_pk_fma_f32 v[154:155], v[154:155], v[58:59], v[50:51]
    v_pk_fma_f32 v[156:157], v[156:157], v[60:61], v[52:53]
    v_pk_fma_f32 v[158:159], v[158:159], v[62:63], v[54:55]
    v_mfma_f32_32x32x16_bf16 a[96:111], a[72:75], v[72:75], a[96:111]
    ds_read_b128 v[48:51], v23 offset:4416
    ds_read_b128 v[56:59], v23 offset:4928
    ds_read_b128 v[52:55], v23 offset:4432
    ds_read_b128 v[60:63], v23 offset:4944
    v_cvt_pk_bf16_f32 v76, v152, v153
    v_cvt_pk_bf16_f32 v77, v154, v155
    v_cvt_pk_bf16_f32 v78, v156, v157
    v_cvt_pk_bf16_f32 v79, v158, v159
    s_waitcnt lgkmcnt(4)
    v_pk_fma_f32 v[160:161], v[160:161], v[40:41], v[32:33]
    v_pk_fma_f32 v[162:163], v[162:163], v[42:43], v[34:35]
    v_pk_fma_f32 v[164:165], v[164:165], v[44:45], v[36:37]
    v_pk_fma_f32 v[166:167], v[166:167], v[46:47], v[38:39]
    v_mfma_f32_32x32x16_bf16 a[96:111], a[76:79], v[76:79], a[96:111]
    ds_read_b128 v[32:35], v23 offset:4480
    ds_read_b128 v[40:43], v23 offset:4992
    ds_read_b128 v[36:39], v23 offset:4496
    ds_read_b128 v[44:47], v23 offset:5008
    v_cvt_pk_bf16_f32 v80, v160, v161
    v_cvt_pk_bf16_f32 v81, v162, v163
    v_cvt_pk_bf16_f32 v82, v164, v165
    v_cvt_pk_bf16_f32 v83, v166, v167
    s_waitcnt lgkmcnt(4)
    v_pk_fma_f32 v[168:169], v[168:169], v[56:57], v[48:49]
    v_pk_fma_f32 v[170:171], v[170:171], v[58:59], v[50:51]
    v_pk_fma_f32 v[172:173], v[172:173], v[60:61], v[52:53]
    v_pk_fma_f32 v[174:175], v[174:175], v[62:63], v[54:55]
    v_mfma_f32_32x32x16_bf16 a[96:111], a[80:83], v[80:83], a[96:111]
    ds_read_b128 v[48:51], v23 offset:4544
    ds_read_b128 v[56:59], v23 offset:5056
    ds_read_b128 v[52:55], v23 offset:4560
    ds_read_b128 v[60:63], v23 offset:5072
    v_cvt_pk_bf16_f32 v84, v168, v169
    v_cvt_pk_bf16_f32 v85, v170, v171
    v_cvt_pk_bf16_f32 v86, v172, v173
    v_cvt_pk_bf16_f32 v87, v174, v175
    s_waitcnt lgkmcnt(4)
    v_pk_fma_f32 v[176:177], v[176:177], v[40:41], v[32:33]
    v_pk_fma_f32 v[178:179], v[178:179], v[42:43], v[34:35]
    v_pk_fma_f32 v[180:181], v[180:181], v[44:45], v[36:37]
    v_pk_fma_f32 v[182:183], v[182:183], v[46:47], v[38:39]
    v_mfma_f32_32x32x16_bf16 a[96:111], a[84:87], v[84:87], a[96:111]
    v_cvt_pk_bf16_f32 v88, v176, v177
    v_cvt_pk_bf16_f32 v89, v178, v179
    v_cvt_pk_bf16_f32 v90, v180, v181
    v_cvt_pk_bf16_f32 v91, v182, v183
    s_waitcnt lgkmcnt(0)
    v_pk_fma_f32 v[184:185], v[184:185], v[56:57], v[48:49]
    v_pk_fma_f32 v[186:187], v[186:187], v[58:59], v[50:51]
    v_pk_fma_f32 v[188:189], v[188:189], v[60:61], v[52:53]
    v_pk_fma_f32 v[190:191], v[190:191], v[62:63], v[54:55]
    v_mfma_f32_32x32x16_bf16 a[96:111], a[88:91], v[88:91], a[96:111]
    v_cvt_pk_bf16_f32 v92, v184, v185
    v_cvt_pk_bf16_f32 v93, v186, v187
    v_cvt_pk_bf16_f32 v94, v188, v189
    v_cvt_pk_bf16_f32 v95, v190, v191
    s_nop 1
    v_mfma_f32_32x32x16_bf16 a[96:111], a[92:95], v[92:95], a[96:111]
    s_nop 11
    ds_write_b128 v16, a[96:99] offset:0
    ds_write_b128 v16, a[100:103] offset:1024
    s_branch adaLN_cond__grouped_kv_mqa__dense_activation_silu__prompt_kernel_hj28
adaLN_cond__grouped_kv_mqa__dense_activation_silu__prompt_kernel_hv26:
    ds_read_b128 v[32:35], v23 offset:4096
    ds_read_b128 v[40:43], v23 offset:4608
    ds_read_b128 v[36:39], v23 offset:4112
    ds_read_b128 v[44:47], v23 offset:4624
    ds_read_b128 v[48:51], v23 offset:4160
    ds_read_b128 v[56:59], v23 offset:4672
    ds_read_b128 v[52:55], v23 offset:4176
    ds_read_b128 v[60:63], v23 offset:4688
    s_waitcnt lgkmcnt(4)
    v_pk_fma_f32 v[128:129], v[128:129], v[40:41], v[32:33]
    v_pk_fma_f32 v[130:131], v[130:131], v[42:43], v[34:35]
    v_pk_fma_f32 v[132:133], v[132:133], v[44:45], v[36:37]
    v_pk_fma_f32 v[134:135], v[134:135], v[46:47], v[38:39]
    ds_read_b128 v[32:35], v23 offset:4224
    ds_read_b128 v[40:43], v23 offset:4736
    ds_read_b128 v[36:39], v23 offset:4240
    ds_read_b128 v[44:47], v23 offset:4752
    v_cvt_pk_bf16_f32 v64, v128, v129
    v_cvt_pk_bf16_f32 v65, v130, v131
    v_cvt_pk_bf16_f32 v66, v132, v133
    v_cvt_pk_bf16_f32 v67, v134, v135
    s_waitcnt lgkmcnt(4)
    v_pk_fma_f32 v[136:137], v[136:137], v[56:57], v[48:49]
    v_pk_fma_f32 v[138:139], v[138:139], v[58:59], v[50:51]
    v_pk_fma_f32 v[140:141], v[140:141], v[60:61], v[52:53]
    v_pk_fma_f32 v[142:143], v[142:143], v[62:63], v[54:55]
    v_mfma_f32_32x32x16_bf16 a[96:111], v[64:67], a[64:67], 0
    ds_read_b128 v[48:51], v23 offset:4288
    ds_read_b128 v[56:59], v23 offset:4800
    ds_read_b128 v[52:55], v23 offset:4304
    ds_read_b128 v[60:63], v23 offset:4816
    v_cvt_pk_bf16_f32 v68, v136, v137
    v_cvt_pk_bf16_f32 v69, v138, v139
    v_cvt_pk_bf16_f32 v70, v140, v141
    v_cvt_pk_bf16_f32 v71, v142, v143
    s_waitcnt lgkmcnt(4)
    v_pk_fma_f32 v[144:145], v[144:145], v[40:41], v[32:33]
    v_pk_fma_f32 v[146:147], v[146:147], v[42:43], v[34:35]
    v_pk_fma_f32 v[148:149], v[148:149], v[44:45], v[36:37]
    v_pk_fma_f32 v[150:151], v[150:151], v[46:47], v[38:39]
    v_mfma_f32_32x32x16_bf16 a[96:111], v[68:71], a[68:71], a[96:111]
    ds_read_b128 v[32:35], v23 offset:4352
    ds_read_b128 v[40:43], v23 offset:4864
    ds_read_b128 v[36:39], v23 offset:4368
    ds_read_b128 v[44:47], v23 offset:4880
    v_cvt_pk_bf16_f32 v72, v144, v145
    v_cvt_pk_bf16_f32 v73, v146, v147
    v_cvt_pk_bf16_f32 v74, v148, v149
    v_cvt_pk_bf16_f32 v75, v150, v151
    s_waitcnt lgkmcnt(4)
    v_pk_fma_f32 v[152:153], v[152:153], v[56:57], v[48:49]
    v_pk_fma_f32 v[154:155], v[154:155], v[58:59], v[50:51]
    v_pk_fma_f32 v[156:157], v[156:157], v[60:61], v[52:53]
    v_pk_fma_f32 v[158:159], v[158:159], v[62:63], v[54:55]
    v_mfma_f32_32x32x16_bf16 a[96:111], v[72:75], a[72:75], a[96:111]
    ds_read_b128 v[48:51], v23 offset:4416
    ds_read_b128 v[56:59], v23 offset:4928
    ds_read_b128 v[52:55], v23 offset:4432
    ds_read_b128 v[60:63], v23 offset:4944
    v_cvt_pk_bf16_f32 v76, v152, v153
    v_cvt_pk_bf16_f32 v77, v154, v155
    v_cvt_pk_bf16_f32 v78, v156, v157
    v_cvt_pk_bf16_f32 v79, v158, v159
    s_waitcnt lgkmcnt(4)
    v_pk_fma_f32 v[160:161], v[160:161], v[40:41], v[32:33]
    v_pk_fma_f32 v[162:163], v[162:163], v[42:43], v[34:35]
    v_pk_fma_f32 v[164:165], v[164:165], v[44:45], v[36:37]
    v_pk_fma_f32 v[166:167], v[166:167], v[46:47], v[38:39]
    v_mfma_f32_32x32x16_bf16 a[96:111], v[76:79], a[76:79], a[96:111]
    ds_read_b128 v[32:35], v23 offset:4480
    ds_read_b128 v[40:43], v23 offset:4992
    ds_read_b128 v[36:39], v23 offset:4496
    ds_read_b128 v[44:47], v23 offset:5008
    v_cvt_pk_bf16_f32 v80, v160, v161
    v_cvt_pk_bf16_f32 v81, v162, v163
    v_cvt_pk_bf16_f32 v82, v164, v165
    v_cvt_pk_bf16_f32 v83, v166, v167
    s_waitcnt lgkmcnt(4)
    v_pk_fma_f32 v[168:169], v[168:169], v[56:57], v[48:49]
    v_pk_fma_f32 v[170:171], v[170:171], v[58:59], v[50:51]
    v_pk_fma_f32 v[172:173], v[172:173], v[60:61], v[52:53]
    v_pk_fma_f32 v[174:175], v[174:175], v[62:63], v[54:55]
    v_mfma_f32_32x32x16_bf16 a[96:111], v[80:83], a[80:83], a[96:111]
    ds_read_b128 v[48:51], v23 offset:4544
    ds_read_b128 v[56:59], v23 offset:5056
    ds_read_b128 v[52:55], v23 offset:4560
    ds_read_b128 v[60:63], v23 offset:5072
    v_cvt_pk_bf16_f32 v84, v168, v169
    v_cvt_pk_bf16_f32 v85, v170, v171
    v_cvt_pk_bf16_f32 v86, v172, v173
    v_cvt_pk_bf16_f32 v87, v174, v175
    s_waitcnt lgkmcnt(4)
    v_pk_fma_f32 v[176:177], v[176:177], v[40:41], v[32:33]
    v_pk_fma_f32 v[178:179], v[178:179], v[42:43], v[34:35]
    v_pk_fma_f32 v[180:181], v[180:181], v[44:45], v[36:37]
    v_pk_fma_f32 v[182:183], v[182:183], v[46:47], v[38:39]
    v_mfma_f32_32x32x16_bf16 a[96:111], v[84:87], a[84:87], a[96:111]
    v_cvt_pk_bf16_f32 v88, v176, v177
    v_cvt_pk_bf16_f32 v89, v178, v179
    v_cvt_pk_bf16_f32 v90, v180, v181
    v_cvt_pk_bf16_f32 v91, v182, v183
    s_waitcnt lgkmcnt(0)
    v_pk_fma_f32 v[184:185], v[184:185], v[56:57], v[48:49]
    v_pk_fma_f32 v[186:187], v[186:187], v[58:59], v[50:51]
    v_pk_fma_f32 v[188:189], v[188:189], v[60:61], v[52:53]
    v_pk_fma_f32 v[190:191], v[190:191], v[62:63], v[54:55]
    v_mfma_f32_32x32x16_bf16 a[96:111], v[88:91], a[88:91], a[96:111]
    v_cvt_pk_bf16_f32 v92, v184, v185
    v_cvt_pk_bf16_f32 v93, v186, v187
    v_cvt_pk_bf16_f32 v94, v188, v189
    v_cvt_pk_bf16_f32 v95, v190, v191
    s_nop 1
    v_mfma_f32_32x32x16_bf16 a[96:111], v[92:95], a[92:95], a[96:111]
    s_nop 11
    ds_write_b128 v16, a[96:99] offset:0
    ds_write_b128 v16, a[100:103] offset:1024
    ds_write_b128 v16, a[104:107] offset:2048
    ds_write_b128 v16, a[108:111] offset:3072
    s_branch adaLN_cond__grouped_kv_mqa__dense_activation_silu__prompt_kernel_hj28
adaLN_cond__grouped_kv_mqa__dense_activation_silu__prompt_kernel_hn27:
    ds_read_b128 v[32:35], v23 offset:4096
    ds_read_b128 v[40:43], v23 offset:4608
    ds_read_b128 v[36:39], v23 offset:4112
    ds_read_b128 v[44:47], v23 offset:4624
    ds_read_b128 v[48:51], v23 offset:4160
    ds_read_b128 v[56:59], v23 offset:4672
    ds_read_b128 v[52:55], v23 offset:4176
    ds_read_b128 v[60:63], v23 offset:4688
    s_waitcnt lgkmcnt(4)
    v_pk_fma_f32 v[128:129], v[128:129], v[40:41], v[32:33]
    v_pk_fma_f32 v[130:131], v[130:131], v[42:43], v[34:35]
    v_pk_fma_f32 v[132:133], v[132:133], v[44:45], v[36:37]
    v_pk_fma_f32 v[134:135], v[134:135], v[46:47], v[38:39]
    ds_read_b128 v[32:35], v23 offset:4224
    ds_read_b128 v[40:43], v23 offset:4736
    ds_read_b128 v[36:39], v23 offset:4240
    ds_read_b128 v[44:47], v23 offset:4752
    v_cvt_pk_bf16_f32 v64, v128, v129
    v_cvt_pk_bf16_f32 v65, v130, v131
    v_cvt_pk_bf16_f32 v66, v132, v133
    v_cvt_pk_bf16_f32 v67, v134, v135
    s_waitcnt lgkmcnt(4)
    v_pk_fma_f32 v[136:137], v[136:137], v[56:57], v[48:49]
    v_pk_fma_f32 v[138:139], v[138:139], v[58:59], v[50:51]
    v_pk_fma_f32 v[140:141], v[140:141], v[60:61], v[52:53]
    v_pk_fma_f32 v[142:143], v[142:143], v[62:63], v[54:55]
    ds_read_b128 v[48:51], v23 offset:4288
    ds_read_b128 v[56:59], v23 offset:4800
    ds_read_b128 v[52:55], v23 offset:4304
    ds_read_b128 v[60:63], v23 offset:4816
    v_cvt_pk_bf16_f32 v68, v136, v137
    v_cvt_pk_bf16_f32 v69, v138, v139
    v_cvt_pk_bf16_f32 v70, v140, v141
    v_cvt_pk_bf16_f32 v71, v142, v143
    s_waitcnt lgkmcnt(4)
    v_pk_fma_f32 v[144:145], v[144:145], v[40:41], v[32:33]
    v_pk_fma_f32 v[146:147], v[146:147], v[42:43], v[34:35]
    v_pk_fma_f32 v[148:149], v[148:149], v[44:45], v[36:37]
    v_pk_fma_f32 v[150:151], v[150:151], v[46:47], v[38:39]
    ds_read_b128 v[32:35], v23 offset:4352
    ds_read_b128 v[40:43], v23 offset:4864
    ds_read_b128 v[36:39], v23 offset:4368
    ds_read_b128 v[44:47], v23 offset:4880
    v_cvt_pk_bf16_f32 v72, v144, v145
    v_cvt_pk_bf16_f32 v73, v146, v147
    v_cvt_pk_bf16_f32 v74, v148, v149
    v_cvt_pk_bf16_f32 v75, v150, v151
    s_waitcnt lgkmcnt(4)
    v_pk_fma_f32 v[152:153], v[152:153], v[56:57], v[48:49]
    v_pk_fma_f32 v[154:155], v[154:155], v[58:59], v[50:51]
    v_pk_fma_f32 v[156:157], v[156:157], v[60:61], v[52:53]
    v_pk_fma_f32 v[158:159], v[158:159], v[62:63], v[54:55]
    ds_read_b128 v[48:51], v23 offset:4416
    ds_read_b128 v[56:59], v23 offset:4928
    ds_read_b128 v[52:55], v23 offset:4432
    ds_read_b128 v[60:63], v23 offset:4944
    v_cvt_pk_bf16_f32 v76, v152, v153
    v_cvt_pk_bf16_f32 v77, v154, v155
    v_cvt_pk_bf16_f32 v78, v156, v157
    v_cvt_pk_bf16_f32 v79, v158, v159
    s_waitcnt lgkmcnt(4)
    v_pk_fma_f32 v[160:161], v[160:161], v[40:41], v[32:33]
    v_pk_fma_f32 v[162:163], v[162:163], v[42:43], v[34:35]
    v_pk_fma_f32 v[164:165], v[164:165], v[44:45], v[36:37]
    v_pk_fma_f32 v[166:167], v[166:167], v[46:47], v[38:39]
    ds_read_b128 v[32:35], v23 offset:4480
    ds_read_b128 v[40:43], v23 offset:4992
    ds_read_b128 v[36:39], v23 offset:4496
    ds_read_b128 v[44:47], v23 offset:5008
    v_cvt_pk_bf16_f32 v80, v160, v161
    v_cvt_pk_bf16_f32 v81, v162, v163
    v_cvt_pk_bf16_f32 v82, v164, v165
    v_cvt_pk_bf16_f32 v83, v166, v167
    s_waitcnt lgkmcnt(4)
    v_pk_fma_f32 v[168:169], v[168:169], v[56:57], v[48:49]
    v_pk_fma_f32 v[170:171], v[170:171], v[58:59], v[50:51]
    v_pk_fma_f32 v[172:173], v[172:173], v[60:61], v[52:53]
    v_pk_fma_f32 v[174:175], v[174:175], v[62:63], v[54:55]
    ds_read_b128 v[48:51], v23 offset:4544
    ds_read_b128 v[56:59], v23 offset:5056
    ds_read_b128 v[52:55], v23 offset:4560
    ds_read_b128 v[60:63], v23 offset:5072
    v_cvt_pk_bf16_f32 v84, v168, v169
    v_cvt_pk_bf16_f32 v85, v170, v171
    v_cvt_pk_bf16_f32 v86, v172, v173
    v_cvt_pk_bf16_f32 v87, v174, v175
    s_waitcnt lgkmcnt(4)
    v_pk_fma_f32 v[176:177], v[176:177], v[40:41], v[32:33]
    v_pk_fma_f32 v[178:179], v[178:179], v[42:43], v[34:35]
    v_pk_fma_f32 v[180:181], v[180:181], v[44:45], v[36:37]
    v_pk_fma_f32 v[182:183], v[182:183], v[46:47], v[38:39]
    v_cvt_pk_bf16_f32 v88, v176, v177
    v_cvt_pk_bf16_f32 v89, v178, v179
    v_cvt_pk_bf16_f32 v90, v180, v181
    v_cvt_pk_bf16_f32 v91, v182, v183
    s_waitcnt lgkmcnt(0)
    v_pk_fma_f32 v[184:185], v[184:185], v[56:57], v[48:49]
    v_pk_fma_f32 v[186:187], v[186:187], v[58:59], v[50:51]
    v_pk_fma_f32 v[188:189], v[188:189], v[60:61], v[52:53]
    v_pk_fma_f32 v[190:191], v[190:191], v[62:63], v[54:55]
    v_cvt_pk_bf16_f32 v92, v184, v185
    v_cvt_pk_bf16_f32 v93, v186, v187
    v_cvt_pk_bf16_f32 v94, v188, v189
    v_cvt_pk_bf16_f32 v95, v190, v191
adaLN_cond__grouped_kv_mqa__dense_activation_silu__prompt_kernel_hj28:
    s_waitcnt lgkmcnt(0)
    s_barrier
    s_cmp_lg_u32 s44, 0
    s_cbranch_scc1 adaLN_cond__grouped_kv_mqa__dense_activation_silu__prompt_kernel_nofin29
    s_cmp_lt_u32 s45, 2
    s_cbranch_scc1 adaLN_cond__grouped_kv_mqa__dense_activation_silu__prompt_kernel_nofin29
    s_cmp_ge_u32 s45, 6
    s_cbranch_scc1 adaLN_cond__grouped_kv_mqa__dense_activation_silu__prompt_kernel_rfin31
    s_cmp_ge_u32 s45, 4
    s_cselect_b32 s54, 2048, 0
    v_bfe_u32 v160, v1, 4, 1
    v_sub_u32 v160, 1, v160
    v_mad_u32_u24 v160, v160, s54, v2
    v_add_u32 v161, 67584, v160
    ds_read_b128 v[128:131], v160 offset:0
    ds_read_b128 v[132:135], v160 offset:1024
    ds_read_b128 v[136:139], v160 offset:33792
    ds_read_b128 v[140:143], v160 offset:34816
    ds_read_b128 v[144:147], v161 offset:0
    ds_read_b128 v[148:151], v161 offset:1024
    ds_read_b128 v[152:155], v161 offset:33792
    ds_read_b128 v[156:159], v161 offset:34816
    s_lshr_b32 s54, s54, 1
    s_lshl1_add_u32 s55, s46, s47
    s_lshl_b32 s55, s55, 11
    s_add_u32 s54, s54, s55
    s_add_u32 s54, s54, 65536
    v_add_u32 v162, s54, v2
    s_waitcnt lgkmcnt(4)
    v_pk_add_f32 v[128:129], v[128:129], v[136:137]
    v_pk_add_f32 v[130:131], v[130:131], v[138:139]
    v_pk_add_f32 v[132:133], v[132:133], v[140:141]
    v_pk_add_f32 v[134:135], v[134:135], v[142:143]
    s_waitcnt lgkmcnt(0)
    v_pk_add_f32 v[144:145], v[144:145], v[152:153]
    v_pk_add_f32 v[146:147], v[146:147], v[154:155]
    v_pk_add_f32 v[148:149], v[148:149], v[156:157]
    v_pk_add_f32 v[150:151], v[150:151], v[158:159]
    v_pk_add_f32 v[128:129], v[128:129], v[144:145]
    v_pk_add_f32 v[130:131], v[130:131], v[146:147]
    v_pk_add_f32 v[132:133], v[132:133], v[148:149]
    v_pk_add_f32 v[134:135], v[134:135], v[150:151]
    v_cvt_pk_bf16_f32 v136, v128, v129
    v_cvt_pk_bf16_f32 v137, v130, v131
    v_cvt_pk_bf16_f32 v138, v132, v133
    v_cvt_pk_bf16_f32 v139, v134, v135
    global_store_dwordx4 v162, v[136:139], s[28:29] sc1
    s_waitcnt vmcnt(5)
    s_branch adaLN_cond__grouped_kv_mqa__dense_activation_silu__prompt_kernel_nofin30
adaLN_cond__grouped_kv_mqa__dense_activation_silu__prompt_kernel_rfin31:
    ds_read_b128 v[96:99], v102 offset:6144
    s_waitcnt lgkmcnt(0)
    v_permlane32_swap_b32 v96, v98
    v_permlane32_swap_b32 v97, v99
    v_add_f32 v96, v96, v98
    v_add_f32 v97, v97, v99
    s_nop 1
    v_permlane16_swap_b32 v96, v97
    v_add_f32 v96, v96, v97
    global_store_dword v100, v96, s[28:29] sc1
    s_waitcnt vmcnt(5)
    s_branch adaLN_cond__grouped_kv_mqa__dense_activation_silu__prompt_kernel_nofin30
adaLN_cond__grouped_kv_mqa__dense_activation_silu__prompt_kernel_nofin29:
    s_waitcnt vmcnt(4)
adaLN_cond__grouped_kv_mqa__dense_activation_silu__prompt_kernel_nofin30:
    ds_read_b64_tr_b16 a[0:1], v18 offset:0
    ds_read_b64_tr_b16 a[2:3], v18 offset:512
    ds_read_b64_tr_b16 a[32:33], v19 offset:0
    ds_read_b64_tr_b16 a[34:35], v19 offset:512
    ds_read_b64_tr_b16 a[4:5], v18 offset:2048
    ds_read_b64_tr_b16 a[6:7], v18 offset:2560
    ds_read_b64_tr_b16 a[36:37], v19 offset:2048
    ds_read_b64_tr_b16 a[38:39], v19 offset:2560
    ds_read_b128 v[32:35], v23 offset:4096
    ds_read_b128 v[40:43], v23 offset:4608
    ds_read_b128 v[36:39], v23 offset:4112
    ds_read_b128 v[44:47], v23 offset:4624
    ds_read_b128 v[48:51], v23 offset:4160
    ds_read_b128 v[56:59], v23 offset:4672
    ds_read_b128 v[52:55], v23 offset:4176
    ds_read_b128 v[60:63], v23 offset:4688
    ds_read_b64_tr_b16 a[8:9], v18 offset:4096
    ds_read_b64_tr_b16 a[10:11], v18 offset:4608
    s_waitcnt lgkmcnt(14)
    v_mfma_f32_32x32x16_bf16 v[128:143], a[0:3], v[64:67], 0
    s_waitcnt lgkmcnt(6)
    v_fma_f32 v192, v192, v40, v32
    v_fma_f32 v193, v193, v41, v33
    v_fma_f32 v194, v194, v42, v34
    v_fma_f32 v195, v195, v43, v35
    v_fma_f32 v196, v196, v44, v36
    v_fma_f32 v197, v197, v45, v37
    ds_read_b64_tr_b16 a[40:41], v19 offset:4096
    ds_read_b64_tr_b16 a[42:43], v19 offset:4608
    v_mfma_f32_32x32x16_bf16 v[144:159], a[32:35], v[64:67], 0
    v_fma_f32 v198, v198, v46, v38
    v_fma_f32 v199, v199, v47, v39
    ds_read_b128 v[32:35], v23 offset:4224
    ds_read_b128 v[40:43], v23 offset:4736
    ds_read_b128 v[36:39], v23 offset:4240
    ds_read_b64_tr_b16 a[12:13], v18 offset:6144
    ds_read_b64_tr_b16 a[14:15], v18 offset:6656
    v_mfma_f32_32x32x16_bf16 v[128:143], a[4:7], v[68:71], v[128:143]
    ds_read_b128 v[44:47], v23 offset:4752
    v_cvt_pk_bf16_f32 v96, v192, v193
    v_cvt_pk_bf16_f32 v97, v194, v195
    v_cvt_pk_bf16_f32 v98, v196, v197
    v_cvt_pk_bf16_f32 v99, v198, v199
    s_waitcnt lgkmcnt(10)
    ds_read_b64_tr_b16 a[44:45], v19 offset:6144
    ds_read_b64_tr_b16 a[46:47], v19 offset:6656
    v_mfma_f32_32x32x16_bf16 v[144:159], a[36:39], v[68:71], v[144:159]
    v_fma_f32 v200, v200, v56, v48
    v_fma_f32 v201, v201, v57, v49
    v_fma_f32 v202, v202, v58, v50
    v_fma_f32 v203, v203, v59, v51
    v_fma_f32 v204, v204, v60, v52
    v_fma_f32 v205, v205, v61, v53
    v_fma_f32 v206, v206, v62, v54
    v_fma_f32 v207, v207, v63, v55
    ds_read_b64_tr_b16 a[16:17], v18 offset:8192
    ds_read_b64_tr_b16 a[18:19], v18 offset:8704
    s_waitcnt lgkmcnt(10)
    v_mfma_f32_32x32x16_bf16 v[128:143], a[8:11], v[72:75], v[128:143]
    ds_read_b128 v[48:51], v23 offset:4288
    ds_read_b128 v[56:59], v23 offset:4800
    ds_read_b128 v[52:55], v23 offset:4304
    ds_read_b64_tr_b16 a[48:49], v19 offset:8192
    ds_read_b64_tr_b16 a[50:51], v19 offset:8704
    v_mfma_f32_32x32x16_bf16 v[144:159], a[40:43], v[72:75], v[144:159]
    ds_read_b128 v[60:63], v23 offset:4816
    v_cvt_pk_bf16_f32 v100, v200, v201
    v_cvt_pk_bf16_f32 v101, v202, v203
    v_cvt_pk_bf16_f32 v102, v204, v205
    v_cvt_pk_bf16_f32 v103, v206, v207
    s_waitcnt lgkmcnt(10)
    v_fma_f32 v208, v208, v40, v32
    ds_read_b64_tr_b16 a[20:21], v18 offset:10240
    ds_read_b64_tr_b16 a[22:23], v18 offset:10752
    s_waitcnt lgkmcnt(10)
    v_mfma_f32_32x32x16_bf16 v[128:143], a[12:15], v[76:79], v[128:143]
    v_fma_f32 v209, v209, v41, v33
    v_fma_f32 v210, v210, v42, v34
    v_fma_f32 v211, v211, v43, v35
    v_fma_f32 v212, v212, v44, v36
    v_fma_f32 v213, v213, v45, v37
    v_fma_f32 v214, v214, v46, v38
    v_fma_f32 v215, v215, v47, v39
    ds_read_b64_tr_b16 a[52:53], v19 offset:10240
    ds_read_b64_tr_b16 a[54:55], v19 offset:10752
    v_mfma_f32_32x32x16_bf16 v[144:159], a[44:47], v[76:79], v[144:159]
    ds_read_b128 v[32:35], v23 offset:4352
    ds_read_b128 v[40:43], v23 offset:4864
    ds_read_b128 v[36:39], v23 offset:4368
    ds_read_b128 v[44:47], v23 offset:4880
    ds_read_b64_tr_b16 a[24:25], v18 offset:12288
    ds_read_b64_tr_b16 a[26:27], v18 offset:12800
    s_waitcnt lgkmcnt(11)
    v_mfma_f32_32x32x16_bf16 v[128:143], a[16:19], v[80:83], v[128:143]
    v_cvt_pk_bf16_f32 v104, v208, v209
    v_cvt_pk_bf16_f32 v105, v210, v211
    v_cvt_pk_bf16_f32 v106, v212, v213
    v_cvt_pk_bf16_f32 v107, v214, v215
    s_waitcnt lgkmcnt(10)
    v_fma_f32 v216, v216, v56, v48
    v_fma_f32 v217, v217, v57, v49
    ds_read_b64_tr_b16 a[56:57], v19 offset:12288
    ds_read_b64_tr_b16 a[58:59], v19 offset:12800
    v_mfma_f32_32x32x16_bf16 v[144:159], a[48:51], v[80:83], v[144:159]
    v_fma_f32 v218, v218, v58, v50
    v_fma_f32 v219, v219, v59, v51
    v_fma_f32 v220, v220, v60, v52
    v_fma_f32 v221, v221, v61, v53
    v_fma_f32 v222, v222, v62, v54
    v_fma_f32 v223, v223, v63, v55
    ds_read_b128 v[48:51], v23 offset:4416
    ds_read_b64_tr_b16 a[28:29], v18 offset:14336
    ds_read_b64_tr_b16 a[30:31], v18 offset:14848
    s_waitcnt lgkmcnt(11)
    v_mfma_f32_32x32x16_bf16 v[128:143], a[20:23], v[84:87], v[128:143]
    ds_read_b128 v[56:59], v23 offset:4928
    ds_read_b128 v[52:55], v23 offset:4432
    ds_read_b128 v[60:63], v23 offset:4944
    v_cvt_pk_bf16_f32 v108, v216, v217
    ds_read_b64_tr_b16 a[60:61], v19 offset:14336
    ds_read_b64_tr_b16 a[62:63], v19 offset:14848
    v_mfma_f32_32x32x16_bf16 v[144:159], a[52:55], v[84:87], v[144:159]
    v_cvt_pk_bf16_f32 v109, v218, v219
    v_cvt_pk_bf16_f32 v110, v220, v221
    v_cvt_pk_bf16_f32 v111, v222, v223
    s_waitcnt lgkmcnt(12)
    v_fma_f32 v224, v224, v40, v32
    v_fma_f32 v225, v225, v41, v33
    v_fma_f32 v226, v226, v42, v34
    v_fma_f32 v227, v227, v43, v35
    s_waitcnt lgkmcnt(8)
    v_mfma_f32_32x32x16_bf16 v[128:143], a[24:27], v[88:91], v[128:143]
    v_fma_f32 v228, v228, v44, v36
    v_fma_f32 v229, v229, v45, v37
    v_fma_f32 v230, v230, v46, v38
    v_fma_f32 v231, v231, v47, v39
    ds_read_b128 v[32:35], v23 offset:4480
    ds_read_b128 v[40:43], v23 offset:4992
    ds_read_b128 v[36:39], v23 offset:4496
    v_mfma_f32_32x32x16_bf16 v[144:159], a[56:59], v[88:91], v[144:159]
    ds_read_b128 v[44:47], v23 offset:5008
    v_cvt_pk_bf16_f32 v112, v224, v225
    v_cvt_pk_bf16_f32 v113, v226, v227
    v_cvt_pk_bf16_f32 v114, v228, v229
    v_cvt_pk_bf16_f32 v115, v230, v231
    s_waitcnt lgkmcnt(6)
    v_fma_f32 v232, v232, v56, v48
    v_fma_f32 v233, v233, v57, v49
    v_fma_f32 v234, v234, v58, v50
    v_fma_f32 v235, v235, v59, v51
    v_fma_f32 v236, v236, v60, v52
    s_waitcnt lgkmcnt(4)
    v_mfma_f32_32x32x16_bf16 v[128:143], a[28:31], v[92:95], v[128:143]
    v_fma_f32 v237, v237, v61, v53
    v_fma_f32 v238, v238, v62, v54
    v_fma_f32 v239, v239, v63, v55
    ds_read_b128 v[48:51], v23 offset:4544
    ds_read_b128 v[56:59], v23 offset:5056
    ds_read_b128 v[52:55], v23 offset:4560
    ds_read_b128 v[60:63], v23 offset:5072
    v_mfma_f32_32x32x16_bf16 v[144:159], a[60:63], v[92:95], v[144:159]
    v_cvt_pk_bf16_f32 v116, v232, v233
    v_cvt_pk_bf16_f32 v117, v234, v235
    v_cvt_pk_bf16_f32 v118, v236, v237
    v_cvt_pk_bf16_f32 v119, v238, v239
    s_waitcnt lgkmcnt(4)
    v_fma_f32 v240, v240, v40, v32
    v_fma_f32 v241, v241, v41, v33
    v_fma_f32 v242, v242, v42, v34
    v_fma_f32 v243, v243, v43, v35
    v_fma_f32 v244, v244, v44, v36
    v_fma_f32 v245, v245, v45, v37
    v_fma_f32 v246, v246, v46, v38
    v_fma_f32 v247, v247, v47, v39
    v_cvt_pk_bf16_f32 v120, v240, v241
    v_cvt_pk_bf16_f32 v121, v242, v243
    v_cvt_pk_bf16_f32 v122, v244, v245
    v_cvt_pk_bf16_f32 v123, v246, v247
    s_waitcnt lgkmcnt(0)
    v_fma_f32 v248, v248, v56, v48
    v_fma_f32 v249, v249, v57, v49
    v_fma_f32 v250, v250, v58, v50
    v_fma_f32 v251, v251, v59, v51
    v_fma_f32 v252, v252, v60, v52
    v_fma_f32 v253, v253, v61, v53
    v_fma_f32 v254, v254, v62, v54
    v_fma_f32 v255, v255, v63, v55
    v_cvt_pk_bf16_f32 v124, v248, v249
    v_cvt_pk_bf16_f32 v125, v250, v251
    v_cvt_pk_bf16_f32 v126, v252, v253
    v_cvt_pk_bf16_f32 v127, v254, v255
    s_xor_b32 s54, s44, 1
    s_mul_i32 s54, s54, 33792
    v_add_u32 v32, s54, v2
    s_xor_b32 s54, s44, 2
    s_mul_i32 s54, s54, 33792
    v_add_u32 v33, s54, v2
    s_xor_b32 s54, s44, 3
    s_mul_i32 s54, s54, 33792
    v_add_u32 v34, s54, v2
    s_movk_i32 s55, 2064
    v_mfma_f32_32x32x16_bf16 v[176:191], a[32:35], v[96:99], 0
    v_add_u32 v4, s48, v2
    v_bfe_u32 v20, v1, 4, 1
    v_cmp_eq_u32 vcc, 1, v20
    s_add_u32 s54, s48, 2048
    v_mov_b32 v21, s54
    v_and_b32 v20, 15, v1
    v_mfma_f32_32x32x16_bf16 v[176:191], a[36:39], v[100:103], v[176:191]
    v_mad_u32_u24 v20, v20, s55, v21
    v_and_b32 v22, 11, v1
    v_cmp_eq_u32 s[58:59], 0, v22
    v_mov_b32 v22, 0x30000
    s_nop 0
    v_cndmask_b32 v21, v22, v21, s[58:59]
    v_add_u32 v22, 1024, v4
    v_mfma_f32_32x32x16_bf16 v[176:191], a[40:43], v[104:107], v[176:191]
    v_cndmask_b32 v5, v21, v22, vcc
    v_add_u32 v22, -256, v22
    v_cndmask_b32 v6, v21, v22, vcc
    v_mov_b32 v24, 0x3f803f80
    v_mov_b32 v25, 0x3f803f80
    v_mov_b32 v26, 0x3f803f80
    v_mfma_f32_32x32x16_bf16 v[176:191], a[44:47], v[108:111], v[176:191]
    v_mov_b32 v27, 0x3f803f80
    s_barrier
    ds_write_b128 v32, v[136:139] offset:20640
    s_add_u32 s6, s50, 32768
    s_addc_u32 s7, s51, 0
    v_mfma_f32_32x32x16_bf16 v[176:191], a[48:51], v[112:115], v[176:191]
    s_add_u32 s8, s50, 65536
    s_addc_u32 s9, s51, 0
    ds_write_b128 v32, v[140:143] offset:21664
    s_add_u32 s10, s50, 98304
    s_addc_u32 s11, s51, 0
    v_mfma_f32_32x32x16_bf16 v[176:191], a[52:55], v[116:119], v[176:191]
    s_add_u32 s12, s50, 131072
    s_addc_u32 s13, s51, 0
    ds_write_b128 v33, v[144:147] offset:22688
    s_add_u32 s18, s50, 262144
    s_addc_u32 s19, s51, 0
    v_mfma_f32_32x32x16_bf16 v[176:191], a[56:59], v[120:123], v[176:191]
    s_add_u32 s20, s50, 380928
    s_addc_u32 s21, s51, 0
    ds_write_b128 v33, v[148:151] offset:23712
    s_add_u32 s14, s4, 0x8000
    s_addc_u32 s15, s5, 0
    v_mfma_f32_32x32x16_bf16 v[176:191], a[60:63], v[124:127], v[176:191]
    s_add_u32 s16, s24, 0x8000
    s_addc_u32 s17, s25, 0
    ds_write_b128 v34, v[152:155] offset:24736
    s_mul_i32 s56, s45, 7
    s_lshl1_add_u32 s56, s44, s56
    v_mfma_f32_32x32x16_bf16 v[160:175], a[0:3], v[96:99], 0
    s_lshr_b32 s57, s45, 1
    s_lshl1_add_u32 s57, s56, s57
    ds_write_b128 v34, v[156:159] offset:25760
    s_lshl_b32 s38, s57, 10
    s_lshl_b32 s56, s56, 15
    v_mfma_f32_32x32x16_bf16 v[160:175], a[4:7], v[100:103], v[160:175]
    s_add_u32 s32, s56, 18878464
    s_cmp_eq_u32 s44, 3
    s_cselect_b32 s22, 0, 2048
    s_lshl_b32 s33, s22, 4
    s_sub_u32 s33, s33, 24576
    s_lshr_b32 s56, s44, 1
    v_mfma_f32_32x32x16_bf16 v[160:175], a[8:11], v[104:107], v[160:175]
    s_lshl1_add_u32 s56, s45, s56
    s_lshl2_add_u32 s57, s56, s44
    s_lshl_b32 s57, s57, 13
    s_add_u32 s34, s57, 17829888
    s_xor_b32 s35, s34, 0x8000
    s_lshl2_add_u32 s57, s56, s44
    ds_write_b128 v33, v[176:179] offset:28832
    v_mfma_f32_32x32x16_bf16 v[160:175], a[12:15], v[108:111], v[160:175]
    s_mul_i32 s57, s57, 28672
    s_add_u32 s36, s57, 20971520
    s_xor_b32 s56, s56, 1
    s_lshl2_add_u32 s57, s56, s44
    ds_write_b128 v33, v[180:183] offset:29856
    v_mfma_f32_32x32x16_bf16 v[160:175], a[16:19], v[112:115], v[160:175]
    s_mul_i32 s57, s57, 28672
    s_add_u32 s37, s57, 20971520
    s_lshl2_add_u32 s56, s45, s44
    s_lshl_b32 s39, s46, 11
    ds_write_b128 v34, v[184:187] offset:30880
    v_mfma_f32_32x32x16_bf16 v[160:175], a[20:23], v[116:119], v[160:175]
    s_add_u32 s39, s39, s56
    s_lshl_b32 s39, s39, 5
    s_lshl_b32 s57, s46, 7
    s_lshl2_add_u32 s57, s56, s57
    ds_write_b128 v34, v[188:191] offset:31904
    v_mfma_f32_32x32x16_bf16 v[160:175], a[24:27], v[120:123], v[160:175]
    s_add_u32 s26, s57, 57344
    s_lshr_b32 s43, s56, 1
    s_lshl_b32 s43, s43, 10
    s_and_b32 s57, s44, 1
    v_mfma_f32_32x32x16_bf16 v[160:175], a[28:31], v[124:127], v[160:175]
    s_lshl3_add_u32 s43, s57, s43
    s_lshl2_add_u32 s56, s46, s44
    s_lshl_b32 s57, s45, 9
    s_lshl2_add_u32 s57, s56, s57
    s_add_u32 s23, s57, 49152
    s_xor_b32 s56, s44, 1
    s_mul_i32 s27, s56, 33792
    s_xor_b32 s56, s44, 2
    s_mul_i32 s30, s56, 33792
    s_xor_b32 s56, s44, 3
    s_mul_i32 s31, s56, 33792
    s_nop 0
    ds_write_b128 v32, v[168:171] offset:26784
    ds_write_b128 v32, v[172:175] offset:27808
    s_waitcnt lgkmcnt(0)
    s_barrier
    s_mov_b32 m0, s48
    ds_read_b128 v[192:195], v4 offset:20640
    ds_read_b128 v[196:199], v4 offset:21664
    ds_read_b128 v[200:203], v4 offset:22688
    ds_read_b128 v[204:207], v4 offset:23712
    ds_read_b128 v[208:211], v4 offset:24736
    ds_read_b128 v[212:215], v4 offset:25760
    ds_read_b128 v[216:219], v4 offset:26784
    ds_read_b128 v[220:223], v4 offset:27808
    ds_read_b128 v[224:227], v4 offset:28832
    ds_read_b128 v[228:231], v4 offset:29856
    ds_read_b128 v[232:235], v4 offset:30880
    ds_read_b128 v[236:239], v4 offset:31904
    global_load_lds_dwordx4 v2, s[52:53] offset:0 sc1
    global_load_lds_dwordx4 v2, s[52:53] offset:1024 sc1
    s_add_u32 m0, s48, 16
    s_mov_b32 s56, 0x3eb8aa3b
    s_lshl_b32 s54, s47, 10
    v_add_u32 v21, s54, v9
    s_xor_b32 s54, s54, 1024
    v_add_u32 v22, s54, v9
    global_load_lds_dwordx4 v2, s[52:53] offset:2048 sc1
    global_load_lds_dwordx4 v2, s[52:53] offset:3072 sc1
    s_lshl2_add_u32 s54, s45, s44
    s_lshl_b32 s54, s54, 10
    v_add_u32 v13, s54, v2
    s_waitcnt lgkmcnt(6)
    v_pk_add_f32 v[128:129], v[128:129], v[192:193]
    v_pk_add_f32 v[200:201], v[200:201], v[208:209]
    v_pk_add_f32 v[130:131], v[130:131], v[194:195]
    v_pk_add_f32 v[202:203], v[202:203], v[210:211]
    v_pk_add_f32 v[132:133], v[132:133], v[196:197]
    v_pk_add_f32 v[204:205], v[204:205], v[212:213]
    v_pk_add_f32 v[134:135], v[134:135], v[198:199]
    v_pk_add_f32 v[206:207], v[206:207], v[214:215]
    v_pk_add_f32 v[128:129], v[128:129], v[200:201]
    v_pk_add_f32 v[130:131], v[130:131], v[202:203]
    v_pk_add_f32 v[132:133], v[132:133], v[204:205]
    v_pk_add_f32 v[134:135], v[134:135], v[206:207]
    v_pk_mul_f32 v[128:129], v[128:129], s[56:57] op_sel_hi:[1,0]
    v_pk_mul_f32 v[130:131], v[130:131], s[56:57] op_sel_hi:[1,0]
    v_pk_mul_f32 v[132:133], v[132:133], s[56:57] op_sel_hi:[1,0]
    v_pk_mul_f32 v[134:135], v[134:135], s[56:57] op_sel_hi:[1,0]
    v_cvt_pk_bf16_f32 v136, v128, v129
    v_cvt_pk_bf16_f32 v137, v130, v131
    v_cvt_pk_bf16_f32 v138, v132, v133
    v_cvt_pk_bf16_f32 v139, v134, v135
    ds_write_b128 v21, v[136:139] offset:4096
    s_waitcnt lgkmcnt(1)
    v_pk_add_f32 v[160:161], v[160:161], v[216:217]
    v_pk_add_f32 v[224:225], v[224:225], v[232:233]
    v_pk_add_f32 v[162:163], v[162:163], v[218:219]
    v_pk_add_f32 v[226:227], v[226:227], v[234:235]
    v_pk_add_f32 v[164:165], v[164:165], v[220:221]
    v_pk_add_f32 v[228:229], v[228:229], v[236:237]
    v_pk_add_f32 v[166:167], v[166:167], v[222:223]
    v_pk_add_f32 v[230:231], v[230:231], v[238:239]
    v_pk_add_f32 v[160:161], v[160:161], v[224:225]
    v_pk_add_f32 v[162:163], v[162:163], v[226:227]
    v_pk_add_f32 v[164:165], v[164:165], v[228:229]
    v_pk_add_f32 v[166:167], v[166:167], v[230:231]
    v_pk_mul_f32 v[160:161], v[160:161], s[56:57] op_sel_hi:[1,0]
    v_pk_mul_f32 v[162:163], v[162:163], s[56:57] op_sel_hi:[1,0]
    v_pk_mul_f32 v[164:165], v[164:165], s[56:57] op_sel_hi:[1,0]
    v_pk_mul_f32 v[166:167], v[166:167], s[56:57] op_sel_hi:[1,0]
    v_cvt_pk_bf16_f32 v168, v160, v161
    v_cvt_pk_bf16_f32 v169, v162, v163
    v_cvt_pk_bf16_f32 v170, v164, v165
    v_cvt_pk_bf16_f32 v171, v166, v167
    ds_write_b128 v22, v[168:171] offset:4096
    ds_write_b128 v20, v[24:27]
    s_waitcnt lgkmcnt(0)
    s_barrier
    ds_read_b128 v[224:227], v9 offset:4096
    ds_read_b128 v[228:231], v10 offset:4096
    ds_read_b128 v[232:235], v11 offset:4096
    ds_read_b128 v[236:239], v12 offset:4096
    ds_read_b128 v[56:59], v9 offset:5120
    ds_read_b128 v[60:63], v10 offset:5120
    ds_read_b128 v[64:67], v11 offset:5120
    ds_read_b128 v[68:71], v12 offset:5120
    s_waitcnt vmcnt(2)
    ds_read_b128 v[136:139], v4 offset:0
    ds_read_b128 v[140:143], v5 offset:0
    ds_read_b128 v[144:147], v6 offset:0
    s_add_u32 m0, s48, 4128
    v_add_u32 v0, 4096, v2
    global_load_lds_dwordx4 v0, s[52:53] offset:0 sc1
    global_load_lds_dwordx4 v0, s[52:53] offset:1024 sc1
    s_add_u32 m0, s48, 4144
    s_nop 0
    global_load_lds_dwordx4 v0, s[52:53] offset:2048 sc1
    global_load_lds_dwordx4 v0, s[52:53] offset:3072 sc1
    s_add_u32 m0, s48, 8256
    v_add_u32 v0, 4096, v0
    global_load_lds_dwordx4 v0, s[52:53] offset:0 sc1
    global_load_lds_dwordx4 v0, s[52:53] offset:1024 sc1
    s_waitcnt lgkmcnt(0)
    v_max3_u32 v240, v136, v140, v144
    v_cmp_eq_u32 vcc, -1, v240
    s_cbranch_vccnz adaLN_cond__grouped_kv_mqa__dense_activation_silu__prompt_kernel_kvs119
adaLN_cond__grouped_kv_mqa__dense_activation_silu__prompt_kernel_kvb121:
    v_mfma_f32_32x32x16_bf16 v[16:31], v[136:139], v[224:227], 0
    s_add_u32 m0, s48, 8272
    s_nop 0
    global_load_lds_dwordx4 v0, s[52:53] offset:2048 sc1
    global_load_lds_dwordx4 v0, s[52:53] offset:3072 sc1
    s_add_u32 m0, s48, 12384
    v_add_u32 v0, 4096, v0
    v_mov_b32 v72, -1
    v_mov_b32 v73, -1
    v_mov_b32 v74, -1
    v_mov_b32 v75, -1
    v_add_u32 v92, s40, v2
    v_add_u32 v93, s41, v92
    v_add_u32 v94, s42, v92
    v_add_u32 v95, s42, v93
    v_add_u32 v96, s38, v2
    v_add_u32 v97, s22, v96
    v_add_u32 v98, s43, v2
    ds_read_b64_tr_b16 v[76:77], v15 offset:0
    ds_read_b64_tr_b16 v[78:79], v15 offset:256
    v_exp_f32 v16, v16
    v_exp_f32 v17, v17
    s_lshr_b32 s3, s46, 3
    s_lshl3_add_u32 s3, s3, s45
    v_exp_f32 v18, v18
    v_exp_f32 v19, v19
    v_mfma_f32_32x32x16_bf16 v[32:47], v[136:139], v[228:231], 0
    ds_read_b64_tr_b16 v[80:81], v15 offset:1024
    ds_read_b64_tr_b16 v[82:83], v15 offset:1280
    v_exp_f32 v20, v20
    v_exp_f32 v21, v21
    v_cvt_pk_bf16_f32 v48, v16, v17
    s_lshl2_add_u32 s3, s3, s44
    s_lshl_b32 s3, s3, 12
    v_exp_f32 v22, v22
    v_exp_f32 v23, v23
    s_waitcnt vmcnt(8)
    v_cvt_pk_bf16_f32 v49, v18, v19
    v_exp_f32 v24, v24
    v_exp_f32 v25, v25
    s_add_u32 s3, s3, 262144
    s_and_b32 s0, s46, 7
    v_cvt_pk_bf16_f32 v50, v20, v21
    v_exp_f32 v26, v26
    v_exp_f32 v27, v27
    s_lshl_b32 s56, s0, 9
    s_add_u32 s56, s56, s3
    v_cvt_pk_bf16_f32 v51, v22, v23
    v_exp_f32 v28, v28
    v_cvt_pk_bf16_f32 v52, v24, v25
    v_lshl_add_u32 v100, v1, 3, s56
    v_exp_f32 v29, v29
    v_cvt_pk_bf16_f32 v53, v26, v27
    v_exp_f32 v30, v30
    v_exp_f32 v31, v31
    v_cvt_pk_bf16_f32 v54, v28, v29
    v_cvt_pk_bf16_f32 v55, v30, v31
    v_mfma_f32_32x32x16_bf16 v[160:175], v[140:143], v[48:51], 0
    ds_read_b128 v[148:151], v4 offset:2064
    v_exp_f32 v32, v32
    v_exp_f32 v33, v33
    v_exp_f32 v34, v34
    v_exp_f32 v35, v35
    v_mfma_f32_32x32x16_bf16 v[16:31], v[136:139], v[232:235], 0
    ds_read_b128 v[152:155], v5 offset:2064
    v_exp_f32 v36, v36
    v_exp_f32 v37, v37
    v_cvt_pk_bf16_f32 v48, v32, v33
    v_exp_f32 v38, v38
    v_exp_f32 v39, v39
    v_mfma_f32_32x32x16_bf16 v[160:175], v[144:147], v[52:55], v[160:175]
    ds_read_b128 v[156:159], v6 offset:2064
    v_cvt_pk_bf16_f32 v49, v34, v35
    v_exp_f32 v40, v40
    v_exp_f32 v41, v41
    global_store_dwordx2 v100, v[72:73], s[28:29] sc1
    v_cvt_pk_bf16_f32 v50, v36, v37
    v_exp_f32 v42, v42
    v_exp_f32 v43, v43
    v_cvt_pk_bf16_f32 v51, v38, v39
    v_exp_f32 v44, v44
    v_cvt_pk_bf16_f32 v52, v40, v41
    v_exp_f32 v45, v45
    v_cvt_pk_bf16_f32 v53, v42, v43
    v_exp_f32 v46, v46
    v_exp_f32 v47, v47
    v_cvt_pk_bf16_f32 v54, v44, v45
    v_cvt_pk_bf16_f32 v55, v46, v47
    v_mfma_f32_32x32x16_bf16 v[176:191], v[140:143], v[48:51], 0
    ds_read_b64_tr_b16 v[84:85], v15 offset:2048
    ds_read_b64_tr_b16 v[86:87], v15 offset:2304
    v_exp_f32 v16, v16
    v_exp_f32 v17, v17
    v_exp_f32 v18, v18
    v_exp_f32 v19, v19
    v_mfma_f32_32x32x16_bf16 v[32:47], v[136:139], v[236:239], 0
    s_waitcnt lgkmcnt(2)
    v_max3_u32 v240, v148, v152, v156
    v_cmp_eq_u32 vcc, -1, v240
    v_exp_f32 v20, v20
    v_exp_f32 v21, v21
    v_cvt_pk_bf16_f32 v48, v16, v17
    v_exp_f32 v22, v22
    v_exp_f32 v23, v23
    v_mfma_f32_32x32x16_bf16 v[176:191], v[144:147], v[52:55], v[176:191]
    s_cbranch_vccnz adaLN_cond__grouped_kv_mqa__dense_activation_silu__prompt_kernel_kvs32
adaLN_cond__grouped_kv_mqa__dense_activation_silu__prompt_kernel_kvb34:
    v_cvt_pk_bf16_f32 v49, v18, v19
    v_exp_f32 v24, v24
    v_exp_f32 v25, v25
    v_cvt_pk_bf16_f32 v50, v20, v21
    v_exp_f32 v26, v26
    v_exp_f32 v27, v27
    v_cvt_pk_bf16_f32 v51, v22, v23
    v_exp_f32 v28, v28
    v_cvt_pk_bf16_f32 v52, v24, v25
    v_exp_f32 v29, v29
    v_cvt_pk_bf16_f32 v53, v26, v27
    v_exp_f32 v30, v30
    v_exp_f32 v31, v31
    v_cvt_pk_bf16_f32 v54, v28, v29
    v_cvt_pk_bf16_f32 v55, v30, v31
    v_mfma_f32_32x32x16_bf16 v[192:207], v[140:143], v[48:51], 0
    ds_read_b64_tr_b16 v[88:89], v15 offset:3072
    ds_read_b64_tr_b16 v[90:91], v15 offset:3328
    v_exp_f32 v32, v32
    v_exp_f32 v33, v33
    v_exp_f32 v34, v34
    v_exp_f32 v35, v35
    v_mfma_f32_32x32x16_bf16 v[16:31], v[148:151], v[224:227], 0
    global_store_dwordx4 v92, v[76:79], s[28:29] sc1
    v_exp_f32 v36, v36
    v_exp_f32 v37, v37
    v_cvt_pk_bf16_f32 v48, v32, v33
    v_exp_f32 v38, v38
    v_exp_f32 v39, v39
    v_mfma_f32_32x32x16_bf16 v[192:207], v[144:147], v[52:55], v[192:207]
    global_store_dwordx4 v93, v[80:83], s[28:29] sc1
    v_cvt_pk_bf16_f32 v49, v34, v35
    v_exp_f32 v40, v40
    v_exp_f32 v41, v41
    v_cvt_pk_bf16_f32 v50, v36, v37
    v_exp_f32 v42, v42
    v_exp_f32 v43, v43
    v_cvt_pk_bf16_f32 v51, v38, v39
    v_exp_f32 v44, v44
    v_cvt_pk_bf16_f32 v52, v40, v41
    v_exp_f32 v45, v45
    v_cvt_pk_bf16_f32 v53, v42, v43
    v_exp_f32 v46, v46
    v_exp_f32 v47, v47
    v_cvt_pk_bf16_f32 v54, v44, v45
    v_cvt_pk_bf16_f32 v55, v46, v47
    v_mfma_f32_32x32x16_bf16 v[208:223], v[140:143], v[48:51], 0
    s_waitcnt lgkmcnt(2)
    global_store_dwordx4 v94, v[84:87], s[28:29] sc1
    v_exp_f32 v16, v16
    v_exp_f32 v17, v17
    v_exp_f32 v18, v18
    v_exp_f32 v19, v19
    v_mfma_f32_32x32x16_bf16 v[32:47], v[148:151], v[228:231], 0
    s_waitcnt lgkmcnt(0)
    global_store_dwordx4 v95, v[88:91], s[28:29] sc1
    v_exp_f32 v20, v20
    v_exp_f32 v21, v21
    v_cvt_pk_bf16_f32 v48, v16, v17
    v_exp_f32 v22, v22
    v_exp_f32 v23, v23
    v_mfma_f32_32x32x16_bf16 v[208:223], v[144:147], v[52:55], v[208:223]
    s_waitcnt vmcnt(11)
    v_cvt_pk_bf16_f32 v49, v18, v19
    v_exp_f32 v24, v24
    v_exp_f32 v25, v25
    v_cvt_pk_bf16_f32 v50, v20, v21
    v_exp_f32 v26, v26
    v_exp_f32 v27, v27
    v_cvt_pk_bf16_f32 v51, v22, v23
    v_exp_f32 v28, v28
    v_cvt_pk_bf16_f32 v52, v24, v25
    v_exp_f32 v29, v29
    v_cvt_pk_bf16_f32 v53, v26, v27
    v_exp_f32 v30, v30
    s_getreg_b32 s100, hwreg(HW_REG_XCC_ID, 0, 16)
    v_exp_f32 v31, v31
    v_cvt_pk_bf16_f32 v54, v28, v29
    v_cvt_pk_bf16_f32 v55, v30, v31
    v_mfma_f32_32x32x16_bf16 v[160:175], v[152:155], v[48:51], v[160:175]
    ds_read_b128 v[136:139], v4 offset:4128
    v_exp_f32 v32, v32
    v_exp_f32 v33, v33
    v_mov_b32 v99, s23
    v_mov_b32 v15, s26
    v_exp_f32 v34, v34
    v_exp_f32 v35, v35
    v_mfma_f32_32x32x16_bf16 v[16:31], v[148:151], v[232:235], 0
    ds_read_b128 v[140:143], v5 offset:4128
    v_exp_f32 v36, v36
    v_exp_f32 v37, v37
    v_cvt_pk_bf16_f32 v48, v32, v33
    v_mov_b32 v134, s100
    s_and_b32 s56, s26, 0xff80
    v_exp_f32 v38, v38
    v_exp_f32 v39, v39
    v_mfma_f32_32x32x16_bf16 v[160:175], v[156:159], v[52:55], v[160:175]
    ds_read_b128 v[144:147], v6 offset:4128
    v_cvt_pk_bf16_f32 v49, v34, v35
    v_exp_f32 v40, v40
    v_exp_f32 v41, v41
    global_store_dword v15, v134, s[28:29] sc1
    v_cvt_pk_bf16_f32 v50, v36, v37
    v_exp_f32 v42, v42
    v_exp_f32 v43, v43
    v_and_b32 v133, 31, v1
    v_lshl_add_u32 v133, v133, 2, s56
    v_cvt_pk_bf16_f32 v51, v38, v39
    v_exp_f32 v44, v44
    v_cvt_pk_bf16_f32 v52, v40, v41
    v_exp_f32 v45, v45
    v_cvt_pk_bf16_f32 v53, v42, v43
    v_exp_f32 v46, v46
    v_exp_f32 v47, v47
    v_cvt_pk_bf16_f32 v54, v44, v45
    v_cvt_pk_bf16_f32 v55, v46, v47
    v_mfma_f32_32x32x16_bf16 v[176:191], v[152:155], v[48:51], v[176:191]
    global_load_lds_dwordx4 v0, s[52:53] offset:0
    v_exp_f32 v16, v16
    v_exp_f32 v17, v17
    v_exp_f32 v18, v18
    v_exp_f32 v19, v19
    v_mfma_f32_32x32x16_bf16 v[32:47], v[148:151], v[236:239], 0
    s_waitcnt lgkmcnt(0)
    v_max3_u32 v240, v136, v140, v144
    v_cmp_eq_u32 vcc, -1, v240
    v_exp_f32 v20, v20
    v_exp_f32 v21, v21
    v_cvt_pk_bf16_f32 v48, v16, v17
    v_exp_f32 v22, v22
    v_exp_f32 v23, v23
    v_mfma_f32_32x32x16_bf16 v[176:191], v[156:159], v[52:55], v[176:191]
    s_cbranch_vccnz adaLN_cond__grouped_kv_mqa__dense_activation_silu__prompt_kernel_kvs36
adaLN_cond__grouped_kv_mqa__dense_activation_silu__prompt_kernel_kvb38:
    v_cvt_pk_bf16_f32 v49, v18, v19
    v_exp_f32 v24, v24
    v_exp_f32 v25, v25
    v_cvt_pk_bf16_f32 v50, v20, v21
    v_exp_f32 v26, v26
    v_exp_f32 v27, v27
    v_cvt_pk_bf16_f32 v51, v22, v23
    v_exp_f32 v28, v28
    v_cvt_pk_bf16_f32 v52, v24, v25
    v_exp_f32 v29, v29
    v_cvt_pk_bf16_f32 v53, v26, v27
    v_exp_f32 v30, v30
    v_exp_f32 v31, v31
    v_cvt_pk_bf16_f32 v54, v28, v29
    v_cvt_pk_bf16_f32 v55, v30, v31
    v_mfma_f32_32x32x16_bf16 v[192:207], v[152:155], v[48:51], v[192:207]
    global_load_lds_dwordx4 v0, s[52:53] offset:1024
    s_add_u32 m0, s48, 12400
    v_exp_f32 v32, v32
    v_exp_f32 v33, v33
    v_exp_f32 v34, v34
    v_exp_f32 v35, v35
    v_mfma_f32_32x32x16_bf16 v[16:31], v[136:139], v[224:227], 0
    global_load_lds_dwordx4 v0, s[52:53] offset:2048
    v_exp_f32 v36, v36
    v_exp_f32 v37, v37
    v_cvt_pk_bf16_f32 v48, v32, v33
    v_exp_f32 v38, v38
    v_exp_f32 v39, v39
    v_mfma_f32_32x32x16_bf16 v[192:207], v[156:159], v[52:55], v[192:207]
    global_load_lds_dwordx4 v0, s[52:53] offset:3072
    s_add_u32 m0, s48, 16512
    v_add_u32 v0, 4096, v0
    v_cvt_pk_bf16_f32 v49, v34, v35
    v_exp_f32 v40, v40
    v_exp_f32 v41, v41
    v_cvt_pk_bf16_f32 v50, v36, v37
    v_exp_f32 v42, v42
    v_exp_f32 v43, v43
    v_cvt_pk_bf16_f32 v51, v38, v39
    v_exp_f32 v44, v44
    v_cvt_pk_bf16_f32 v52, v40, v41
    v_exp_f32 v45, v45
    v_cvt_pk_bf16_f32 v53, v42, v43
    v_exp_f32 v46, v46
    v_exp_f32 v47, v47
    v_cvt_pk_bf16_f32 v54, v44, v45
    v_cvt_pk_bf16_f32 v55, v46, v47
    v_mfma_f32_32x32x16_bf16 v[208:223], v[152:155], v[48:51], v[208:223]
    global_load_lds_dwordx4 v0, s[52:53] offset:0
    v_exp_f32 v16, v16
    v_exp_f32 v17, v17
    v_exp_f32 v18, v18
    v_exp_f32 v19, v19
    v_mfma_f32_32x32x16_bf16 v[32:47], v[136:139], v[228:231], 0
    global_load_lds_dwordx4 v0, s[52:53] offset:1024
    s_add_u32 m0, s48, 16528
    v_exp_f32 v20, v20
    v_exp_f32 v21, v21
    v_cvt_pk_bf16_f32 v48, v16, v17
    v_exp_f32 v22, v22
    v_exp_f32 v23, v23
    v_mfma_f32_32x32x16_bf16 v[208:223], v[156:159], v[52:55], v[208:223]
    s_waitcnt vmcnt(16)
    v_cvt_pk_bf16_f32 v49, v18, v19
    v_exp_f32 v24, v24
    v_exp_f32 v25, v25
    v_cvt_pk_bf16_f32 v50, v20, v21
    v_exp_f32 v26, v26
    v_exp_f32 v27, v27
    v_cvt_pk_bf16_f32 v51, v22, v23
    v_exp_f32 v28, v28
    v_cvt_pk_bf16_f32 v52, v24, v25
    v_exp_f32 v29, v29
    v_cvt_pk_bf16_f32 v53, v26, v27
    v_exp_f32 v30, v30
    v_exp_f32 v31, v31
    v_cvt_pk_bf16_f32 v54, v28, v29
    v_cvt_pk_bf16_f32 v55, v30, v31
    v_mfma_f32_32x32x16_bf16 v[160:175], v[140:143], v[48:51], v[160:175]
    ds_read_b128 v[148:151], v4 offset:6192
    v_exp_f32 v32, v32
    v_exp_f32 v33, v33
    v_exp_f32 v34, v34
    v_exp_f32 v35, v35
    v_mfma_f32_32x32x16_bf16 v[16:31], v[136:139], v[232:235], 0
    ds_read_b128 v[152:155], v5 offset:6192
    v_exp_f32 v36, v36
    v_exp_f32 v37, v37
    v_cvt_pk_bf16_f32 v48, v32, v33
    v_exp_f32 v38, v38
    v_exp_f32 v39, v39
    v_mfma_f32_32x32x16_bf16 v[160:175], v[144:147], v[52:55], v[160:175]
    ds_read_b128 v[156:159], v6 offset:6192
    v_cvt_pk_bf16_f32 v49, v34, v35
    v_exp_f32 v40, v40
    v_exp_f32 v41, v41
    v_cvt_pk_bf16_f32 v50, v36, v37
    v_exp_f32 v42, v42
    v_exp_f32 v43, v43
    v_cvt_pk_bf16_f32 v51, v38, v39
    v_exp_f32 v44, v44
    v_cvt_pk_bf16_f32 v52, v40, v41
    v_exp_f32 v45, v45
    v_cvt_pk_bf16_f32 v53, v42, v43
    v_exp_f32 v46, v46
    v_exp_f32 v47, v47
    v_cvt_pk_bf16_f32 v54, v44, v45
    v_cvt_pk_bf16_f32 v55, v46, v47
    v_mfma_f32_32x32x16_bf16 v[176:191], v[140:143], v[48:51], v[176:191]
    v_exp_f32 v16, v16
    v_exp_f32 v17, v17
    v_exp_f32 v18, v18
    v_exp_f32 v19, v19
    v_mfma_f32_32x32x16_bf16 v[32:47], v[136:139], v[236:239], 0
    s_waitcnt lgkmcnt(0)
    v_max3_u32 v240, v148, v152, v156
    v_cmp_eq_u32 vcc, -1, v240
    v_exp_f32 v20, v20
    v_exp_f32 v21, v21
    v_cvt_pk_bf16_f32 v48, v16, v17
    v_exp_f32 v22, v22
    v_exp_f32 v23, v23
    v_mfma_f32_32x32x16_bf16 v[176:191], v[144:147], v[52:55], v[176:191]
    s_cbranch_vccnz adaLN_cond__grouped_kv_mqa__dense_activation_silu__prompt_kernel_kvs40
adaLN_cond__grouped_kv_mqa__dense_activation_silu__prompt_kernel_kvb42:
    v_cvt_pk_bf16_f32 v49, v18, v19
    v_exp_f32 v24, v24
    v_exp_f32 v25, v25
    v_cvt_pk_bf16_f32 v50, v20, v21
    v_exp_f32 v26, v26
    v_exp_f32 v27, v27
    v_cvt_pk_bf16_f32 v51, v22, v23
    v_exp_f32 v28, v28
    v_cvt_pk_bf16_f32 v52, v24, v25
    v_exp_f32 v29, v29
    v_cvt_pk_bf16_f32 v53, v26, v27
    v_exp_f32 v30, v30
    v_exp_f32 v31, v31
    v_cvt_pk_bf16_f32 v54, v28, v29
    v_cvt_pk_bf16_f32 v55, v30, v31
    v_mfma_f32_32x32x16_bf16 v[192:207], v[140:143], v[48:51], v[192:207]
    v_exp_f32 v32, v32
    v_exp_f32 v33, v33
    v_exp_f32 v34, v34
    v_exp_f32 v35, v35
    v_mfma_f32_32x32x16_bf16 v[16:31], v[148:151], v[224:227], 0
    v_exp_f32 v36, v36
    v_exp_f32 v37, v37
    v_cvt_pk_bf16_f32 v48, v32, v33
    v_exp_f32 v38, v38
    v_exp_f32 v39, v39
    v_mfma_f32_32x32x16_bf16 v[192:207], v[144:147], v[52:55], v[192:207]
    v_cvt_pk_bf16_f32 v49, v34, v35
    v_exp_f32 v40, v40
    v_exp_f32 v41, v41
    v_cvt_pk_bf16_f32 v50, v36, v37
    v_exp_f32 v42, v42
    v_exp_f32 v43, v43
    v_cvt_pk_bf16_f32 v51, v38, v39
    v_exp_f32 v44, v44
    v_cvt_pk_bf16_f32 v52, v40, v41
    v_exp_f32 v45, v45
    v_cvt_pk_bf16_f32 v53, v42, v43
    v_exp_f32 v46, v46
    v_exp_f32 v47, v47
    v_cvt_pk_bf16_f32 v54, v44, v45
    v_cvt_pk_bf16_f32 v55, v46, v47
    v_mfma_f32_32x32x16_bf16 v[208:223], v[140:143], v[48:51], v[208:223]
    v_exp_f32 v16, v16
    v_exp_f32 v17, v17
    v_exp_f32 v18, v18
    v_exp_f32 v19, v19
    v_mfma_f32_32x32x16_bf16 v[32:47], v[148:151], v[228:231], 0
    v_exp_f32 v20, v20
    v_exp_f32 v21, v21
    v_cvt_pk_bf16_f32 v48, v16, v17
    v_exp_f32 v22, v22
    v_exp_f32 v23, v23
    v_mfma_f32_32x32x16_bf16 v[208:223], v[144:147], v[52:55], v[208:223]
    s_waitcnt vmcnt(14)
    v_cvt_pk_bf16_f32 v49, v18, v19
    v_exp_f32 v24, v24
    v_exp_f32 v25, v25
    v_cvt_pk_bf16_f32 v50, v20, v21
    v_exp_f32 v26, v26
    v_exp_f32 v27, v27
    v_cvt_pk_bf16_f32 v51, v22, v23
    v_exp_f32 v28, v28
    v_cvt_pk_bf16_f32 v52, v24, v25
    v_exp_f32 v29, v29
    v_cvt_pk_bf16_f32 v53, v26, v27
    v_exp_f32 v30, v30
    v_exp_f32 v31, v31
    v_cvt_pk_bf16_f32 v54, v28, v29
    v_cvt_pk_bf16_f32 v55, v30, v31
    v_mfma_f32_32x32x16_bf16 v[160:175], v[152:155], v[48:51], v[160:175]
    ds_read_b128 v[136:139], v4 offset:8256
    v_exp_f32 v32, v32
    v_exp_f32 v33, v33
    v_exp_f32 v34, v34
    v_exp_f32 v35, v35
    v_mfma_f32_32x32x16_bf16 v[16:31], v[148:151], v[232:235], 0
    ds_read_b128 v[140:143], v5 offset:8256
    v_exp_f32 v36, v36
    v_exp_f32 v37, v37
    v_cvt_pk_bf16_f32 v48, v32, v33
    v_exp_f32 v38, v38
    v_exp_f32 v39, v39
    v_mfma_f32_32x32x16_bf16 v[160:175], v[156:159], v[52:55], v[160:175]
    ds_read_b128 v[144:147], v6 offset:8256
    v_cvt_pk_bf16_f32 v49, v34, v35
    v_exp_f32 v40, v40
    v_exp_f32 v41, v41
    v_cvt_pk_bf16_f32 v50, v36, v37
    v_exp_f32 v42, v42
    v_exp_f32 v43, v43
    global_load_lds_dwordx4 v0, s[52:53] offset:2048
    v_cvt_pk_bf16_f32 v51, v38, v39
    v_exp_f32 v44, v44
    v_cvt_pk_bf16_f32 v52, v40, v41
    v_exp_f32 v45, v45
    v_cvt_pk_bf16_f32 v53, v42, v43
    v_exp_f32 v46, v46
    v_exp_f32 v47, v47
    v_cvt_pk_bf16_f32 v54, v44, v45
    v_cvt_pk_bf16_f32 v55, v46, v47
    v_mfma_f32_32x32x16_bf16 v[176:191], v[152:155], v[48:51], v[176:191]
    global_load_lds_dwordx4 v0, s[52:53] offset:3072
    s_add_u32 m0, s48, 20640
    v_add_u32 v0, 4096, v0
    v_exp_f32 v16, v16
    v_exp_f32 v17, v17
    v_exp_f32 v18, v18
    v_exp_f32 v19, v19
    v_mfma_f32_32x32x16_bf16 v[32:47], v[148:151], v[236:239], 0
    s_waitcnt lgkmcnt(0)
    v_max3_u32 v240, v136, v140, v144
    v_cmp_eq_u32 vcc, -1, v240
    v_exp_f32 v20, v20
    v_exp_f32 v21, v21
    v_cvt_pk_bf16_f32 v48, v16, v17
    v_exp_f32 v22, v22
    v_exp_f32 v23, v23
    v_mfma_f32_32x32x16_bf16 v[176:191], v[156:159], v[52:55], v[176:191]
    s_cbranch_vccnz adaLN_cond__grouped_kv_mqa__dense_activation_silu__prompt_kernel_kvs44
adaLN_cond__grouped_kv_mqa__dense_activation_silu__prompt_kernel_kvb46:
    v_cvt_pk_bf16_f32 v49, v18, v19
    v_exp_f32 v24, v24
    v_exp_f32 v25, v25
    v_cvt_pk_bf16_f32 v50, v20, v21
    v_exp_f32 v26, v26
    v_exp_f32 v27, v27
    global_load_lds_dwordx4 v0, s[52:53] offset:0
    v_cvt_pk_bf16_f32 v51, v22, v23
    v_exp_f32 v28, v28
    v_cvt_pk_bf16_f32 v52, v24, v25
    v_exp_f32 v29, v29
    v_cvt_pk_bf16_f32 v53, v26, v27
    v_exp_f32 v30, v30
    v_exp_f32 v31, v31
    v_cvt_pk_bf16_f32 v54, v28, v29
    v_cvt_pk_bf16_f32 v55, v30, v31
    v_mfma_f32_32x32x16_bf16 v[192:207], v[152:155], v[48:51], v[192:207]
    s_waitcnt vmcnt(10)
    v_exp_f32 v32, v32
    v_exp_f32 v33, v33
    v_exp_f32 v34, v34
    v_exp_f32 v35, v35
    v_mfma_f32_32x32x16_bf16 v[16:31], v[136:139], v[224:227], 0
    global_store_dword v99, v1, s[28:29] sc1
    v_exp_f32 v36, v36
    v_exp_f32 v37, v37
    v_cvt_pk_bf16_f32 v48, v32, v33
    v_exp_f32 v38, v38
    v_exp_f32 v39, v39
    v_mfma_f32_32x32x16_bf16 v[192:207], v[156:159], v[52:55], v[192:207]
    global_load_lds_dwordx4 v0, s[52:53] offset:1024
    s_add_u32 m0, s48, 20656
    v_cvt_pk_bf16_f32 v49, v34, v35
    v_exp_f32 v40, v40
    v_exp_f32 v41, v41
    v_cvt_pk_bf16_f32 v50, v36, v37
    v_exp_f32 v42, v42
    v_exp_f32 v43, v43
    v_cvt_pk_bf16_f32 v51, v38, v39
    v_exp_f32 v44, v44
    v_cvt_pk_bf16_f32 v52, v40, v41
    v_exp_f32 v45, v45
    v_cvt_pk_bf16_f32 v53, v42, v43
    v_exp_f32 v46, v46
    v_exp_f32 v47, v47
    v_cvt_pk_bf16_f32 v54, v44, v45
    v_cvt_pk_bf16_f32 v55, v46, v47
    v_mfma_f32_32x32x16_bf16 v[208:223], v[152:155], v[48:51], v[208:223]
    global_load_lds_dwordx4 v0, s[52:53] offset:2048
    v_exp_f32 v16, v16
    v_exp_f32 v17, v17
    s_and_b32 s56, s23, 0xfe00
    s_lshl_b32 s57, s44, 7
    v_exp_f32 v18, v18
    v_exp_f32 v19, v19
    v_mfma_f32_32x32x16_bf16 v[32:47], v[136:139], v[228:231], 0
    global_load_lds_dwordx4 v0, s[52:53] offset:3072
    s_add_u32 m0, s48, 24768
    v_add_u32 v0, 4096, v0
    v_exp_f32 v20, v20
    v_exp_f32 v21, v21
    v_cvt_pk_bf16_f32 v48, v16, v17
    s_add_u32 s56, s56, s57
    v_and_b32 v128, 31, v1
    v_exp_f32 v22, v22
    v_exp_f32 v23, v23
    v_mfma_f32_32x32x16_bf16 v[208:223], v[156:159], v[52:55], v[208:223]
    v_cvt_pk_bf16_f32 v49, v18, v19
    v_exp_f32 v24, v24
    v_exp_f32 v25, v25
    v_lshl_add_u32 v128, v128, 2, s56
    v_mov_b32 v129, s39
    v_cvt_pk_bf16_f32 v50, v20, v21
    v_exp_f32 v26, v26
    v_exp_f32 v27, v27
    v_cvt_pk_bf16_f32 v51, v22, v23
    v_exp_f32 v28, v28
    v_cvt_pk_bf16_f32 v52, v24, v25
    v_exp_f32 v29, v29
    v_cvt_pk_bf16_f32 v53, v26, v27
    v_exp_f32 v30, v30
    v_exp_f32 v31, v31
    v_cvt_pk_bf16_f32 v54, v28, v29
    v_cvt_pk_bf16_f32 v55, v30, v31
    v_mfma_f32_32x32x16_bf16 v[160:175], v[140:143], v[48:51], v[160:175]
    ds_read_b128 v[148:151], v4 offset:10320
    v_exp_f32 v32, v32
    v_exp_f32 v33, v33
    v_lshrrev_b32 v106, 5, v1
    s_lshl_b32 s56, s44, 9
    v_exp_f32 v34, v34
    v_exp_f32 v35, v35
    v_mfma_f32_32x32x16_bf16 v[16:31], v[136:139], v[232:235], 0
    ds_read_b128 v[152:155], v5 offset:10320
    v_exp_f32 v36, v36
    v_exp_f32 v37, v37
    v_cvt_pk_bf16_f32 v48, v32, v33
    s_add_u32 s56, s56, 8192
    v_mul_u32_u24 v102, 2560, v106
    v_exp_f32 v38, v38
    v_exp_f32 v39, v39
    v_mfma_f32_32x32x16_bf16 v[160:175], v[144:147], v[52:55], v[160:175]
    ds_read_b128 v[156:159], v6 offset:10320
    v_cvt_pk_bf16_f32 v49, v34, v35
    v_exp_f32 v40, v40
    v_exp_f32 v41, v41
    v_sub_u32 v102, v2, v102
    v_add_u32 v102, s56, v102
    v_cvt_pk_bf16_f32 v50, v36, v37
    v_exp_f32 v42, v42
    v_exp_f32 v43, v43
    global_load_lds_dwordx4 v0, s[52:53] offset:0
    v_add_u32 v103, 12288, v102
    v_lshrrev_b32 v107, 4, v1
    v_cvt_pk_bf16_f32 v51, v38, v39
    v_exp_f32 v44, v44
    v_cvt_pk_bf16_f32 v52, v40, v41
    v_and_b32 v104, 15, v1
    v_lshlrev_b32 v104, 2, v104
    v_exp_f32 v45, v45
    v_cvt_pk_bf16_f32 v53, v42, v43
    v_exp_f32 v46, v46
    v_lshl_add_u32 v104, v107, 11, v104
    s_and_b32 s56, s39, 0xffff
    v_exp_f32 v47, v47
    v_cvt_pk_bf16_f32 v54, v44, v45
    v_cvt_pk_bf16_f32 v55, v46, v47
    v_mfma_f32_32x32x16_bf16 v[176:191], v[140:143], v[48:51], v[176:191]
    global_load_lds_dwordx4 v0, s[52:53] offset:1024
    s_add_u32 m0, s48, 24784
    v_exp_f32 v16, v16
    v_exp_f32 v17, v17
    s_lshl1_add_u32 s56, s56, 4096
    v_add_u32 v104, s56, v104
    v_exp_f32 v18, v18
    v_exp_f32 v19, v19
    v_mfma_f32_32x32x16_bf16 v[32:47], v[136:139], v[236:239], 0
    s_waitcnt lgkmcnt(0)
    v_max3_u32 v240, v148, v152, v156
    v_cmp_eq_u32 vcc, -1, v240
    v_exp_f32 v20, v20
    v_exp_f32 v21, v21
    v_cvt_pk_bf16_f32 v48, v16, v17
    v_add_u32 v105, 12288, v104
    v_cmp_eq_u32 s[56:57], 0, v106
    v_exp_f32 v22, v22
    v_exp_f32 v23, v23
    v_mfma_f32_32x32x16_bf16 v[176:191], v[144:147], v[52:55], v[176:191]
    s_cbranch_vccnz adaLN_cond__grouped_kv_mqa__dense_activation_silu__prompt_kernel_kvs48
adaLN_cond__grouped_kv_mqa__dense_activation_silu__prompt_kernel_kvb50:
    v_cvt_pk_bf16_f32 v49, v18, v19
    v_exp_f32 v24, v24
    v_exp_f32 v25, v25
    v_cmp_eq_u32 s[58:59], 2, v107
    v_cndmask_b32 v106, 0, 1.0, s[56:57]
    v_cvt_pk_bf16_f32 v50, v20, v21
    v_exp_f32 v26, v26
    v_exp_f32 v27, v27
    v_cndmask_b32 v107, 0, 1.0, s[58:59]
    s_add_u32 s56, s48, 33024
    v_cvt_pk_bf16_f32 v51, v22, v23
    v_exp_f32 v28, v28
    v_cvt_pk_bf16_f32 v52, v24, v25
    v_lshl_add_u32 v130, v1, 3, s56
    v_lshl_add_u32 v132, v1, 2, s56
    v_exp_f32 v29, v29
    v_cvt_pk_bf16_f32 v53, v26, v27
    v_exp_f32 v30, v30
    v_exp_f32 v31, v31
    v_cvt_pk_bf16_f32 v54, v28, v29
    v_cvt_pk_bf16_f32 v55, v30, v31
    v_mfma_f32_32x32x16_bf16 v[192:207], v[140:143], v[48:51], v[192:207]
    global_load_lds_dwordx4 v0, s[52:53] offset:2048
    v_exp_f32 v32, v32
    v_exp_f32 v33, v33
    v_exp_f32 v34, v34
    v_exp_f32 v35, v35
    v_mfma_f32_32x32x16_bf16 v[16:31], v[148:151], v[224:227], 0
    global_load_lds_dwordx4 v0, s[52:53] offset:3072
    s_add_u32 m0, s48, 28896
    v_add_u32 v0, 4096, v0
    v_exp_f32 v36, v36
    v_exp_f32 v37, v37
    v_cvt_pk_bf16_f32 v48, v32, v33
    v_exp_f32 v38, v38
    v_exp_f32 v39, v39
    v_mfma_f32_32x32x16_bf16 v[192:207], v[144:147], v[52:55], v[192:207]
    global_load_lds_dwordx4 v0, s[52:53] offset:0
    v_cvt_pk_bf16_f32 v49, v34, v35
    v_exp_f32 v40, v40
    v_exp_f32 v41, v41
    v_cvt_pk_bf16_f32 v50, v36, v37
    v_exp_f32 v42, v42
    v_exp_f32 v43, v43
    v_cvt_pk_bf16_f32 v51, v38, v39
    v_exp_f32 v44, v44
    v_cvt_pk_bf16_f32 v52, v40, v41
    v_exp_f32 v45, v45
    v_cvt_pk_bf16_f32 v53, v42, v43
    v_exp_f32 v46, v46
    v_exp_f32 v47, v47
    v_cvt_pk_bf16_f32 v54, v44, v45
    v_cvt_pk_bf16_f32 v55, v46, v47
    v_mfma_f32_32x32x16_bf16 v[208:223], v[140:143], v[48:51], v[208:223]
    global_load_dwordx4 v[108:111], v102, s[28:29] sc1
    v_exp_f32 v16, v16
    v_exp_f32 v17, v17
    v_exp_f32 v18, v18
    v_exp_f32 v19, v19
    v_mfma_f32_32x32x16_bf16 v[32:47], v[148:151], v[228:231], 0
    global_load_dwordx4 v[112:115], v103, s[28:29] sc1
    v_exp_f32 v20, v20
    v_exp_f32 v21, v21
    v_cvt_pk_bf16_f32 v48, v16, v17
    v_exp_f32 v22, v22
    v_exp_f32 v23, v23
    v_mfma_f32_32x32x16_bf16 v[208:223], v[144:147], v[52:55], v[208:223]
    s_waitcnt vmcnt(18)
    v_cvt_pk_bf16_f32 v49, v18, v19
    v_exp_f32 v24, v24
    v_exp_f32 v25, v25
    v_cvt_pk_bf16_f32 v50, v20, v21
    v_exp_f32 v26, v26
    v_exp_f32 v27, v27
    v_cvt_pk_bf16_f32 v51, v22, v23
    v_exp_f32 v28, v28
    v_cvt_pk_bf16_f32 v52, v24, v25
    v_exp_f32 v29, v29
    v_cvt_pk_bf16_f32 v53, v26, v27
    v_exp_f32 v30, v30
    v_exp_f32 v31, v31
    v_cvt_pk_bf16_f32 v54, v28, v29
    v_cvt_pk_bf16_f32 v55, v30, v31
    v_mfma_f32_32x32x16_bf16 v[160:175], v[152:155], v[48:51], v[160:175]
    ds_read_b128 v[136:139], v4 offset:12384
    v_exp_f32 v32, v32
    v_exp_f32 v33, v33
    v_exp_f32 v34, v34
    v_exp_f32 v35, v35
    v_mfma_f32_32x32x16_bf16 v[16:31], v[148:151], v[232:235], 0
    ds_read_b128 v[140:143], v5 offset:12384
    v_exp_f32 v36, v36
    v_exp_f32 v37, v37
    v_cvt_pk_bf16_f32 v48, v32, v33
    v_exp_f32 v38, v38
    v_exp_f32 v39, v39
    v_mfma_f32_32x32x16_bf16 v[160:175], v[156:159], v[52:55], v[160:175]
    ds_read_b128 v[144:147], v6 offset:12384
    v_cvt_pk_bf16_f32 v49, v34, v35
    v_exp_f32 v40, v40
    v_exp_f32 v41, v41
    v_cvt_pk_bf16_f32 v50, v36, v37
    v_exp_f32 v42, v42
    v_exp_f32 v43, v43
    global_load_lds_dwordx4 v0, s[52:53] offset:1024
    s_add_u32 m0, s48, 28912
    v_cvt_pk_bf16_f32 v51, v38, v39
    v_exp_f32 v44, v44
    v_cvt_pk_bf16_f32 v52, v40, v41
    v_exp_f32 v45, v45
    v_cvt_pk_bf16_f32 v53, v42, v43
    v_exp_f32 v46, v46
    v_exp_f32 v47, v47
    v_cvt_pk_bf16_f32 v54, v44, v45
    v_cvt_pk_bf16_f32 v55, v46, v47
    v_mfma_f32_32x32x16_bf16 v[176:191], v[152:155], v[48:51], v[176:191]
    global_load_lds_dwordx4 v0, s[52:53] offset:2048
    v_exp_f32 v16, v16
    v_exp_f32 v17, v17
    v_exp_f32 v18, v18
    v_exp_f32 v19, v19
    v_mfma_f32_32x32x16_bf16 v[32:47], v[148:151], v[236:239], 0
    s_waitcnt lgkmcnt(0)
    v_max3_u32 v240, v136, v140, v144
    v_cmp_eq_u32 vcc, -1, v240
    v_exp_f32 v20, v20
    v_exp_f32 v21, v21
    v_cvt_pk_bf16_f32 v48, v16, v17
    v_exp_f32 v22, v22
    v_exp_f32 v23, v23
    v_mfma_f32_32x32x16_bf16 v[176:191], v[156:159], v[52:55], v[176:191]
    s_cbranch_vccnz adaLN_cond__grouped_kv_mqa__dense_activation_silu__prompt_kernel_kvs52
adaLN_cond__grouped_kv_mqa__dense_activation_silu__prompt_kernel_kvb54:
    v_cvt_pk_bf16_f32 v49, v18, v19
    v_exp_f32 v24, v24
    v_exp_f32 v25, v25
    v_cvt_pk_bf16_f32 v50, v20, v21
    v_exp_f32 v26, v26
    v_exp_f32 v27, v27
    global_load_lds_dwordx4 v0, s[52:53] offset:3072
    v_cvt_pk_bf16_f32 v51, v22, v23
    v_exp_f32 v28, v28
    v_cvt_pk_bf16_f32 v52, v24, v25
    v_exp_f32 v29, v29
    v_cvt_pk_bf16_f32 v53, v26, v27
    v_exp_f32 v30, v30
    v_exp_f32 v31, v31
    v_cvt_pk_bf16_f32 v54, v28, v29
    v_cvt_pk_bf16_f32 v55, v30, v31
    v_mfma_f32_32x32x16_bf16 v[192:207], v[152:155], v[48:51], v[192:207]
    global_load_dword v116, v104, s[28:29] sc1
    v_exp_f32 v32, v32
    v_exp_f32 v33, v33
    v_exp_f32 v34, v34
    v_exp_f32 v35, v35
    v_mfma_f32_32x32x16_bf16 v[16:31], v[136:139], v[224:227], 0
    global_load_dword v117, v105, s[28:29] sc1
    v_exp_f32 v36, v36
    v_exp_f32 v37, v37
    v_cvt_pk_bf16_f32 v48, v32, v33
    v_exp_f32 v38, v38
    v_exp_f32 v39, v39
    v_mfma_f32_32x32x16_bf16 v[192:207], v[156:159], v[52:55], v[192:207]
    global_store_dwordx4 v13, v[72:75], s[50:51]
    v_cvt_pk_bf16_f32 v49, v34, v35
    v_exp_f32 v40, v40
    v_exp_f32 v41, v41
    v_cvt_pk_bf16_f32 v50, v36, v37
    v_exp_f32 v42, v42
    v_exp_f32 v43, v43
    v_cvt_pk_bf16_f32 v51, v38, v39
    v_exp_f32 v44, v44
    v_cvt_pk_bf16_f32 v52, v40, v41
    v_exp_f32 v45, v45
    v_cvt_pk_bf16_f32 v53, v42, v43
    v_exp_f32 v46, v46
    v_exp_f32 v47, v47
    v_cvt_pk_bf16_f32 v54, v44, v45
    v_cvt_pk_bf16_f32 v55, v46, v47
    v_mfma_f32_32x32x16_bf16 v[208:223], v[152:155], v[48:51], v[208:223]
    global_load_dword v124, v128, s[28:29] sc1
    v_exp_f32 v16, v16
    v_exp_f32 v17, v17
    v_exp_f32 v18, v18
    v_exp_f32 v19, v19
    v_mfma_f32_32x32x16_bf16 v[32:47], v[136:139], v[228:231], 0
    global_load_dword v131, v129, s[24:25]
    v_exp_f32 v20, v20
    v_exp_f32 v21, v21
    v_cvt_pk_bf16_f32 v48, v16, v17
    v_exp_f32 v22, v22
    v_exp_f32 v23, v23
    v_mfma_f32_32x32x16_bf16 v[208:223], v[156:159], v[52:55], v[208:223]
    s_waitcnt vmcnt(24)
    v_cvt_pk_bf16_f32 v49, v18, v19
    v_exp_f32 v24, v24
    v_exp_f32 v25, v25
    v_cvt_pk_bf16_f32 v50, v20, v21
    v_exp_f32 v26, v26
    v_exp_f32 v27, v27
    v_cvt_pk_bf16_f32 v51, v22, v23
    v_exp_f32 v28, v28
    v_cvt_pk_bf16_f32 v52, v24, v25
    v_exp_f32 v29, v29
    v_cvt_pk_bf16_f32 v53, v26, v27
    v_exp_f32 v30, v30
    v_exp_f32 v31, v31
    v_cvt_pk_bf16_f32 v54, v28, v29
    v_cvt_pk_bf16_f32 v55, v30, v31
    v_mfma_f32_32x32x16_bf16 v[160:175], v[140:143], v[48:51], v[160:175]
    ds_read_b128 v[148:151], v4 offset:14448
    v_exp_f32 v32, v32
    v_exp_f32 v33, v33
    v_exp_f32 v34, v34
    v_exp_f32 v35, v35
    v_mfma_f32_32x32x16_bf16 v[16:31], v[136:139], v[232:235], 0
    ds_read_b128 v[152:155], v5 offset:14448
    v_exp_f32 v36, v36
    v_exp_f32 v37, v37
    v_cvt_pk_bf16_f32 v48, v32, v33
    v_exp_f32 v38, v38
    v_exp_f32 v39, v39
    v_mfma_f32_32x32x16_bf16 v[160:175], v[144:147], v[52:55], v[160:175]
    ds_read_b128 v[156:159], v6 offset:14448
    v_cvt_pk_bf16_f32 v49, v34, v35
    v_exp_f32 v40, v40
    v_exp_f32 v41, v41
    v_cvt_pk_bf16_f32 v50, v36, v37
    v_exp_f32 v42, v42
    v_exp_f32 v43, v43
    v_cvt_pk_bf16_f32 v51, v38, v39
    v_exp_f32 v44, v44
    v_cvt_pk_bf16_f32 v52, v40, v41
    v_exp_f32 v45, v45
    v_cvt_pk_bf16_f32 v53, v42, v43
    v_exp_f32 v46, v46
    v_exp_f32 v47, v47
    v_cvt_pk_bf16_f32 v54, v44, v45
    v_cvt_pk_bf16_f32 v55, v46, v47
    v_mfma_f32_32x32x16_bf16 v[176:191], v[140:143], v[48:51], v[176:191]
    global_store_dwordx4 v13, v[72:75], s[6:7]
    v_exp_f32 v16, v16
    v_exp_f32 v17, v17
    v_exp_f32 v18, v18
    v_exp_f32 v19, v19
    v_mfma_f32_32x32x16_bf16 v[32:47], v[136:139], v[236:239], 0
    s_waitcnt lgkmcnt(0)
    v_max3_u32 v240, v148, v152, v156
    v_cmp_eq_u32 vcc, -1, v240
    v_exp_f32 v20, v20
    v_exp_f32 v21, v21
    v_cvt_pk_bf16_f32 v48, v16, v17
    v_exp_f32 v22, v22
    v_exp_f32 v23, v23
    v_mfma_f32_32x32x16_bf16 v[176:191], v[144:147], v[52:55], v[176:191]
    s_cbranch_vccnz adaLN_cond__grouped_kv_mqa__dense_activation_silu__prompt_kernel_kvs56
adaLN_cond__grouped_kv_mqa__dense_activation_silu__prompt_kernel_kvb58:
    v_cvt_pk_bf16_f32 v49, v18, v19
    v_exp_f32 v24, v24
    v_exp_f32 v25, v25
    v_cvt_pk_bf16_f32 v50, v20, v21
    v_exp_f32 v26, v26
    v_exp_f32 v27, v27
    v_cvt_pk_bf16_f32 v51, v22, v23
    v_exp_f32 v28, v28
    v_cvt_pk_bf16_f32 v52, v24, v25
    v_exp_f32 v29, v29
    v_cvt_pk_bf16_f32 v53, v26, v27
    v_exp_f32 v30, v30
    v_exp_f32 v31, v31
    v_cvt_pk_bf16_f32 v54, v28, v29
    v_cvt_pk_bf16_f32 v55, v30, v31
    v_mfma_f32_32x32x16_bf16 v[192:207], v[140:143], v[48:51], v[192:207]
    s_waitcnt vmcnt(4)
    v_exp_f32 v32, v32
    v_exp_f32 v33, v33
    v_max_u32 v242, v108, v109
    v_max3_u32 v242, v242, v110, v111
    v_max3_u32 v242, v242, v112, v113
    v_exp_f32 v34, v34
    v_exp_f32 v35, v35
    v_mfma_f32_32x32x16_bf16 v[16:31], v[148:151], v[224:227], 0
    global_store_dwordx4 v13, v[72:75], s[8:9]
    v_exp_f32 v36, v36
    v_exp_f32 v37, v37
    v_cvt_pk_bf16_f32 v48, v32, v33
    v_max3_u32 v242, v242, v114, v115
    v_max3_u32 v242, v242, v116, v117
    v_cmp_eq_u32 vcc, -1, v242
    v_exp_f32 v38, v38
    v_exp_f32 v39, v39
    v_mfma_f32_32x32x16_bf16 v[192:207], v[144:147], v[52:55], v[192:207]
    s_cbranch_vccnz adaLN_cond__grouped_kv_mqa__dense_activation_silu__prompt_kernel_st95
adaLN_cond__grouped_kv_mqa__dense_activation_silu__prompt_kernel_bk96:
    v_cvt_pk_bf16_f32 v49, v34, v35
    v_exp_f32 v40, v40
    v_exp_f32 v41, v41
    v_cvt_pk_bf16_f32 v50, v36, v37
    v_exp_f32 v42, v42
    v_exp_f32 v43, v43
    v_cvt_pk_bf16_f32 v51, v38, v39
    v_exp_f32 v44, v44
    v_cvt_pk_bf16_f32 v52, v40, v41
    v_exp_f32 v45, v45
    v_cvt_pk_bf16_f32 v53, v42, v43
    v_exp_f32 v46, v46
    v_exp_f32 v47, v47
    v_cvt_pk_bf16_f32 v54, v44, v45
    v_cvt_pk_bf16_f32 v55, v46, v47
    v_mfma_f32_32x32x16_bf16 v[208:223], v[140:143], v[48:51], v[208:223]
    global_store_dwordx4 v13, v[72:75], s[10:11]
    v_exp_f32 v16, v16
    v_exp_f32 v17, v17
    v_add_f32 v108, v108, v112
    v_add_f32 v109, v109, v113
    v_exp_f32 v18, v18
    v_exp_f32 v19, v19
    v_mfma_f32_32x32x16_bf16 v[32:47], v[148:151], v[228:231], 0
    global_store_dwordx2 v98, v[72:73], s[12:13]
    v_exp_f32 v20, v20
    v_exp_f32 v21, v21
    v_cvt_pk_bf16_f32 v48, v16, v17
    v_add_f32 v110, v110, v114
    v_add_f32 v111, v111, v115
    v_exp_f32 v22, v22
    v_exp_f32 v23, v23
    v_mfma_f32_32x32x16_bf16 v[208:223], v[144:147], v[52:55], v[208:223]
    v_cvt_pk_bf16_f32 v49, v18, v19
    v_exp_f32 v24, v24
    v_exp_f32 v25, v25
    v_add_f32 v112, v116, v117
    v_cvt_pk_bf16_f32 v118, v108, v109
    v_cvt_pk_bf16_f32 v50, v20, v21
    v_exp_f32 v26, v26
    v_exp_f32 v27, v27
    v_cvt_pk_bf16_f32 v119, v110, v111
    v_cvt_pk_bf16_f32 v120, v112, v112
    v_cvt_pk_bf16_f32 v51, v22, v23
    v_exp_f32 v28, v28
    v_cvt_pk_bf16_f32 v52, v24, v25
    v_lshlrev_b32 v108, 16, v118
    v_and_b32 v109, 0xffff0000, v118
    v_exp_f32 v29, v29
    v_cvt_pk_bf16_f32 v53, v26, v27
    v_exp_f32 v30, v30
    v_lshlrev_b32 v110, 16, v119
    v_and_b32 v111, 0xffff0000, v119
    v_exp_f32 v31, v31
    v_cvt_pk_bf16_f32 v54, v28, v29
    v_cvt_pk_bf16_f32 v55, v30, v31
    v_mfma_f32_32x32x16_bf16 v[160:175], v[152:155], v[48:51], v[160:175]
    ds_read_b128 v[136:139], v4 offset:16512
    v_exp_f32 v32, v32
    v_exp_f32 v33, v33
    v_lshlrev_b32 v112, 16, v120
    v_add_f32 v108, v108, v106
    v_exp_f32 v34, v34
    v_exp_f32 v35, v35
    v_mfma_f32_32x32x16_bf16 v[16:31], v[148:151], v[232:235], 0
    ds_read_b128 v[140:143], v5 offset:16512
    v_exp_f32 v36, v36
    v_exp_f32 v37, v37
    v_cvt_pk_bf16_f32 v48, v32, v33
    v_add_f32 v109, v109, v106
    v_add_f32 v110, v110, v106
    v_exp_f32 v38, v38
    v_exp_f32 v39, v39
    v_mfma_f32_32x32x16_bf16 v[160:175], v[156:159], v[52:55], v[160:175]
    ds_read_b128 v[144:147], v6 offset:16512
    v_cvt_pk_bf16_f32 v49, v34, v35
    v_exp_f32 v40, v40
    v_exp_f32 v41, v41
    v_add_f32 v111, v111, v106
    v_add_f32 v112, v112, v107
    v_cvt_pk_bf16_f32 v50, v36, v37
    v_exp_f32 v42, v42
    v_exp_f32 v43, v43
    v_cvt_pk_bf16_f32 v118, v108, v109
    v_cvt_pk_bf16_f32 v119, v110, v111
    v_cvt_pk_bf16_f32 v51, v38, v39
    v_exp_f32 v44, v44
    v_cvt_pk_bf16_f32 v52, v40, v41
    v_cvt_pk_bf16_f32 v120, v112, v112
    v_lshlrev_b32 v14, 16, v120
    v_exp_f32 v45, v45
    v_cvt_pk_bf16_f32 v53, v42, v43
    v_exp_f32 v46, v46
    v_exp_f32 v47, v47
    v_cvt_pk_bf16_f32 v54, v44, v45
    v_cvt_pk_bf16_f32 v55, v46, v47
    v_mfma_f32_32x32x16_bf16 v[176:191], v[152:155], v[48:51], v[176:191]
    ds_write_b64 v130, v[118:119]
    ds_write_b32 v132, v14 offset:512
    v_exp_f32 v16, v16
    v_exp_f32 v17, v17
    v_exp_f32 v18, v18
    v_exp_f32 v19, v19
    v_mfma_f32_32x32x16_bf16 v[32:47], v[148:151], v[236:239], 0
    s_waitcnt lgkmcnt(2)
    v_max3_u32 v240, v136, v140, v144
    v_cmp_eq_u32 vcc, -1, v240
    v_exp_f32 v20, v20
    v_exp_f32 v21, v21
    v_cvt_pk_bf16_f32 v48, v16, v17
    v_exp_f32 v22, v22
    v_exp_f32 v23, v23
    v_mfma_f32_32x32x16_bf16 v[176:191], v[156:159], v[52:55], v[176:191]
    s_cbranch_vccnz adaLN_cond__grouped_kv_mqa__dense_activation_silu__prompt_kernel_kvs60
adaLN_cond__grouped_kv_mqa__dense_activation_silu__prompt_kernel_kvb62:
    v_cvt_pk_bf16_f32 v49, v18, v19
    v_exp_f32 v24, v24
    v_exp_f32 v25, v25
    v_cvt_pk_bf16_f32 v50, v20, v21
    v_exp_f32 v26, v26
    v_exp_f32 v27, v27
    v_cvt_pk_bf16_f32 v51, v22, v23
    v_exp_f32 v28, v28
    v_cvt_pk_bf16_f32 v52, v24, v25
    v_exp_f32 v29, v29
    v_cvt_pk_bf16_f32 v53, v26, v27
    v_exp_f32 v30, v30
    v_exp_f32 v31, v31
    v_cvt_pk_bf16_f32 v54, v28, v29
    v_cvt_pk_bf16_f32 v55, v30, v31
    v_mfma_f32_32x32x16_bf16 v[192:207], v[152:155], v[48:51], v[192:207]
    s_waitcnt vmcnt(5) lgkmcnt(1)
    v_exp_f32 v32, v32
    v_exp_f32 v33, v33
    v_cmp_eq_u32 vcc, -1, v124
    v_exp_f32 v34, v34
    v_exp_f32 v35, v35
    v_mfma_f32_32x32x16_bf16 v[16:31], v[136:139], v[224:227], 0
    s_cbranch_vccnz adaLN_cond__grouped_kv_mqa__dense_activation_silu__prompt_kernel_st92
adaLN_cond__grouped_kv_mqa__dense_activation_silu__prompt_kernel_bk93:
    s_barrier
    v_exp_f32 v36, v36
    v_exp_f32 v37, v37
    v_cvt_pk_bf16_f32 v48, v32, v33
    v_add_u32 v0, s32, v2
    v_exp_f32 v38, v38
    v_exp_f32 v39, v39
    v_mfma_f32_32x32x16_bf16 v[192:207], v[156:159], v[52:55], v[192:207]
    global_store_dwordx4 v96, v[72:75], s[18:19] offset:0
    v_cvt_pk_bf16_f32 v49, v34, v35
    v_exp_f32 v40, v40
    v_exp_f32 v41, v41
    v_cvt_pk_bf16_f32 v50, v36, v37
    v_exp_f32 v42, v42
    v_exp_f32 v43, v43
    v_cvt_pk_bf16_f32 v51, v38, v39
    v_exp_f32 v44, v44
    v_cvt_pk_bf16_f32 v52, v40, v41
    v_exp_f32 v45, v45
    v_cvt_pk_bf16_f32 v53, v42, v43
    v_exp_f32 v46, v46
    v_exp_f32 v47, v47
    v_cvt_pk_bf16_f32 v54, v44, v45
    v_cvt_pk_bf16_f32 v55, v46, v47
    v_mfma_f32_32x32x16_bf16 v[208:223], v[152:155], v[48:51], v[208:223]
    global_store_dwordx4 v96, v[72:75], s[18:19] offset:1024
    v_exp_f32 v16, v16
    v_exp_f32 v17, v17
    s_lshl_b32 s56, s0, 12
    s_add_u32 s56, s56, s32
    v_exp_f32 v18, v18
    v_exp_f32 v19, v19
    v_mfma_f32_32x32x16_bf16 v[32:47], v[136:139], v[228:231], 0
    global_store_dwordx4 v97, v[72:75], s[18:19] offset:0
    v_exp_f32 v20, v20
    v_exp_f32 v21, v21
    v_cvt_pk_bf16_f32 v48, v16, v17
    s_add_u32 s57, s33, 24576
    v_add_u32 v104, s56, v2
    v_exp_f32 v22, v22
    v_exp_f32 v23, v23
    v_mfma_f32_32x32x16_bf16 v[208:223], v[156:159], v[52:55], v[208:223]
    global_store_dwordx4 v97, v[72:75], s[18:19] offset:1024
    v_cvt_pk_bf16_f32 v49, v18, v19
    v_exp_f32 v24, v24
    v_exp_f32 v25, v25
    v_add_u32 v105, s57, v104
    v_lshrrev_b32 v106, 2, v1
    v_cvt_pk_bf16_f32 v50, v20, v21
    v_exp_f32 v26, v26
    v_exp_f32 v27, v27
    v_xor_b32 v106, v106, v1
    v_and_b32 v106, 4, v106
    v_cvt_pk_bf16_f32 v51, v22, v23
    v_exp_f32 v28, v28
    v_cvt_pk_bf16_f32 v52, v24, v25
    v_cmp_eq_u32 s[58:59], 0, v106
    s_lshr_b32 s56, s0, 1
    v_exp_f32 v29, v29
    v_cvt_pk_bf16_f32 v53, v26, v27
    v_exp_f32 v30, v30
    s_mul_i32 s56, s56, 33536
    s_lshl_b32 s57, s0, 7
    v_exp_f32 v31, v31
    v_cvt_pk_bf16_f32 v54, v28, v29
    v_cvt_pk_bf16_f32 v55, v30, v31
    v_mfma_f32_32x32x16_bf16 v[160:175], v[140:143], v[48:51], v[160:175]
    ds_read_b128 v[148:151], v4 offset:18576
    v_exp_f32 v32, v32
    v_exp_f32 v33, v33
    s_add_u32 s56, s56, s57
    v_and_b32 v106, 8, v1
    v_exp_f32 v34, v34
    v_exp_f32 v35, v35
    v_mfma_f32_32x32x16_bf16 v[16:31], v[136:139], v[232:235], 0
    ds_read_b128 v[152:155], v5 offset:18576
    v_exp_f32 v36, v36
    v_exp_f32 v37, v37
    v_cvt_pk_bf16_f32 v48, v32, v33
    v_lshrrev_b32 v107, 5, v1
    v_lshl_add_u32 v106, v106, 5, s56
    v_exp_f32 v38, v38
    v_exp_f32 v39, v39
    v_mfma_f32_32x32x16_bf16 v[160:175], v[144:147], v[52:55], v[160:175]
    ds_read_b128 v[156:159], v6 offset:18576
    v_cvt_pk_bf16_f32 v49, v34, v35
    v_exp_f32 v40, v40
    v_exp_f32 v41, v41
    v_lshl_add_u32 v106, v107, 4, v106
    v_mov_b32 v107, 0x30000
    v_cvt_pk_bf16_f32 v50, v36, v37
    v_exp_f32 v42, v42
    v_exp_f32 v43, v43
    v_cndmask_b32 v106, v107, v106, s[58:59]
    s_lshr_b32 s56, s0, 2
    v_cvt_pk_bf16_f32 v51, v38, v39
    v_exp_f32 v44, v44
    v_cvt_pk_bf16_f32 v52, v40, v41
    s_mul_i32 s56, s56, 1008
    s_lshl2_add_u32 s56, s0, s56
    v_exp_f32 v45, v45
    v_cvt_pk_bf16_f32 v53, v42, v43
    v_exp_f32 v46, v46
    s_add_u32 s56, s56, s3
    v_add_u32 v107, s56, v2
    v_exp_f32 v47, v47
    v_cvt_pk_bf16_f32 v54, v44, v45
    v_cvt_pk_bf16_f32 v55, v46, v47
    v_mfma_f32_32x32x16_bf16 v[176:191], v[140:143], v[48:51], v[176:191]
    global_store_dwordx4 v96, v[72:75], s[20:21] offset:0
    v_exp_f32 v16, v16
    v_exp_f32 v17, v17
    v_exp_f32 v18, v18
    v_exp_f32 v19, v19
    v_mfma_f32_32x32x16_bf16 v[32:47], v[136:139], v[236:239], 0
    s_waitcnt lgkmcnt(0)
    v_max3_u32 v240, v148, v152, v156
    v_cmp_eq_u32 vcc, -1, v240
    v_exp_f32 v20, v20
    v_exp_f32 v21, v21
    v_cvt_pk_bf16_f32 v48, v16, v17
    v_exp_f32 v22, v22
    v_exp_f32 v23, v23
    v_mfma_f32_32x32x16_bf16 v[176:191], v[144:147], v[52:55], v[176:191]
    s_cbranch_vccnz adaLN_cond__grouped_kv_mqa__dense_activation_silu__prompt_kernel_kvs64
adaLN_cond__grouped_kv_mqa__dense_activation_silu__prompt_kernel_kvb66:
    v_cvt_pk_bf16_f32 v49, v18, v19
    v_exp_f32 v24, v24
    v_exp_f32 v25, v25
    v_cvt_pk_bf16_f32 v50, v20, v21
    v_exp_f32 v26, v26
    v_exp_f32 v27, v27
    v_cvt_pk_bf16_f32 v51, v22, v23
    v_exp_f32 v28, v28
    v_cvt_pk_bf16_f32 v52, v24, v25
    v_exp_f32 v29, v29
    v_cvt_pk_bf16_f32 v53, v26, v27
    v_exp_f32 v30, v30
    v_exp_f32 v31, v31
    v_cvt_pk_bf16_f32 v54, v28, v29
    v_cvt_pk_bf16_f32 v55, v30, v31
    v_mfma_f32_32x32x16_bf16 v[192:207], v[140:143], v[48:51], v[192:207]
    global_store_dwordx4 v96, v[72:75], s[20:21] offset:1024
    v_exp_f32 v32, v32
    v_exp_f32 v33, v33
    v_exp_f32 v34, v34
    v_exp_f32 v35, v35
    v_mfma_f32_32x32x16_bf16 v[16:31], v[148:151], v[224:227], 0
    global_store_dwordx4 v97, v[72:75], s[20:21] offset:0
    v_exp_f32 v36, v36
    v_exp_f32 v37, v37
    v_cvt_pk_bf16_f32 v48, v32, v33
    v_exp_f32 v38, v38
    v_exp_f32 v39, v39
    v_mfma_f32_32x32x16_bf16 v[192:207], v[144:147], v[52:55], v[192:207]
    global_store_dwordx4 v97, v[72:75], s[20:21] offset:1024
    v_cvt_pk_bf16_f32 v49, v34, v35
    v_exp_f32 v40, v40
    v_exp_f32 v41, v41
    v_cvt_pk_bf16_f32 v50, v36, v37
    v_exp_f32 v42, v42
    v_exp_f32 v43, v43
    v_cvt_pk_bf16_f32 v51, v38, v39
    v_exp_f32 v44, v44
    v_cvt_pk_bf16_f32 v52, v40, v41
    v_exp_f32 v45, v45
    v_cvt_pk_bf16_f32 v53, v42, v43
    v_exp_f32 v46, v46
    v_exp_f32 v47, v47
    v_cvt_pk_bf16_f32 v54, v44, v45
    v_cvt_pk_bf16_f32 v55, v46, v47
    v_mfma_f32_32x32x16_bf16 v[208:223], v[140:143], v[48:51], v[208:223]
    global_load_dword v134, v133, s[28:29] sc1
    v_exp_f32 v16, v16
    v_exp_f32 v17, v17
    v_exp_f32 v18, v18
    v_exp_f32 v19, v19
    v_mfma_f32_32x32x16_bf16 v[32:47], v[148:151], v[228:231], 0
    global_load_dwordx4 a[112:115], v104, s[28:29] offset:-4096
    v_exp_f32 v20, v20
    v_exp_f32 v21, v21
    v_cvt_pk_bf16_f32 v48, v16, v17
    v_exp_f32 v22, v22
    v_exp_f32 v23, v23
    v_mfma_f32_32x32x16_bf16 v[208:223], v[144:147], v[52:55], v[208:223]
    global_load_dwordx4 a[116:119], v104, s[28:29] offset:-3072
    v_cvt_pk_bf16_f32 v49, v18, v19
    v_exp_f32 v24, v24
    v_exp_f32 v25, v25
    v_cvt_pk_bf16_f32 v50, v20, v21
    v_exp_f32 v26, v26
    v_exp_f32 v27, v27
    v_cvt_pk_bf16_f32 v51, v22, v23
    v_exp_f32 v28, v28
    v_cvt_pk_bf16_f32 v52, v24, v25
    v_exp_f32 v29, v29
    v_cvt_pk_bf16_f32 v53, v26, v27
    v_exp_f32 v30, v30
    v_exp_f32 v31, v31
    v_cvt_pk_bf16_f32 v54, v28, v29
    v_cvt_pk_bf16_f32 v55, v30, v31
    v_mfma_f32_32x32x16_bf16 v[160:175], v[152:155], v[48:51], v[160:175]
    ds_read_b128 v[136:139], v4 offset:20640
    v_exp_f32 v32, v32
    v_exp_f32 v33, v33
    v_exp_f32 v34, v34
    v_exp_f32 v35, v35
    v_mfma_f32_32x32x16_bf16 v[16:31], v[148:151], v[232:235], 0
    ds_read_b128 v[140:143], v5 offset:20640
    v_exp_f32 v36, v36
    v_exp_f32 v37, v37
    v_cvt_pk_bf16_f32 v48, v32, v33
    v_exp_f32 v38, v38
    v_exp_f32 v39, v39
    v_mfma_f32_32x32x16_bf16 v[160:175], v[156:159], v[52:55], v[160:175]
    ds_read_b128 v[144:147], v6 offset:20640
    v_cvt_pk_bf16_f32 v49, v34, v35
    v_exp_f32 v40, v40
    v_exp_f32 v41, v41
    v_cvt_pk_bf16_f32 v50, v36, v37
    v_exp_f32 v42, v42
    v_exp_f32 v43, v43
    v_cvt_pk_bf16_f32 v51, v38, v39
    v_exp_f32 v44, v44
    v_cvt_pk_bf16_f32 v52, v40, v41
    v_exp_f32 v45, v45
    v_cvt_pk_bf16_f32 v53, v42, v43
    v_exp_f32 v46, v46
    v_exp_f32 v47, v47
    v_cvt_pk_bf16_f32 v54, v44, v45
    v_cvt_pk_bf16_f32 v55, v46, v47
    v_mfma_f32_32x32x16_bf16 v[176:191], v[152:155], v[48:51], v[176:191]
    global_load_dwordx4 a[120:123], v104, s[28:29] offset:-2048
    v_exp_f32 v16, v16
    v_exp_f32 v17, v17
    v_exp_f32 v18, v18
    v_exp_f32 v19, v19
    v_mfma_f32_32x32x16_bf16 v[32:47], v[148:151], v[236:239], 0
    s_waitcnt lgkmcnt(0)
    v_max3_u32 v240, v136, v140, v144
    v_cmp_eq_u32 vcc, -1, v240
    v_exp_f32 v20, v20
    v_exp_f32 v21, v21
    v_cvt_pk_bf16_f32 v48, v16, v17
    v_exp_f32 v22, v22
    v_exp_f32 v23, v23
    v_mfma_f32_32x32x16_bf16 v[176:191], v[156:159], v[52:55], v[176:191]
    s_cbranch_vccnz adaLN_cond__grouped_kv_mqa__dense_activation_silu__prompt_kernel_kvs68
adaLN_cond__grouped_kv_mqa__dense_activation_silu__prompt_kernel_kvb70:
    v_cvt_pk_bf16_f32 v49, v18, v19
    v_exp_f32 v24, v24
    v_exp_f32 v25, v25
    v_cvt_pk_bf16_f32 v50, v20, v21
    v_exp_f32 v26, v26
    v_exp_f32 v27, v27
    v_cvt_pk_bf16_f32 v51, v22, v23
    v_exp_f32 v28, v28
    v_cvt_pk_bf16_f32 v52, v24, v25
    v_exp_f32 v29, v29
    v_cvt_pk_bf16_f32 v53, v26, v27
    v_exp_f32 v30, v30
    v_exp_f32 v31, v31
    v_cvt_pk_bf16_f32 v54, v28, v29
    v_cvt_pk_bf16_f32 v55, v30, v31
    v_mfma_f32_32x32x16_bf16 v[192:207], v[152:155], v[48:51], v[192:207]
    global_load_dwordx4 a[124:127], v104, s[28:29] offset:-1024
    v_exp_f32 v32, v32
    v_exp_f32 v33, v33
    v_exp_f32 v34, v34
    v_exp_f32 v35, v35
    v_mfma_f32_32x32x16_bf16 v[16:31], v[136:139], v[224:227], 0
    global_load_dwordx4 a[240:243], v105, s[28:29] offset:-4096
    v_exp_f32 v36, v36
    v_exp_f32 v37, v37
    v_cvt_pk_bf16_f32 v48, v32, v33
    v_exp_f32 v38, v38
    v_exp_f32 v39, v39
    v_mfma_f32_32x32x16_bf16 v[192:207], v[156:159], v[52:55], v[192:207]
    global_load_dwordx4 a[244:247], v105, s[28:29] offset:-3072
    v_cvt_pk_bf16_f32 v49, v34, v35
    v_exp_f32 v40, v40
    v_exp_f32 v41, v41
    v_cvt_pk_bf16_f32 v50, v36, v37
    v_exp_f32 v42, v42
    v_exp_f32 v43, v43
    v_cvt_pk_bf16_f32 v51, v38, v39
    v_exp_f32 v44, v44
    v_cvt_pk_bf16_f32 v52, v40, v41
    v_exp_f32 v45, v45
    v_cvt_pk_bf16_f32 v53, v42, v43
    v_exp_f32 v46, v46
    v_exp_f32 v47, v47
    v_cvt_pk_bf16_f32 v54, v44, v45
    v_cvt_pk_bf16_f32 v55, v46, v47
    v_mfma_f32_32x32x16_bf16 v[208:223], v[152:155], v[48:51], v[208:223]
    global_load_dwordx4 a[248:251], v105, s[28:29] offset:-2048
    v_exp_f32 v16, v16
    v_exp_f32 v17, v17
    v_exp_f32 v18, v18
    v_exp_f32 v19, v19
    v_mfma_f32_32x32x16_bf16 v[32:47], v[136:139], v[228:231], 0
    global_load_dwordx4 a[252:255], v105, s[28:29] offset:-1024
    v_exp_f32 v20, v20
    v_exp_f32 v21, v21
    v_cvt_pk_bf16_f32 v48, v16, v17
    v_exp_f32 v22, v22
    v_exp_f32 v23, v23
    v_mfma_f32_32x32x16_bf16 v[208:223], v[156:159], v[52:55], v[208:223]
    ds_read_b128 v[76:79], v106 offset:33024
    v_cvt_pk_bf16_f32 v49, v18, v19
    v_exp_f32 v24, v24
    v_exp_f32 v25, v25
    v_cvt_pk_bf16_f32 v50, v20, v21
    v_exp_f32 v26, v26
    v_exp_f32 v27, v27
    v_cvt_pk_bf16_f32 v51, v22, v23
    v_exp_f32 v28, v28
    v_cvt_pk_bf16_f32 v52, v24, v25
    v_exp_f32 v29, v29
    v_cvt_pk_bf16_f32 v53, v26, v27
    v_exp_f32 v30, v30
    v_exp_f32 v31, v31
    v_cvt_pk_bf16_f32 v54, v28, v29
    v_cvt_pk_bf16_f32 v55, v30, v31
    v_mfma_f32_32x32x16_bf16 v[160:175], v[140:143], v[48:51], v[160:175]
    ds_read_b128 v[148:151], v4 offset:22704
    v_exp_f32 v32, v32
    v_exp_f32 v33, v33
    v_exp_f32 v34, v34
    v_exp_f32 v35, v35
    v_mfma_f32_32x32x16_bf16 v[16:31], v[136:139], v[232:235], 0
    ds_read_b128 v[152:155], v5 offset:22704
    v_exp_f32 v36, v36
    v_exp_f32 v37, v37
    v_cvt_pk_bf16_f32 v48, v32, v33
    v_exp_f32 v38, v38
    v_exp_f32 v39, v39
    v_mfma_f32_32x32x16_bf16 v[160:175], v[144:147], v[52:55], v[160:175]
    ds_read_b128 v[156:159], v6 offset:22704
    v_cvt_pk_bf16_f32 v49, v34, v35
    v_exp_f32 v40, v40
    v_exp_f32 v41, v41
    v_cvt_pk_bf16_f32 v50, v36, v37
    v_exp_f32 v42, v42
    v_exp_f32 v43, v43
    v_cvt_pk_bf16_f32 v51, v38, v39
    v_exp_f32 v44, v44
    v_cvt_pk_bf16_f32 v52, v40, v41
    v_exp_f32 v45, v45
    v_cvt_pk_bf16_f32 v53, v42, v43
    v_exp_f32 v46, v46
    v_exp_f32 v47, v47
    v_cvt_pk_bf16_f32 v54, v44, v45
    v_cvt_pk_bf16_f32 v55, v46, v47
    v_mfma_f32_32x32x16_bf16 v[176:191], v[140:143], v[48:51], v[176:191]
    ds_read_b128 v[80:83], v106 offset:33056
    v_exp_f32 v16, v16
    v_exp_f32 v17, v17
    v_exp_f32 v18, v18
    v_exp_f32 v19, v19
    v_mfma_f32_32x32x16_bf16 v[32:47], v[136:139], v[236:239], 0
    s_waitcnt lgkmcnt(1)
    v_max3_u32 v240, v148, v152, v156
    v_cmp_eq_u32 vcc, -1, v240
    v_exp_f32 v20, v20
    v_exp_f32 v21, v21
    v_cvt_pk_bf16_f32 v48, v16, v17
    v_exp_f32 v22, v22
    v_exp_f32 v23, v23
    v_mfma_f32_32x32x16_bf16 v[176:191], v[144:147], v[52:55], v[176:191]
    s_cbranch_vccnz adaLN_cond__grouped_kv_mqa__dense_activation_silu__prompt_kernel_kvs72
adaLN_cond__grouped_kv_mqa__dense_activation_silu__prompt_kernel_kvb74:
    v_cvt_pk_bf16_f32 v49, v18, v19
    v_exp_f32 v24, v24
    v_exp_f32 v25, v25
    v_cvt_pk_bf16_f32 v50, v20, v21
    v_exp_f32 v26, v26
    v_exp_f32 v27, v27
    v_cvt_pk_bf16_f32 v51, v22, v23
    v_exp_f32 v28, v28
    v_cvt_pk_bf16_f32 v52, v24, v25
    v_exp_f32 v29, v29
    v_cvt_pk_bf16_f32 v53, v26, v27
    v_exp_f32 v30, v30
    v_exp_f32 v31, v31
    v_cvt_pk_bf16_f32 v54, v28, v29
    v_cvt_pk_bf16_f32 v55, v30, v31
    v_mfma_f32_32x32x16_bf16 v[192:207], v[140:143], v[48:51], v[192:207]
    ds_read_b128 v[84:87], v106 offset:33088
    v_exp_f32 v32, v32
    v_exp_f32 v33, v33
    s_waitcnt vmcnt(8)
    v_cmp_eq_u32 vcc, -1, v134
    v_exp_f32 v34, v34
    v_exp_f32 v35, v35
    v_mfma_f32_32x32x16_bf16 v[16:31], v[148:151], v[224:227], 0
    ds_read_b128 v[88:91], v106 offset:33120
    v_exp_f32 v36, v36
    v_exp_f32 v37, v37
    v_cvt_pk_bf16_f32 v48, v32, v33
    s_cbranch_vccnz adaLN_cond__grouped_kv_mqa__dense_activation_silu__prompt_kernel_st98
adaLN_cond__grouped_kv_mqa__dense_activation_silu__prompt_kernel_bk99:
    v_cmp_ne_u32 s[98:99], s100, v134
    v_exp_f32 v38, v38
    v_exp_f32 v39, v39
    v_mfma_f32_32x32x16_bf16 v[192:207], v[144:147], v[52:55], v[192:207]
    global_load_dwordx4 a[0:3], v0, s[28:29] offset:-4096
    v_cvt_pk_bf16_f32 v49, v34, v35
    v_exp_f32 v40, v40
    v_exp_f32 v41, v41
    v_cvt_pk_bf16_f32 v50, v36, v37
    v_exp_f32 v42, v42
    v_exp_f32 v43, v43
    v_cvt_pk_bf16_f32 v51, v38, v39
    v_exp_f32 v44, v44
    v_cvt_pk_bf16_f32 v52, v40, v41
    v_exp_f32 v45, v45
    v_cvt_pk_bf16_f32 v53, v42, v43
    v_exp_f32 v46, v46
    v_exp_f32 v47, v47
    v_cvt_pk_bf16_f32 v54, v44, v45
    v_cvt_pk_bf16_f32 v55, v46, v47
    v_mfma_f32_32x32x16_bf16 v[208:223], v[140:143], v[48:51], v[208:223]
    global_load_dwordx4 a[4:7], v0, s[28:29] offset:-3072
    v_exp_f32 v16, v16
    v_exp_f32 v17, v17
    v_exp_f32 v18, v18
    v_exp_f32 v19, v19
    v_mfma_f32_32x32x16_bf16 v[32:47], v[148:151], v[228:231], 0
    global_load_dwordx4 a[8:11], v0, s[28:29] offset:-2048
    v_exp_f32 v20, v20
    v_exp_f32 v21, v21
    v_cvt_pk_bf16_f32 v48, v16, v17
    v_exp_f32 v22, v22
    v_exp_f32 v23, v23
    v_mfma_f32_32x32x16_bf16 v[208:223], v[144:147], v[52:55], v[208:223]
    global_load_dwordx4 a[12:15], v0, s[28:29] offset:-1024
    v_cvt_pk_bf16_f32 v49, v18, v19
    v_exp_f32 v24, v24
    v_exp_f32 v25, v25
    v_cvt_pk_bf16_f32 v50, v20, v21
    v_exp_f32 v26, v26
    v_exp_f32 v27, v27
    v_cvt_pk_bf16_f32 v51, v22, v23
    v_exp_f32 v28, v28
    v_cvt_pk_bf16_f32 v52, v24, v25
    v_exp_f32 v29, v29
    v_cvt_pk_bf16_f32 v53, v26, v27
    v_exp_f32 v30, v30
    v_exp_f32 v31, v31
    v_cvt_pk_bf16_f32 v54, v28, v29
    v_cvt_pk_bf16_f32 v55, v30, v31
    v_mfma_f32_32x32x16_bf16 v[160:175], v[152:155], v[48:51], v[160:175]
    ds_read_b128 v[136:139], v4 offset:24768
    v_exp_f32 v32, v32
    v_exp_f32 v33, v33
    v_exp_f32 v34, v34
    v_exp_f32 v35, v35
    v_mfma_f32_32x32x16_bf16 v[16:31], v[148:151], v[232:235], 0
    ds_read_b128 v[140:143], v5 offset:24768
    v_exp_f32 v36, v36
    v_exp_f32 v37, v37
    v_cvt_pk_bf16_f32 v48, v32, v33
    v_exp_f32 v38, v38
    v_exp_f32 v39, v39
    v_mfma_f32_32x32x16_bf16 v[160:175], v[156:159], v[52:55], v[160:175]
    ds_read_b128 v[144:147], v6 offset:24768
    v_cvt_pk_bf16_f32 v49, v34, v35
    v_exp_f32 v40, v40
    v_exp_f32 v41, v41
    v_cvt_pk_bf16_f32 v50, v36, v37
    v_exp_f32 v42, v42
    v_exp_f32 v43, v43
    v_cvt_pk_bf16_f32 v51, v38, v39
    v_exp_f32 v44, v44
    v_cvt_pk_bf16_f32 v52, v40, v41
    v_exp_f32 v45, v45
    v_cvt_pk_bf16_f32 v53, v42, v43
    v_exp_f32 v46, v46
    v_exp_f32 v47, v47
    v_cvt_pk_bf16_f32 v54, v44, v45
    v_cvt_pk_bf16_f32 v55, v46, v47
    v_mfma_f32_32x32x16_bf16 v[176:191], v[152:155], v[48:51], v[176:191]
    s_cmp_lg_u64 s[98:99], 0
    s_cbranch_scc1 adaLN_cond__grouped_kv_mqa__dense_activation_silu__prompt_kernel_alt101
    global_store_dword v15, v1, s[28:29] offset:-4096
adaLN_cond__grouped_kv_mqa__dense_activation_silu__prompt_kernel_bk102:
    v_exp_f32 v16, v16
    v_exp_f32 v17, v17
    v_exp_f32 v18, v18
    v_exp_f32 v19, v19
    v_mfma_f32_32x32x16_bf16 v[32:47], v[148:151], v[236:239], 0
    s_waitcnt lgkmcnt(0)
    v_max3_u32 v240, v136, v140, v144
    v_cmp_eq_u32 vcc, -1, v240
    v_exp_f32 v20, v20
    v_exp_f32 v21, v21
    v_cvt_pk_bf16_f32 v48, v16, v17
    v_exp_f32 v22, v22
    v_exp_f32 v23, v23
    v_mfma_f32_32x32x16_bf16 v[176:191], v[156:159], v[52:55], v[176:191]
    s_cbranch_vccnz adaLN_cond__grouped_kv_mqa__dense_activation_silu__prompt_kernel_kvs76
adaLN_cond__grouped_kv_mqa__dense_activation_silu__prompt_kernel_kvb78:
    v_cvt_pk_bf16_f32 v49, v18, v19
    v_exp_f32 v24, v24
    v_exp_f32 v25, v25
    v_cvt_pk_bf16_f32 v50, v20, v21
    v_exp_f32 v26, v26
    v_exp_f32 v27, v27
    v_cvt_pk_bf16_f32 v51, v22, v23
    v_exp_f32 v28, v28
    v_cvt_pk_bf16_f32 v52, v24, v25
    v_exp_f32 v29, v29
    v_cvt_pk_bf16_f32 v53, v26, v27
    v_exp_f32 v30, v30
    v_exp_f32 v31, v31
    v_cvt_pk_bf16_f32 v54, v28, v29
    v_cvt_pk_bf16_f32 v55, v30, v31
    v_mfma_f32_32x32x16_bf16 v[192:207], v[152:155], v[48:51], v[192:207]
    global_load_dwordx4 a[16:19], v0, s[28:29] offset:0
    v_exp_f32 v32, v32
    v_exp_f32 v33, v33
    v_exp_f32 v34, v34
    v_exp_f32 v35, v35
    v_mfma_f32_32x32x16_bf16 v[16:31], v[136:139], v[224:227], 0
    global_load_dwordx4 a[20:23], v0, s[28:29] offset:1024
    v_exp_f32 v36, v36
    v_exp_f32 v37, v37
    v_cvt_pk_bf16_f32 v48, v32, v33
    v_exp_f32 v38, v38
    v_exp_f32 v39, v39
    v_mfma_f32_32x32x16_bf16 v[192:207], v[156:159], v[52:55], v[192:207]
    global_load_dwordx4 a[24:27], v0, s[28:29] offset:2048
    v_cvt_pk_bf16_f32 v49, v34, v35
    v_exp_f32 v40, v40
    v_exp_f32 v41, v41
    v_cvt_pk_bf16_f32 v50, v36, v37
    v_exp_f32 v42, v42
    v_exp_f32 v43, v43
    v_cvt_pk_bf16_f32 v51, v38, v39
    v_exp_f32 v44, v44
    v_cvt_pk_bf16_f32 v52, v40, v41
    v_exp_f32 v45, v45
    v_cvt_pk_bf16_f32 v53, v42, v43
    v_exp_f32 v46, v46
    v_exp_f32 v47, v47
    v_cvt_pk_bf16_f32 v54, v44, v45
    v_cvt_pk_bf16_f32 v55, v46, v47
    v_mfma_f32_32x32x16_bf16 v[208:223], v[152:155], v[48:51], v[208:223]
    global_load_dwordx4 a[28:31], v0, s[28:29] offset:3072
    v_add_u32 v0, 0x2000, v0
    v_exp_f32 v16, v16
    v_exp_f32 v17, v17
    v_exp_f32 v18, v18
    v_exp_f32 v19, v19
    v_mfma_f32_32x32x16_bf16 v[32:47], v[136:139], v[228:231], 0
    global_load_dwordx4 a[32:35], v0, s[28:29] offset:-4096
    v_exp_f32 v20, v20
    v_exp_f32 v21, v21
    v_cvt_pk_bf16_f32 v48, v16, v17
    v_exp_f32 v22, v22
    v_exp_f32 v23, v23
    v_mfma_f32_32x32x16_bf16 v[208:223], v[156:159], v[52:55], v[208:223]
    global_load_dwordx4 a[36:39], v0, s[28:29] offset:-3072
    v_cvt_pk_bf16_f32 v49, v18, v19
    v_exp_f32 v24, v24
    v_exp_f32 v25, v25
    v_cvt_pk_bf16_f32 v50, v20, v21
    s_waitcnt vmcnt(11)
    v_mfma_f32_16x16x32_bf16 v[92:95], v[76:79], a[112:115], 0
    v_exp_f32 v26, v26
    v_exp_f32 v27, v27
    v_cvt_pk_bf16_f32 v51, v22, v23
    v_exp_f32 v28, v28
    v_cvt_pk_bf16_f32 v52, v24, v25
    v_exp_f32 v29, v29
    v_mfma_f32_16x16x32_bf16 v[100:103], v[76:79], a[240:243], 0
    v_cvt_pk_bf16_f32 v53, v26, v27
    v_exp_f32 v30, v30
    v_exp_f32 v31, v31
    v_cvt_pk_bf16_f32 v54, v28, v29
    v_cvt_pk_bf16_f32 v55, v30, v31
    v_mfma_f32_32x32x16_bf16 v[160:175], v[140:143], v[48:51], v[160:175]
    ds_read_b128 v[148:151], v4 offset:26832
    v_exp_f32 v32, v32
    v_exp_f32 v33, v33
    v_exp_f32 v34, v34
    v_exp_f32 v35, v35
    v_mfma_f32_32x32x16_bf16 v[16:31], v[136:139], v[232:235], 0
    ds_read_b128 v[152:155], v5 offset:26832
    v_exp_f32 v36, v36
    v_exp_f32 v37, v37
    v_cvt_pk_bf16_f32 v48, v32, v33
    v_exp_f32 v38, v38
    v_exp_f32 v39, v39
    v_mfma_f32_32x32x16_bf16 v[160:175], v[144:147], v[52:55], v[160:175]
    ds_read_b128 v[156:159], v6 offset:26832
    v_cvt_pk_bf16_f32 v49, v34, v35
    v_exp_f32 v40, v40
    v_exp_f32 v41, v41
    v_cvt_pk_bf16_f32 v50, v36, v37
    v_mfma_f32_16x16x32_bf16 v[92:95], v[80:83], a[116:119], v[92:95]
    global_load_dwordx4 a[40:43], v0, s[28:29] offset:-2048
    v_exp_f32 v42, v42
    v_exp_f32 v43, v43
    v_cvt_pk_bf16_f32 v51, v38, v39
    v_exp_f32 v44, v44
    v_cvt_pk_bf16_f32 v52, v40, v41
    v_exp_f32 v45, v45
    v_mfma_f32_16x16x32_bf16 v[100:103], v[80:83], a[244:247], v[100:103]
    global_load_dwordx4 a[44:47], v0, s[28:29] offset:-1024
    v_cvt_pk_bf16_f32 v53, v42, v43
    v_exp_f32 v46, v46
    v_exp_f32 v47, v47
    v_cvt_pk_bf16_f32 v54, v44, v45
    v_cvt_pk_bf16_f32 v55, v46, v47
    v_mfma_f32_32x32x16_bf16 v[176:191], v[140:143], v[48:51], v[176:191]
    global_load_dwordx4 a[48:51], v0, s[28:29] offset:0
    v_exp_f32 v16, v16
    v_exp_f32 v17, v17
    v_exp_f32 v18, v18
    v_exp_f32 v19, v19
    v_mfma_f32_32x32x16_bf16 v[32:47], v[136:139], v[236:239], 0
    s_waitcnt lgkmcnt(0)
    v_max3_u32 v240, v148, v152, v156
    v_cmp_eq_u32 vcc, -1, v240
    v_exp_f32 v20, v20
    v_exp_f32 v21, v21
    v_cvt_pk_bf16_f32 v48, v16, v17
    v_exp_f32 v22, v22
    v_exp_f32 v23, v23
    v_mfma_f32_32x32x16_bf16 v[176:191], v[144:147], v[52:55], v[176:191]
    s_cbranch_vccnz adaLN_cond__grouped_kv_mqa__dense_activation_silu__prompt_kernel_kvs80
adaLN_cond__grouped_kv_mqa__dense_activation_silu__prompt_kernel_kvb82:
    v_cvt_pk_bf16_f32 v49, v18, v19
    v_exp_f32 v24, v24
    v_exp_f32 v25, v25
    v_cvt_pk_bf16_f32 v50, v20, v21
    v_mfma_f32_16x16x32_bf16 v[92:95], v[84:87], a[120:123], v[92:95]
    global_load_dwordx4 a[52:55], v0, s[28:29] offset:1024
    v_exp_f32 v26, v26
    v_exp_f32 v27, v27
    v_cvt_pk_bf16_f32 v51, v22, v23
    v_exp_f32 v28, v28
    v_cvt_pk_bf16_f32 v52, v24, v25
    v_exp_f32 v29, v29
    v_mfma_f32_16x16x32_bf16 v[100:103], v[84:87], a[248:251], v[100:103]
    global_load_dwordx4 a[56:59], v0, s[28:29] offset:2048
    v_cvt_pk_bf16_f32 v53, v26, v27
    v_exp_f32 v30, v30
    v_exp_f32 v31, v31
    v_cvt_pk_bf16_f32 v54, v28, v29
    v_cvt_pk_bf16_f32 v55, v30, v31
    v_mfma_f32_32x32x16_bf16 v[192:207], v[140:143], v[48:51], v[192:207]
    global_load_dwordx4 a[60:63], v0, s[28:29] offset:3072
    v_add_u32 v0, 0x2000, v0
    v_exp_f32 v32, v32
    v_exp_f32 v33, v33
    v_exp_f32 v34, v34
    v_exp_f32 v35, v35
    v_mfma_f32_32x32x16_bf16 v[16:31], v[148:151], v[224:227], 0
    global_load_dwordx4 a[64:67], v0, s[28:29] offset:-4096
    v_exp_f32 v36, v36
    v_exp_f32 v37, v37
    v_cvt_pk_bf16_f32 v48, v32, v33
    v_exp_f32 v38, v38
    v_exp_f32 v39, v39
    v_mfma_f32_32x32x16_bf16 v[192:207], v[144:147], v[52:55], v[192:207]
    global_load_dwordx4 a[68:71], v0, s[28:29] offset:-3072
    v_cvt_pk_bf16_f32 v49, v34, v35
    v_exp_f32 v40, v40
    v_exp_f32 v41, v41
    v_cvt_pk_bf16_f32 v50, v36, v37
    v_mfma_f32_16x16x32_bf16 v[92:95], v[88:91], a[124:127], v[92:95]
    v_exp_f32 v42, v42
    v_exp_f32 v43, v43
    v_cvt_pk_bf16_f32 v51, v38, v39
    v_exp_f32 v44, v44
    v_cvt_pk_bf16_f32 v52, v40, v41
    v_exp_f32 v45, v45
    v_mfma_f32_16x16x32_bf16 v[100:103], v[88:91], a[252:255], v[100:103]
    v_cvt_pk_bf16_f32 v53, v42, v43
    v_exp_f32 v46, v46
    v_exp_f32 v47, v47
    v_cvt_pk_bf16_f32 v54, v44, v45
    v_cvt_pk_bf16_f32 v55, v46, v47
    v_mfma_f32_32x32x16_bf16 v[208:223], v[140:143], v[48:51], v[208:223]
    global_load_dwordx4 a[72:75], v0, s[28:29] offset:-2048
    v_exp_f32 v16, v16
    v_exp_f32 v17, v17
    v_exp_f32 v18, v18
    v_exp_f32 v19, v19
    v_mfma_f32_32x32x16_bf16 v[32:47], v[148:151], v[228:231], 0
    global_store_dword v107, v92, s[28:29] offset:0 sc1
    v_exp_f32 v20, v20
    v_exp_f32 v21, v21
    v_cvt_pk_bf16_f32 v48, v16, v17
    v_exp_f32 v22, v22
    v_exp_f32 v23, v23
    v_mfma_f32_32x32x16_bf16 v[208:223], v[144:147], v[52:55], v[208:223]
    global_store_dword v107, v100, s[28:29] offset:2048 sc1
    v_cvt_pk_bf16_f32 v49, v18, v19
    v_exp_f32 v24, v24
    v_exp_f32 v25, v25
    v_cvt_pk_bf16_f32 v50, v20, v21
    v_exp_f32 v26, v26
    v_exp_f32 v27, v27
    v_cvt_pk_bf16_f32 v51, v22, v23
    v_exp_f32 v28, v28
    v_cvt_pk_bf16_f32 v52, v24, v25
    v_exp_f32 v29, v29
    v_cvt_pk_bf16_f32 v53, v26, v27
    v_exp_f32 v30, v30
    v_exp_f32 v31, v31
    v_cvt_pk_bf16_f32 v54, v28, v29
    v_cvt_pk_bf16_f32 v55, v30, v31
    v_mfma_f32_32x32x16_bf16 v[160:175], v[152:155], v[48:51], v[160:175]
    ds_read_b128 v[136:139], v4 offset:28896
    v_exp_f32 v32, v32
    v_exp_f32 v33, v33
    v_exp_f32 v34, v34
    v_exp_f32 v35, v35
    v_mfma_f32_32x32x16_bf16 v[16:31], v[148:151], v[232:235], 0
    ds_read_b128 v[140:143], v5 offset:28896
    v_exp_f32 v36, v36
    v_exp_f32 v37, v37
    v_cvt_pk_bf16_f32 v48, v32, v33
    v_exp_f32 v38, v38
    v_exp_f32 v39, v39
    v_mfma_f32_32x32x16_bf16 v[160:175], v[156:159], v[52:55], v[160:175]
    ds_read_b128 v[144:147], v6 offset:28896
    v_cvt_pk_bf16_f32 v49, v34, v35
    v_exp_f32 v40, v40
    v_exp_f32 v41, v41
    v_cvt_pk_bf16_f32 v50, v36, v37
    v_exp_f32 v42, v42
    v_exp_f32 v43, v43
    v_cvt_pk_bf16_f32 v51, v38, v39
    v_exp_f32 v44, v44
    v_cvt_pk_bf16_f32 v52, v40, v41
    v_exp_f32 v45, v45
    v_cvt_pk_bf16_f32 v53, v42, v43
    v_exp_f32 v46, v46
    v_exp_f32 v47, v47
    v_cvt_pk_bf16_f32 v54, v44, v45
    v_cvt_pk_bf16_f32 v55, v46, v47
    v_mfma_f32_32x32x16_bf16 v[176:191], v[152:155], v[48:51], v[176:191]
    global_load_dwordx4 a[76:79], v0, s[28:29] offset:-1024
    v_exp_f32 v16, v16
    v_exp_f32 v17, v17
    v_exp_f32 v18, v18
    v_exp_f32 v19, v19
    v_mfma_f32_32x32x16_bf16 v[32:47], v[148:151], v[236:239], 0
    s_waitcnt lgkmcnt(0)
    v_max3_u32 v240, v136, v140, v144
    v_cmp_eq_u32 vcc, -1, v240
    v_exp_f32 v20, v20
    v_exp_f32 v21, v21
    v_cvt_pk_bf16_f32 v48, v16, v17
    v_exp_f32 v22, v22
    v_exp_f32 v23, v23
    v_mfma_f32_32x32x16_bf16 v[176:191], v[156:159], v[52:55], v[176:191]
    s_cbranch_vccnz adaLN_cond__grouped_kv_mqa__dense_activation_silu__prompt_kernel_kvs84
adaLN_cond__grouped_kv_mqa__dense_activation_silu__prompt_kernel_kvb86:
    v_cvt_pk_bf16_f32 v49, v18, v19
    v_exp_f32 v24, v24
    v_exp_f32 v25, v25
    v_cvt_pk_bf16_f32 v50, v20, v21
    v_exp_f32 v26, v26
    v_exp_f32 v27, v27
    v_cvt_pk_bf16_f32 v51, v22, v23
    v_exp_f32 v28, v28
    v_cvt_pk_bf16_f32 v52, v24, v25
    v_exp_f32 v29, v29
    v_cvt_pk_bf16_f32 v53, v26, v27
    v_exp_f32 v30, v30
    v_exp_f32 v31, v31
    v_cvt_pk_bf16_f32 v54, v28, v29
    v_cvt_pk_bf16_f32 v55, v30, v31
    v_mfma_f32_32x32x16_bf16 v[192:207], v[152:155], v[48:51], v[192:207]
    global_load_dwordx4 a[80:83], v0, s[28:29] offset:0
    v_exp_f32 v32, v32
    v_exp_f32 v33, v33
    v_exp_f32 v34, v34
    v_exp_f32 v35, v35
    v_mfma_f32_32x32x16_bf16 v[16:31], v[136:139], v[224:227], 0
    global_load_dwordx4 a[84:87], v0, s[28:29] offset:1024
    v_exp_f32 v36, v36
    v_exp_f32 v37, v37
    v_cvt_pk_bf16_f32 v48, v32, v33
    v_exp_f32 v38, v38
    v_exp_f32 v39, v39
    v_mfma_f32_32x32x16_bf16 v[192:207], v[156:159], v[52:55], v[192:207]
    global_load_dwordx4 a[88:91], v0, s[28:29] offset:2048
    v_cvt_pk_bf16_f32 v49, v34, v35
    v_exp_f32 v40, v40
    v_exp_f32 v41, v41
    v_cvt_pk_bf16_f32 v50, v36, v37
    v_exp_f32 v42, v42
    v_exp_f32 v43, v43
    v_cvt_pk_bf16_f32 v51, v38, v39
    v_exp_f32 v44, v44
    v_cvt_pk_bf16_f32 v52, v40, v41
    v_exp_f32 v45, v45
    v_cvt_pk_bf16_f32 v53, v42, v43
    v_exp_f32 v46, v46
    v_exp_f32 v47, v47
    v_cvt_pk_bf16_f32 v54, v44, v45
    v_cvt_pk_bf16_f32 v55, v46, v47
    v_mfma_f32_32x32x16_bf16 v[208:223], v[152:155], v[48:51], v[208:223]
    global_load_dwordx4 a[92:95], v0, s[28:29] offset:3072
    v_add_u32 v0, 0x2000, v0
    v_exp_f32 v16, v16
    v_exp_f32 v17, v17
    v_exp_f32 v18, v18
    v_exp_f32 v19, v19
    v_mfma_f32_32x32x16_bf16 v[32:47], v[136:139], v[228:231], 0
    global_load_dwordx4 a[96:99], v0, s[28:29] offset:-4096
    v_exp_f32 v20, v20
    v_exp_f32 v21, v21
    v_cvt_pk_bf16_f32 v48, v16, v17
    v_exp_f32 v22, v22
    v_exp_f32 v23, v23
    v_mfma_f32_32x32x16_bf16 v[208:223], v[156:159], v[52:55], v[208:223]
    global_load_dwordx4 a[100:103], v0, s[28:29] offset:-3072
    v_cvt_pk_bf16_f32 v49, v18, v19
    v_exp_f32 v24, v24
    v_exp_f32 v25, v25
    v_cvt_pk_bf16_f32 v50, v20, v21
    v_exp_f32 v26, v26
    v_exp_f32 v27, v27
    v_cvt_pk_bf16_f32 v51, v22, v23
    v_exp_f32 v28, v28
    v_cvt_pk_bf16_f32 v52, v24, v25
    v_exp_f32 v29, v29
    v_cvt_pk_bf16_f32 v53, v26, v27
    v_exp_f32 v30, v30
    v_exp_f32 v31, v31
    v_cvt_pk_bf16_f32 v54, v28, v29
    v_cvt_pk_bf16_f32 v55, v30, v31
    v_mfma_f32_32x32x16_bf16 v[160:175], v[140:143], v[48:51], v[160:175]
    ds_read_b128 v[148:151], v4 offset:30960
    v_exp_f32 v32, v32
    v_exp_f32 v33, v33
    v_exp_f32 v34, v34
    v_exp_f32 v35, v35
    v_mfma_f32_32x32x16_bf16 v[16:31], v[136:139], v[232:235], 0
    ds_read_b128 v[152:155], v5 offset:30960
    v_exp_f32 v36, v36
    v_exp_f32 v37, v37
    v_cvt_pk_bf16_f32 v48, v32, v33
    v_exp_f32 v38, v38
    v_exp_f32 v39, v39
    v_mfma_f32_32x32x16_bf16 v[160:175], v[144:147], v[52:55], v[160:175]
    ds_read_b128 v[156:159], v6 offset:30960
    v_cvt_pk_bf16_f32 v49, v34, v35
    v_exp_f32 v40, v40
    v_exp_f32 v41, v41
    v_cvt_pk_bf16_f32 v50, v36, v37
    v_exp_f32 v42, v42
    v_exp_f32 v43, v43
    v_cvt_pk_bf16_f32 v51, v38, v39
    v_exp_f32 v44, v44
    v_cvt_pk_bf16_f32 v52, v40, v41
    v_exp_f32 v45, v45
    v_cvt_pk_bf16_f32 v53, v42, v43
    v_exp_f32 v46, v46
    v_exp_f32 v47, v47
    v_cvt_pk_bf16_f32 v54, v44, v45
    v_cvt_pk_bf16_f32 v55, v46, v47
    v_mfma_f32_32x32x16_bf16 v[176:191], v[140:143], v[48:51], v[176:191]
    global_load_dwordx4 a[104:107], v0, s[28:29] offset:-2048
    v_exp_f32 v16, v16
    v_exp_f32 v17, v17
    v_exp_f32 v18, v18
    v_exp_f32 v19, v19
    v_mfma_f32_32x32x16_bf16 v[32:47], v[136:139], v[236:239], 0
    s_waitcnt lgkmcnt(0)
    v_max3_u32 v240, v148, v152, v156
    v_cmp_eq_u32 vcc, -1, v240
    v_exp_f32 v20, v20
    v_exp_f32 v21, v21
    v_cvt_pk_bf16_f32 v48, v16, v17
    v_exp_f32 v22, v22
    v_exp_f32 v23, v23
    v_mfma_f32_32x32x16_bf16 v[176:191], v[144:147], v[52:55], v[176:191]
    s_cbranch_vccnz adaLN_cond__grouped_kv_mqa__dense_activation_silu__prompt_kernel_kvs88
adaLN_cond__grouped_kv_mqa__dense_activation_silu__prompt_kernel_kvb90:
    v_cvt_pk_bf16_f32 v49, v18, v19
    v_exp_f32 v24, v24
    v_exp_f32 v25, v25
    v_cvt_pk_bf16_f32 v50, v20, v21
    v_exp_f32 v26, v26
    v_exp_f32 v27, v27
    v_cvt_pk_bf16_f32 v51, v22, v23
    v_exp_f32 v28, v28
    v_cvt_pk_bf16_f32 v52, v24, v25
    v_exp_f32 v29, v29
    v_cvt_pk_bf16_f32 v53, v26, v27
    v_exp_f32 v30, v30
    v_exp_f32 v31, v31
    v_cvt_pk_bf16_f32 v54, v28, v29
    v_cvt_pk_bf16_f32 v55, v30, v31
    v_mfma_f32_32x32x16_bf16 v[192:207], v[140:143], v[48:51], v[192:207]
    global_load_dwordx4 a[108:111], v0, s[28:29] offset:-1024
    v_add_u32 v0, s33, v0
    v_exp_f32 v32, v32
    v_exp_f32 v33, v33
    v_exp_f32 v34, v34
    v_exp_f32 v35, v35
    v_mfma_f32_32x32x16_bf16 v[16:31], v[148:151], v[224:227], 0
    global_load_dwordx4 a[128:131], v0, s[28:29] offset:-4096
    v_exp_f32 v36, v36
    v_exp_f32 v37, v37
    v_cvt_pk_bf16_f32 v48, v32, v33
    v_exp_f32 v38, v38
    v_exp_f32 v39, v39
    v_mfma_f32_32x32x16_bf16 v[192:207], v[144:147], v[52:55], v[192:207]
    global_load_dwordx4 a[132:135], v0, s[28:29] offset:-3072
    v_cvt_pk_bf16_f32 v49, v34, v35
    v_exp_f32 v40, v40
    v_exp_f32 v41, v41
    v_cvt_pk_bf16_f32 v50, v36, v37
    v_exp_f32 v42, v42
    v_exp_f32 v43, v43
    v_cvt_pk_bf16_f32 v51, v38, v39
    v_exp_f32 v44, v44
    v_cvt_pk_bf16_f32 v52, v40, v41
    v_exp_f32 v45, v45
    v_cvt_pk_bf16_f32 v53, v42, v43
    v_exp_f32 v46, v46
    v_exp_f32 v47, v47
    v_cvt_pk_bf16_f32 v54, v44, v45
    v_cvt_pk_bf16_f32 v55, v46, v47
    v_mfma_f32_32x32x16_bf16 v[208:223], v[140:143], v[48:51], v[208:223]
    global_load_dwordx4 a[136:139], v0, s[28:29] offset:-2048
    v_exp_f32 v16, v16
    v_exp_f32 v17, v17
    v_exp_f32 v18, v18
    v_exp_f32 v19, v19
    v_mfma_f32_32x32x16_bf16 v[32:47], v[148:151], v[228:231], 0
    global_load_dwordx4 a[140:143], v0, s[28:29] offset:-1024
    v_exp_f32 v20, v20
    v_exp_f32 v21, v21
    v_cvt_pk_bf16_f32 v48, v16, v17
    v_exp_f32 v22, v22
    v_exp_f32 v23, v23
    v_mfma_f32_32x32x16_bf16 v[208:223], v[144:147], v[52:55], v[208:223]
    global_load_dwordx4 a[144:147], v0, s[28:29] offset:0
    v_cvt_pk_bf16_f32 v49, v18, v19
    v_exp_f32 v24, v24
    v_exp_f32 v25, v25
    v_cvt_pk_bf16_f32 v50, v20, v21
    v_exp_f32 v26, v26
    v_exp_f32 v27, v27
    v_cvt_pk_bf16_f32 v51, v22, v23
    v_exp_f32 v28, v28
    v_cvt_pk_bf16_f32 v52, v24, v25
    v_exp_f32 v29, v29
    v_cvt_pk_bf16_f32 v53, v26, v27
    v_exp_f32 v30, v30
    v_exp_f32 v31, v31
    v_cvt_pk_bf16_f32 v54, v28, v29
    v_cvt_pk_bf16_f32 v55, v30, v31
    v_mfma_f32_32x32x16_bf16 v[160:175], v[152:155], v[48:51], v[160:175]
    ds_read_b128 v[136:139], v4 offset:0
    v_exp_f32 v32, v32
    v_exp_f32 v33, v33
    v_exp_f32 v34, v34
    v_exp_f32 v35, v35
    v_mfma_f32_32x32x16_bf16 v[16:31], v[148:151], v[232:235], 0
    ds_read_b128 v[140:143], v5 offset:0
    v_exp_f32 v36, v36
    v_exp_f32 v37, v37
    v_cvt_pk_bf16_f32 v48, v32, v33
    v_exp_f32 v38, v38
    v_exp_f32 v39, v39
    v_mfma_f32_32x32x16_bf16 v[160:175], v[156:159], v[52:55], v[160:175]
    ds_read_b128 v[144:147], v6 offset:0
    v_cvt_pk_bf16_f32 v49, v34, v35
    v_exp_f32 v40, v40
    v_exp_f32 v41, v41
    v_cvt_pk_bf16_f32 v50, v36, v37
    v_exp_f32 v42, v42
    v_exp_f32 v43, v43
    v_cvt_pk_bf16_f32 v51, v38, v39
    v_exp_f32 v44, v44
    v_cvt_pk_bf16_f32 v52, v40, v41
    v_exp_f32 v45, v45
    v_cvt_pk_bf16_f32 v53, v42, v43
    v_exp_f32 v46, v46
    v_exp_f32 v47, v47
    v_cvt_pk_bf16_f32 v54, v44, v45
    v_cvt_pk_bf16_f32 v55, v46, v47
    v_mfma_f32_32x32x16_bf16 v[176:191], v[152:155], v[48:51], v[176:191]
    global_load_dword v134, v133, s[28:29] offset:-4096 sc1
    v_exp_f32 v16, v16
    v_exp_f32 v17, v17
    v_exp_f32 v18, v18
    v_exp_f32 v19, v19
    v_mfma_f32_32x32x16_bf16 v[32:47], v[148:151], v[236:239], 0
    global_load_dwordx4 a[148:151], v0, s[28:29] offset:1024
    v_exp_f32 v20, v20
    v_exp_f32 v21, v21
    v_cvt_pk_bf16_f32 v48, v16, v17
    v_exp_f32 v22, v22
    v_exp_f32 v23, v23
    v_mfma_f32_32x32x16_bf16 v[176:191], v[156:159], v[52:55], v[176:191]
    global_load_dwordx4 a[152:155], v0, s[28:29] offset:2048
    v_cvt_pk_bf16_f32 v49, v18, v19
    v_exp_f32 v24, v24
    v_exp_f32 v25, v25
    v_cvt_pk_bf16_f32 v50, v20, v21
    v_exp_f32 v26, v26
    v_exp_f32 v27, v27
    v_cvt_pk_bf16_f32 v51, v22, v23
    v_exp_f32 v28, v28
    v_cvt_pk_bf16_f32 v52, v24, v25
    v_exp_f32 v29, v29
    v_cvt_pk_bf16_f32 v53, v26, v27
    v_exp_f32 v30, v30
    v_exp_f32 v31, v31
    v_cvt_pk_bf16_f32 v54, v28, v29
    v_cvt_pk_bf16_f32 v55, v30, v31
    v_mfma_f32_32x32x16_bf16 v[192:207], v[152:155], v[48:51], v[192:207]
    s_waitcnt lgkmcnt(0)
    v_exp_f32 v32, v32
    v_exp_f32 v33, v33
    v_exp_f32 v34, v34
    v_exp_f32 v35, v35
    v_mfma_f32_32x32x16_bf16 v[16:31], v[136:139], v[56:59], 0
    ds_write_b128 v10, v[184:187] offset:0
    v_exp_f32 v36, v36
    v_exp_f32 v37, v37
    v_cvt_pk_bf16_f32 v48, v32, v33
    v_exp_f32 v38, v38
    v_exp_f32 v39, v39
    v_mfma_f32_32x32x16_bf16 v[192:207], v[156:159], v[52:55], v[192:207]
    ds_write_b128 v10, v[188:191] offset:1024
    v_cvt_pk_bf16_f32 v49, v34, v35
    v_exp_f32 v40, v40
    v_exp_f32 v41, v41
    v_cvt_pk_bf16_f32 v50, v36, v37
    v_exp_f32 v42, v42
    v_exp_f32 v43, v43
    v_cvt_pk_bf16_f32 v51, v38, v39
    v_exp_f32 v44, v44
    v_cvt_pk_bf16_f32 v52, v40, v41
    v_exp_f32 v45, v45
    v_cvt_pk_bf16_f32 v53, v42, v43
    v_exp_f32 v46, v46
    v_exp_f32 v47, v47
    v_cvt_pk_bf16_f32 v54, v44, v45
    v_cvt_pk_bf16_f32 v55, v46, v47
    v_mfma_f32_32x32x16_bf16 v[208:223], v[152:155], v[48:51], v[208:223]
    ds_write_b32 v10, v176 offset:6144
    v_exp_f32 v16, v16
    v_exp_f32 v17, v17
    v_exp_f32 v18, v18
    v_exp_f32 v19, v19
    v_mfma_f32_32x32x16_bf16 v[32:47], v[136:139], v[60:63], 0
    ds_write_b128 v11, v[200:203] offset:2048
    v_exp_f32 v20, v20
    v_exp_f32 v21, v21
    v_cvt_pk_bf16_f32 v48, v16, v17
    v_exp_f32 v22, v22
    v_exp_f32 v23, v23
    v_mfma_f32_32x32x16_bf16 v[208:223], v[156:159], v[52:55], v[208:223]
    ds_write_b128 v11, v[204:207] offset:3072
    v_cvt_pk_bf16_f32 v49, v18, v19
    v_exp_f32 v24, v24
    v_exp_f32 v25, v25
    v_cvt_pk_bf16_f32 v50, v20, v21
    v_exp_f32 v26, v26
    v_exp_f32 v27, v27
    v_cvt_pk_bf16_f32 v51, v22, v23
    v_exp_f32 v28, v28
    v_cvt_pk_bf16_f32 v52, v24, v25
    v_exp_f32 v29, v29
    v_cvt_pk_bf16_f32 v53, v26, v27
    v_exp_f32 v30, v30
    v_exp_f32 v31, v31
    v_cvt_pk_bf16_f32 v54, v28, v29
    v_cvt_pk_bf16_f32 v55, v30, v31
    v_mfma_f32_32x32x16_bf16 v[72:87], v[140:143], v[48:51], 0
    ds_read_b128 v[148:151], v4 offset:2064
    v_exp_f32 v32, v32
    v_exp_f32 v33, v33
    v_exp_f32 v34, v34
    v_exp_f32 v35, v35
    v_mfma_f32_32x32x16_bf16 v[16:31], v[136:139], v[64:67], 0
    ds_read_b128 v[152:155], v5 offset:2064
    v_exp_f32 v36, v36
    v_exp_f32 v37, v37
    v_cvt_pk_bf16_f32 v48, v32, v33
    v_exp_f32 v38, v38
    v_exp_f32 v39, v39
    v_mfma_f32_32x32x16_bf16 v[72:87], v[144:147], v[52:55], v[72:87]
    ds_read_b128 v[156:159], v6 offset:2064
    v_cvt_pk_bf16_f32 v49, v34, v35
    v_exp_f32 v40, v40
    v_exp_f32 v41, v41
    v_cvt_pk_bf16_f32 v50, v36, v37
    v_exp_f32 v42, v42
    v_exp_f32 v43, v43
    v_cvt_pk_bf16_f32 v51, v38, v39
    v_exp_f32 v44, v44
    v_cvt_pk_bf16_f32 v52, v40, v41
    v_exp_f32 v45, v45
    v_cvt_pk_bf16_f32 v53, v42, v43
    v_exp_f32 v46, v46
    v_exp_f32 v47, v47
    v_cvt_pk_bf16_f32 v54, v44, v45
    v_cvt_pk_bf16_f32 v55, v46, v47
    v_mfma_f32_32x32x16_bf16 v[88:103], v[140:143], v[48:51], 0
    ds_write_b32 v11, v192 offset:6148
    v_exp_f32 v16, v16
    v_exp_f32 v17, v17
    v_exp_f32 v18, v18
    v_exp_f32 v19, v19
    v_mfma_f32_32x32x16_bf16 v[32:47], v[136:139], v[68:71], 0
    ds_write_b128 v12, v[216:219] offset:4096
    v_exp_f32 v20, v20
    v_exp_f32 v21, v21
    v_cvt_pk_bf16_f32 v48, v16, v17
    v_exp_f32 v22, v22
    v_exp_f32 v23, v23
    v_mfma_f32_32x32x16_bf16 v[88:103], v[144:147], v[52:55], v[88:103]
    ds_write_b128 v12, v[220:223] offset:5120
    v_cvt_pk_bf16_f32 v49, v18, v19
    v_exp_f32 v24, v24
    v_exp_f32 v25, v25
    v_cvt_pk_bf16_f32 v50, v20, v21
    v_exp_f32 v26, v26
    v_exp_f32 v27, v27
    v_cvt_pk_bf16_f32 v51, v22, v23
    v_exp_f32 v28, v28
    v_cvt_pk_bf16_f32 v52, v24, v25
    v_exp_f32 v29, v29
    v_cvt_pk_bf16_f32 v53, v26, v27
    v_exp_f32 v30, v30
    v_exp_f32 v31, v31
    v_cvt_pk_bf16_f32 v54, v28, v29
    v_cvt_pk_bf16_f32 v55, v30, v31
    v_mfma_f32_32x32x16_bf16 v[104:119], v[140:143], v[48:51], 0
    s_waitcnt lgkmcnt(3)
    v_exp_f32 v32, v32
    v_exp_f32 v33, v33
    v_exp_f32 v34, v34
    v_exp_f32 v35, v35
    v_mfma_f32_32x32x16_bf16 v[16:31], v[148:151], v[56:59], 0
    ds_write_b32 v12, v208 offset:6152
    v_exp_f32 v36, v36
    v_exp_f32 v37, v37
    v_cvt_pk_bf16_f32 v48, v32, v33
    v_exp_f32 v38, v38
    v_exp_f32 v39, v39
    v_mfma_f32_32x32x16_bf16 v[104:119], v[144:147], v[52:55], v[104:119]
    global_load_dwordx4 a[156:159], v0, s[28:29] offset:3072
    v_add_u32 v0, 0x2000, v0
    v_cvt_pk_bf16_f32 v49, v34, v35
    v_exp_f32 v40, v40
    v_exp_f32 v41, v41
    s_waitcnt vmcnt(3)
    v_cmp_eq_u32 vcc, -1, v134
    s_lshl_b32 s54, s44, 13
    s_add_u32 s54, s54, 4096
    v_cvt_pk_bf16_f32 v50, v36, v37
    v_exp_f32 v42, v42
    v_exp_f32 v43, v43
    s_cbranch_vccnz adaLN_cond__grouped_kv_mqa__dense_activation_silu__prompt_kernel_st103
adaLN_cond__grouped_kv_mqa__dense_activation_silu__prompt_kernel_bk104:
    v_add_u32 v15, s54, v2
    v_add_u32 v14, s35, v3
    v_cvt_pk_bf16_f32 v51, v38, v39
    v_exp_f32 v44, v44
    v_cvt_pk_bf16_f32 v52, v40, v41
    v_exp_f32 v45, v45
    v_cvt_pk_bf16_f32 v53, v42, v43
    v_exp_f32 v46, v46
    v_exp_f32 v47, v47
    v_cvt_pk_bf16_f32 v54, v44, v45
    v_cvt_pk_bf16_f32 v55, v46, v47
    v_mfma_f32_32x32x16_bf16 v[120:135], v[140:143], v[48:51], 0
    global_load_dwordx4 v[192:195], v14, s[28:29] offset:-4096
    v_exp_f32 v16, v16
    v_exp_f32 v17, v17
    v_exp_f32 v18, v18
    v_exp_f32 v19, v19
    v_mfma_f32_32x32x16_bf16 v[32:47], v[148:151], v[60:63], 0
    global_load_dwordx4 v[196:199], v14, s[28:29] offset:-3072
    v_exp_f32 v20, v20
    v_exp_f32 v21, v21
    v_cvt_pk_bf16_f32 v48, v16, v17
    v_exp_f32 v22, v22
    v_exp_f32 v23, v23
    v_mfma_f32_32x32x16_bf16 v[120:135], v[144:147], v[52:55], v[120:135]
    global_load_dwordx4 v[200:203], v14, s[28:29] offset:-2048
    v_cvt_pk_bf16_f32 v49, v18, v19
    v_exp_f32 v24, v24
    v_exp_f32 v25, v25
    v_cvt_pk_bf16_f32 v50, v20, v21
    v_exp_f32 v26, v26
    v_exp_f32 v27, v27
    v_cvt_pk_bf16_f32 v51, v22, v23
    v_exp_f32 v28, v28
    v_cvt_pk_bf16_f32 v52, v24, v25
    v_exp_f32 v29, v29
    v_cvt_pk_bf16_f32 v53, v26, v27
    v_exp_f32 v30, v30
    v_exp_f32 v31, v31
    v_cvt_pk_bf16_f32 v54, v28, v29
    v_cvt_pk_bf16_f32 v55, v30, v31
    v_mfma_f32_32x32x16_bf16 v[72:87], v[152:155], v[48:51], v[72:87]
    ds_read_b128 v[136:139], v4 offset:4128
    v_exp_f32 v32, v32
    v_exp_f32 v33, v33
    v_mov_b32 v176, 0
    v_exp_f32 v34, v34
    v_exp_f32 v35, v35
    v_mfma_f32_32x32x16_bf16 v[16:31], v[148:151], v[64:67], 0
    ds_read_b128 v[140:143], v5 offset:4128
    v_exp_f32 v36, v36
    v_exp_f32 v37, v37
    v_cvt_pk_bf16_f32 v48, v32, v33
    v_exp_f32 v38, v38
    v_exp_f32 v39, v39
    v_mfma_f32_32x32x16_bf16 v[72:87], v[156:159], v[52:55], v[72:87]
    ds_read_b128 v[144:147], v6 offset:4128
    v_cvt_pk_bf16_f32 v49, v34, v35
    v_exp_f32 v40, v40
    v_exp_f32 v41, v41
    v_cvt_pk_bf16_f32 v50, v36, v37
    v_exp_f32 v42, v42
    v_exp_f32 v43, v43
    v_cvt_pk_bf16_f32 v51, v38, v39
    v_exp_f32 v44, v44
    v_cvt_pk_bf16_f32 v52, v40, v41
    v_exp_f32 v45, v45
    v_cvt_pk_bf16_f32 v53, v42, v43
    v_exp_f32 v46, v46
    v_exp_f32 v47, v47
    v_cvt_pk_bf16_f32 v54, v44, v45
    v_cvt_pk_bf16_f32 v55, v46, v47
    v_mfma_f32_32x32x16_bf16 v[88:103], v[152:155], v[48:51], v[88:103]
    s_waitcnt lgkmcnt(0)
    v_exp_f32 v16, v16
    v_exp_f32 v17, v17
    v_exp_f32 v18, v18
    v_exp_f32 v19, v19
    v_mfma_f32_32x32x16_bf16 v[32:47], v[148:151], v[68:71], 0
    s_barrier
    ds_read_b128 v[252:255], v9 offset:6144
    v_exp_f32 v20, v20
    v_exp_f32 v21, v21
    v_cvt_pk_bf16_f32 v48, v16, v17
    v_exp_f32 v22, v22
    v_exp_f32 v23, v23
    v_mfma_f32_32x32x16_bf16 v[88:103], v[156:159], v[52:55], v[88:103]
    ds_read_b128 v[228:231], v9 offset:0
    v_cvt_pk_bf16_f32 v49, v18, v19
    v_exp_f32 v24, v24
    v_exp_f32 v25, v25
    v_cvt_pk_bf16_f32 v50, v20, v21
    v_exp_f32 v26, v26
    v_exp_f32 v27, v27
    v_cvt_pk_bf16_f32 v51, v22, v23
    v_exp_f32 v28, v28
    v_cvt_pk_bf16_f32 v52, v24, v25
    v_exp_f32 v29, v29
    v_cvt_pk_bf16_f32 v53, v26, v27
    v_exp_f32 v30, v30
    v_exp_f32 v31, v31
    v_cvt_pk_bf16_f32 v54, v28, v29
    v_cvt_pk_bf16_f32 v55, v30, v31
    v_mfma_f32_32x32x16_bf16 v[104:119], v[152:155], v[48:51], v[104:119]
    v_exp_f32 v32, v32
    v_exp_f32 v33, v33
    v_exp_f32 v34, v34
    v_exp_f32 v35, v35
    v_mfma_f32_32x32x16_bf16 v[16:31], v[136:139], v[56:59], 0
    ds_read_b128 v[232:235], v9 offset:1024
    v_exp_f32 v36, v36
    v_exp_f32 v37, v37
    v_cvt_pk_bf16_f32 v48, v32, v33
    v_exp_f32 v38, v38
    v_exp_f32 v39, v39
    v_mfma_f32_32x32x16_bf16 v[104:119], v[156:159], v[52:55], v[104:119]
    ds_read_b128 v[236:239], v9 offset:2048
    v_cvt_pk_bf16_f32 v49, v34, v35
    v_exp_f32 v40, v40
    v_exp_f32 v41, v41
    v_cvt_pk_bf16_f32 v50, v36, v37
    v_exp_f32 v42, v42
    v_exp_f32 v43, v43
    v_cvt_pk_bf16_f32 v51, v38, v39
    v_exp_f32 v44, v44
    v_cvt_pk_bf16_f32 v52, v40, v41
    v_exp_f32 v45, v45
    v_cvt_pk_bf16_f32 v53, v42, v43
    v_exp_f32 v46, v46
    v_exp_f32 v47, v47
    v_cvt_pk_bf16_f32 v54, v44, v45
    v_cvt_pk_bf16_f32 v55, v46, v47
    v_mfma_f32_32x32x16_bf16 v[120:135], v[152:155], v[48:51], v[120:135]
    ds_read_b128 v[240:243], v9 offset:3072
    v_exp_f32 v16, v16
    v_exp_f32 v17, v17
    v_exp_f32 v18, v18
    v_exp_f32 v19, v19
    v_mfma_f32_32x32x16_bf16 v[32:47], v[136:139], v[60:63], 0
    ds_read_b128 v[244:247], v9 offset:4096
    v_exp_f32 v20, v20
    v_exp_f32 v21, v21
    v_cvt_pk_bf16_f32 v48, v16, v17
    v_exp_f32 v22, v22
    v_exp_f32 v23, v23
    v_mfma_f32_32x32x16_bf16 v[120:135], v[156:159], v[52:55], v[120:135]
    ds_read_b128 v[248:251], v9 offset:5120
    v_cvt_pk_bf16_f32 v49, v18, v19
    v_exp_f32 v24, v24
    v_exp_f32 v25, v25
    v_cvt_pk_bf16_f32 v50, v20, v21
    v_exp_f32 v26, v26
    v_exp_f32 v27, v27
    v_cvt_pk_bf16_f32 v51, v22, v23
    v_exp_f32 v28, v28
    v_cvt_pk_bf16_f32 v52, v24, v25
    v_exp_f32 v29, v29
    v_cvt_pk_bf16_f32 v53, v26, v27
    v_exp_f32 v30, v30
    v_exp_f32 v31, v31
    v_cvt_pk_bf16_f32 v54, v28, v29
    v_cvt_pk_bf16_f32 v55, v30, v31
    v_mfma_f32_32x32x16_bf16 v[72:87], v[140:143], v[48:51], v[72:87]
    ds_read_b128 v[148:151], v4 offset:6192
    v_exp_f32 v32, v32
    v_exp_f32 v33, v33
    v_exp_f32 v34, v34
    v_exp_f32 v35, v35
    v_mfma_f32_32x32x16_bf16 v[16:31], v[136:139], v[64:67], 0
    ds_read_b128 v[152:155], v5 offset:6192
    v_exp_f32 v36, v36
    v_exp_f32 v37, v37
    v_cvt_pk_bf16_f32 v48, v32, v33
    v_exp_f32 v38, v38
    v_exp_f32 v39, v39
    v_mfma_f32_32x32x16_bf16 v[72:87], v[144:147], v[52:55], v[72:87]
    ds_read_b128 v[156:159], v6 offset:6192
    v_cvt_pk_bf16_f32 v49, v34, v35
    v_exp_f32 v40, v40
    v_exp_f32 v41, v41
    s_waitcnt lgkmcnt(3)
    v_add_f32 v252, v252, v253
    v_add_f32 v228, v228, v236
    v_cvt_pk_bf16_f32 v50, v36, v37
    v_exp_f32 v42, v42
    v_exp_f32 v43, v43
    v_add_f32 v229, v229, v237
    v_add_f32 v230, v230, v238
    v_add_f32 v231, v231, v239
    v_cvt_pk_bf16_f32 v51, v38, v39
    v_exp_f32 v44, v44
    v_cvt_pk_bf16_f32 v52, v40, v41
    v_add_f32 v232, v232, v240
    v_add_f32 v233, v233, v241
    v_add_f32 v234, v234, v242
    v_exp_f32 v45, v45
    v_cvt_pk_bf16_f32 v53, v42, v43
    v_exp_f32 v46, v46
    v_add_f32 v235, v235, v243
    v_add_f32 v252, v252, v254
    v_add_f32 v228, v228, v244
    v_exp_f32 v47, v47
    v_cvt_pk_bf16_f32 v54, v44, v45
    v_cvt_pk_bf16_f32 v55, v46, v47
    v_mfma_f32_32x32x16_bf16 v[88:103], v[140:143], v[48:51], v[88:103]
    global_load_dwordx4 v[204:207], v14, s[28:29] offset:-1024
    v_exp_f32 v16, v16
    v_exp_f32 v17, v17
    v_add_f32 v229, v229, v245
    v_add_f32 v230, v230, v246
    v_add_f32 v231, v231, v247
    v_exp_f32 v18, v18
    v_exp_f32 v19, v19
    v_mfma_f32_32x32x16_bf16 v[32:47], v[136:139], v[68:71], 0
    global_load_dwordx4 v[208:211], v14, s[28:29] offset:0
    v_exp_f32 v20, v20
    v_exp_f32 v21, v21
    v_cvt_pk_bf16_f32 v48, v16, v17
    v_add_f32 v232, v232, v248
    v_add_f32 v233, v233, v249
    v_add_f32 v234, v234, v250
    v_exp_f32 v22, v22
    v_exp_f32 v23, v23
    v_mfma_f32_32x32x16_bf16 v[88:103], v[144:147], v[52:55], v[88:103]
    global_load_dwordx4 v[212:215], v14, s[28:29] offset:1024
    v_cvt_pk_bf16_f32 v49, v18, v19
    v_exp_f32 v24, v24
    v_exp_f32 v25, v25
    v_add_f32 v235, v235, v251
    v_add_f32 v252, v252, v160
    v_rcp_f32 v253, v252
    v_cvt_pk_bf16_f32 v50, v20, v21
    v_exp_f32 v26, v26
    v_exp_f32 v27, v27
    v_subrev_u32 v254, 0x21800000, v252
    v_add_f32 v228, v228, v168
    v_add_f32 v229, v229, v169
    v_cvt_pk_bf16_f32 v51, v22, v23
    v_exp_f32 v28, v28
    v_cvt_pk_bf16_f32 v52, v24, v25
    v_add_f32 v230, v230, v170
    v_add_f32 v231, v231, v171
    v_add_f32 v232, v232, v172
    v_exp_f32 v29, v29
    v_cvt_pk_bf16_f32 v53, v26, v27
    v_exp_f32 v30, v30
    v_add_f32 v233, v233, v173
    v_add_f32 v234, v234, v174
    v_add_f32 v235, v235, v175
    v_exp_f32 v31, v31
    v_cvt_pk_bf16_f32 v54, v28, v29
    v_cvt_pk_bf16_f32 v55, v30, v31
    v_mfma_f32_32x32x16_bf16 v[104:119], v[140:143], v[48:51], v[104:119]
    s_waitcnt lgkmcnt(0)
    v_exp_f32 v32, v32
    v_exp_f32 v33, v33
    v_cmp_lt_u32 vcc, 0x3c000000, v254
    v_mul_f32 v228, v228, v253
    v_mul_f32 v229, v229, v253
    v_exp_f32 v34, v34
    v_exp_f32 v35, v35
    v_mfma_f32_32x32x16_bf16 v[16:31], v[148:151], v[56:59], 0
    global_load_dwordx4 v[216:219], v14, s[28:29] offset:2048
    v_exp_f32 v36, v36
    v_exp_f32 v37, v37
    v_cvt_pk_bf16_f32 v48, v32, v33
    v_mul_f32 v230, v230, v253
    v_mul_f32 v231, v231, v253
    v_mul_f32 v232, v232, v253
    v_exp_f32 v38, v38
    v_exp_f32 v39, v39
    v_mfma_f32_32x32x16_bf16 v[104:119], v[144:147], v[52:55], v[104:119]
    global_load_dwordx4 v[220:223], v14, s[28:29] offset:3072
    v_add_u32 v14, s34, v3
    v_cvt_pk_bf16_f32 v49, v34, v35
    v_exp_f32 v40, v40
    v_exp_f32 v41, v41
    v_mul_f32 v233, v233, v253
    v_mul_f32 v234, v234, v253
    v_mul_f32 v235, v235, v253
    v_cvt_pk_bf16_f32 v50, v36, v37
    v_exp_f32 v42, v42
    v_exp_f32 v43, v43
    v_cvt_pk_bf16_f32 v228, v228, v229
    v_cvt_pk_bf16_f32 v229, v230, v231
    v_cvt_pk_bf16_f32 v230, v232, v233
    v_cvt_pk_bf16_f32 v51, v38, v39
    v_exp_f32 v44, v44
    v_cvt_pk_bf16_f32 v52, v40, v41
    v_cvt_pk_bf16_f32 v231, v234, v235
    v_exp_f32 v45, v45
    v_cvt_pk_bf16_f32 v53, v42, v43
    v_exp_f32 v46, v46
    v_exp_f32 v47, v47
    v_cvt_pk_bf16_f32 v54, v44, v45
    v_cvt_pk_bf16_f32 v55, v46, v47
    v_mfma_f32_32x32x16_bf16 v[120:135], v[140:143], v[48:51], v[120:135]
    s_or_b64 s[56:57], vcc, s[98:99]
    s_cbranch_scc1 adaLN_cond__grouped_kv_mqa__dense_activation_silu__prompt_kernel_alt108
    global_store_dwordx4 v13, v[228:231], s[50:51]
adaLN_cond__grouped_kv_mqa__dense_activation_silu__prompt_kernel_obk107:
    v_exp_f32 v16, v16
    v_exp_f32 v17, v17
    v_exp_f32 v18, v18
    v_exp_f32 v19, v19
    v_mfma_f32_32x32x16_bf16 v[32:47], v[148:151], v[60:63], 0
    ds_write_b32 v9, v176 offset:6156
    v_exp_f32 v20, v20
    v_exp_f32 v21, v21
    v_cvt_pk_bf16_f32 v48, v16, v17
    v_exp_f32 v22, v22
    v_exp_f32 v23, v23
    v_mfma_f32_32x32x16_bf16 v[120:135], v[144:147], v[52:55], v[120:135]
    global_load_dwordx4 v[180:183], v14, s[28:29] offset:1024
    v_cvt_pk_bf16_f32 v49, v18, v19
    v_exp_f32 v24, v24
    v_exp_f32 v25, v25
    v_cvt_pk_bf16_f32 v50, v20, v21
    v_exp_f32 v26, v26
    v_exp_f32 v27, v27
    v_cvt_pk_bf16_f32 v51, v22, v23
    v_exp_f32 v28, v28
    v_cvt_pk_bf16_f32 v52, v24, v25
    v_exp_f32 v29, v29
    v_cvt_pk_bf16_f32 v53, v26, v27
    v_exp_f32 v30, v30
    v_exp_f32 v31, v31
    v_cvt_pk_bf16_f32 v54, v28, v29
    v_cvt_pk_bf16_f32 v55, v30, v31
    v_mfma_f32_32x32x16_bf16 v[72:87], v[152:155], v[48:51], v[72:87]
    ds_read_b128 v[136:139], v4 offset:8256
    v_exp_f32 v32, v32
    v_exp_f32 v33, v33
    v_exp_f32 v34, v34
    v_exp_f32 v35, v35
    v_mfma_f32_32x32x16_bf16 v[16:31], v[148:151], v[64:67], 0
    ds_read_b128 v[140:143], v5 offset:8256
    v_exp_f32 v36, v36
    v_exp_f32 v37, v37
    v_cvt_pk_bf16_f32 v48, v32, v33
    v_exp_f32 v38, v38
    v_exp_f32 v39, v39
    v_mfma_f32_32x32x16_bf16 v[72:87], v[156:159], v[52:55], v[72:87]
    ds_read_b128 v[144:147], v6 offset:8256
    v_cvt_pk_bf16_f32 v49, v34, v35
    v_exp_f32 v40, v40
    v_exp_f32 v41, v41
    v_cvt_pk_bf16_f32 v50, v36, v37
    v_exp_f32 v42, v42
    v_exp_f32 v43, v43
    v_cvt_pk_bf16_f32 v51, v38, v39
    v_exp_f32 v44, v44
    v_cvt_pk_bf16_f32 v52, v40, v41
    v_exp_f32 v45, v45
    v_cvt_pk_bf16_f32 v53, v42, v43
    v_exp_f32 v46, v46
    v_exp_f32 v47, v47
    v_cvt_pk_bf16_f32 v54, v44, v45
    v_cvt_pk_bf16_f32 v55, v46, v47
    v_mfma_f32_32x32x16_bf16 v[88:103], v[152:155], v[48:51], v[88:103]
    global_load_dwordx4 v[184:187], v14, s[28:29] offset:2048
    v_exp_f32 v16, v16
    v_exp_f32 v17, v17
    v_exp_f32 v18, v18
    v_exp_f32 v19, v19
    v_mfma_f32_32x32x16_bf16 v[32:47], v[148:151], v[68:71], 0
    global_load_dwordx4 v[188:191], v14, s[28:29] offset:3072
    v_exp_f32 v20, v20
    v_exp_f32 v21, v21
    v_cvt_pk_bf16_f32 v48, v16, v17
    v_exp_f32 v22, v22
    v_exp_f32 v23, v23
    v_mfma_f32_32x32x16_bf16 v[88:103], v[156:159], v[52:55], v[88:103]
    global_load_dwordx4 v[160:163], v14, s[28:29] offset:-4096
    v_cvt_pk_bf16_f32 v49, v18, v19
    v_exp_f32 v24, v24
    v_exp_f32 v25, v25
    v_cvt_pk_bf16_f32 v50, v20, v21
    v_exp_f32 v26, v26
    v_exp_f32 v27, v27
    v_cvt_pk_bf16_f32 v51, v22, v23
    v_exp_f32 v28, v28
    v_cvt_pk_bf16_f32 v52, v24, v25
    v_exp_f32 v29, v29
    v_cvt_pk_bf16_f32 v53, v26, v27
    v_exp_f32 v30, v30
    v_exp_f32 v31, v31
    v_cvt_pk_bf16_f32 v54, v28, v29
    v_cvt_pk_bf16_f32 v55, v30, v31
    v_mfma_f32_32x32x16_bf16 v[104:119], v[152:155], v[48:51], v[104:119]
    s_waitcnt lgkmcnt(0)
    v_exp_f32 v32, v32
    v_exp_f32 v33, v33
    v_exp_f32 v34, v34
    v_exp_f32 v35, v35
    v_mfma_f32_32x32x16_bf16 v[16:31], v[136:139], v[56:59], 0
    global_load_dwordx4 v[164:167], v14, s[28:29] offset:-3072
    v_exp_f32 v36, v36
    v_exp_f32 v37, v37
    v_cvt_pk_bf16_f32 v48, v32, v33
    v_exp_f32 v38, v38
    v_exp_f32 v39, v39
    v_mfma_f32_32x32x16_bf16 v[104:119], v[156:159], v[52:55], v[104:119]
    global_load_dwordx4 v[168:171], v14, s[28:29] offset:-2048
    v_cvt_pk_bf16_f32 v49, v34, v35
    v_exp_f32 v40, v40
    v_exp_f32 v41, v41
    v_cvt_pk_bf16_f32 v50, v36, v37
    v_exp_f32 v42, v42
    v_exp_f32 v43, v43
    v_cvt_pk_bf16_f32 v51, v38, v39
    v_exp_f32 v44, v44
    v_cvt_pk_bf16_f32 v52, v40, v41
    v_exp_f32 v45, v45
    v_cvt_pk_bf16_f32 v53, v42, v43
    v_exp_f32 v46, v46
    v_exp_f32 v47, v47
    v_cvt_pk_bf16_f32 v54, v44, v45
    v_cvt_pk_bf16_f32 v55, v46, v47
    v_mfma_f32_32x32x16_bf16 v[120:135], v[152:155], v[48:51], v[120:135]
    global_load_dwordx4 v[172:175], v14, s[28:29] offset:-1024
    v_exp_f32 v16, v16
    v_exp_f32 v17, v17
    v_exp_f32 v18, v18
    v_exp_f32 v19, v19
    v_mfma_f32_32x32x16_bf16 v[32:47], v[136:139], v[60:63], 0
    global_load_dwordx4 v[176:179], v14, s[28:29] offset:0
    v_exp_f32 v20, v20
    v_exp_f32 v21, v21
    v_cvt_pk_bf16_f32 v48, v16, v17
    v_exp_f32 v22, v22
    v_exp_f32 v23, v23
    v_mfma_f32_32x32x16_bf16 v[120:135], v[156:159], v[52:55], v[120:135]
    global_load_dwordx4 a[160:163], v0, s[28:29] offset:-4096
    v_cvt_pk_bf16_f32 v49, v18, v19
    v_exp_f32 v24, v24
    v_exp_f32 v25, v25
    v_cvt_pk_bf16_f32 v50, v20, v21
    v_exp_f32 v26, v26
    v_exp_f32 v27, v27
    v_cvt_pk_bf16_f32 v51, v22, v23
    v_exp_f32 v28, v28
    v_cvt_pk_bf16_f32 v52, v24, v25
    v_exp_f32 v29, v29
    v_cvt_pk_bf16_f32 v53, v26, v27
    v_exp_f32 v30, v30
    v_exp_f32 v31, v31
    v_cvt_pk_bf16_f32 v54, v28, v29
    v_cvt_pk_bf16_f32 v55, v30, v31
    v_mfma_f32_32x32x16_bf16 v[72:87], v[140:143], v[48:51], v[72:87]
    ds_read_b128 v[148:151], v4 offset:10320
    v_exp_f32 v32, v32
    v_exp_f32 v33, v33
    v_exp_f32 v34, v34
    v_exp_f32 v35, v35
    v_mfma_f32_32x32x16_bf16 v[16:31], v[136:139], v[64:67], 0
    ds_read_b128 v[152:155], v5 offset:10320
    v_exp_f32 v36, v36
    v_exp_f32 v37, v37
    v_cvt_pk_bf16_f32 v48, v32, v33
    v_exp_f32 v38, v38
    v_exp_f32 v39, v39
    v_mfma_f32_32x32x16_bf16 v[72:87], v[144:147], v[52:55], v[72:87]
    ds_read_b128 v[156:159], v6 offset:10320
    v_cvt_pk_bf16_f32 v49, v34, v35
    v_exp_f32 v40, v40
    v_exp_f32 v41, v41
    v_cvt_pk_bf16_f32 v50, v36, v37
    v_exp_f32 v42, v42
    v_exp_f32 v43, v43
    v_cvt_pk_bf16_f32 v51, v38, v39
    v_exp_f32 v44, v44
    v_cvt_pk_bf16_f32 v52, v40, v41
    v_exp_f32 v45, v45
    v_cvt_pk_bf16_f32 v53, v42, v43
    v_exp_f32 v46, v46
    v_exp_f32 v47, v47
    v_cvt_pk_bf16_f32 v54, v44, v45
    v_cvt_pk_bf16_f32 v55, v46, v47
    v_mfma_f32_32x32x16_bf16 v[88:103], v[140:143], v[48:51], v[88:103]
    global_load_dwordx4 v[224:227], v15, s[50:51] offset:-4096 sc1
    v_exp_f32 v16, v16
    v_exp_f32 v17, v17
    v_exp_f32 v18, v18
    v_exp_f32 v19, v19
    v_mfma_f32_32x32x16_bf16 v[32:47], v[136:139], v[68:71], 0
    global_load_dwordx4 v[228:231], v15, s[50:51] offset:-3072 sc1
    v_exp_f32 v20, v20
    v_exp_f32 v21, v21
    v_cvt_pk_bf16_f32 v48, v16, v17
    v_exp_f32 v22, v22
    v_exp_f32 v23, v23
    v_mfma_f32_32x32x16_bf16 v[88:103], v[144:147], v[52:55], v[88:103]
    global_load_dwordx4 v[232:235], v15, s[50:51] offset:-2048 sc1
    v_cvt_pk_bf16_f32 v49, v18, v19
    v_exp_f32 v24, v24
    v_exp_f32 v25, v25
    v_cvt_pk_bf16_f32 v50, v20, v21
    v_exp_f32 v26, v26
    v_exp_f32 v27, v27
    v_cvt_pk_bf16_f32 v51, v22, v23
    v_exp_f32 v28, v28
    v_cvt_pk_bf16_f32 v52, v24, v25
    v_exp_f32 v29, v29
    v_cvt_pk_bf16_f32 v53, v26, v27
    v_exp_f32 v30, v30
    v_exp_f32 v31, v31
    v_cvt_pk_bf16_f32 v54, v28, v29
    v_cvt_pk_bf16_f32 v55, v30, v31
    v_mfma_f32_32x32x16_bf16 v[104:119], v[140:143], v[48:51], v[104:119]
    s_waitcnt lgkmcnt(0)
    v_exp_f32 v32, v32
    v_exp_f32 v33, v33
    v_exp_f32 v34, v34
    v_exp_f32 v35, v35
    v_mfma_f32_32x32x16_bf16 v[16:31], v[148:151], v[56:59], 0
    global_load_dwordx4 v[236:239], v15, s[50:51] offset:-1024 sc1
    v_exp_f32 v36, v36
    v_exp_f32 v37, v37
    v_cvt_pk_bf16_f32 v48, v32, v33
    v_exp_f32 v38, v38
    v_exp_f32 v39, v39
    v_mfma_f32_32x32x16_bf16 v[104:119], v[144:147], v[52:55], v[104:119]
    global_load_dwordx4 v[240:243], v15, s[50:51] offset:0 sc1
    v_cvt_pk_bf16_f32 v49, v34, v35
    v_exp_f32 v40, v40
    v_exp_f32 v41, v41
    v_cvt_pk_bf16_f32 v50, v36, v37
    v_exp_f32 v42, v42
    v_exp_f32 v43, v43
    v_cvt_pk_bf16_f32 v51, v38, v39
    v_exp_f32 v44, v44
    v_cvt_pk_bf16_f32 v52, v40, v41
    v_exp_f32 v45, v45
    v_cvt_pk_bf16_f32 v53, v42, v43
    v_exp_f32 v46, v46
    v_exp_f32 v47, v47
    v_cvt_pk_bf16_f32 v54, v44, v45
    v_cvt_pk_bf16_f32 v55, v46, v47
    v_mfma_f32_32x32x16_bf16 v[120:135], v[140:143], v[48:51], v[120:135]
    global_load_dwordx4 v[244:247], v15, s[50:51] offset:1024 sc1
    v_exp_f32 v16, v16
    v_exp_f32 v17, v17
    v_exp_f32 v18, v18
    v_exp_f32 v19, v19
    v_mfma_f32_32x32x16_bf16 v[32:47], v[148:151], v[60:63], 0
    global_load_dwordx4 v[248:251], v15, s[50:51] offset:2048 sc1
    v_exp_f32 v20, v20
    v_exp_f32 v21, v21
    v_cvt_pk_bf16_f32 v48, v16, v17
    v_exp_f32 v22, v22
    v_exp_f32 v23, v23
    v_mfma_f32_32x32x16_bf16 v[120:135], v[144:147], v[52:55], v[120:135]
    global_load_dwordx4 v[252:255], v15, s[50:51] offset:3072 sc1
    v_cvt_pk_bf16_f32 v49, v18, v19
    v_exp_f32 v24, v24
    v_exp_f32 v25, v25
    v_cvt_pk_bf16_f32 v50, v20, v21
    v_exp_f32 v26, v26
    v_exp_f32 v27, v27
    v_cvt_pk_bf16_f32 v51, v22, v23
    v_exp_f32 v28, v28
    v_cvt_pk_bf16_f32 v52, v24, v25
    v_exp_f32 v29, v29
    v_cvt_pk_bf16_f32 v53, v26, v27
    v_exp_f32 v30, v30
    v_exp_f32 v31, v31
    v_cvt_pk_bf16_f32 v54, v28, v29
    v_cvt_pk_bf16_f32 v55, v30, v31
    v_mfma_f32_32x32x16_bf16 v[72:87], v[152:155], v[48:51], v[72:87]
    ds_read_b128 v[136:139], v4 offset:12384
    v_exp_f32 v32, v32
    v_exp_f32 v33, v33
    v_exp_f32 v34, v34
    v_exp_f32 v35, v35
    v_mfma_f32_32x32x16_bf16 v[16:31], v[148:151], v[64:67], 0
    ds_read_b128 v[140:143], v5 offset:12384
    v_exp_f32 v36, v36
    v_exp_f32 v37, v37
    v_cvt_pk_bf16_f32 v48, v32, v33
    v_exp_f32 v38, v38
    v_exp_f32 v39, v39
    v_mfma_f32_32x32x16_bf16 v[72:87], v[156:159], v[52:55], v[72:87]
    ds_read_b128 v[144:147], v6 offset:12384
    v_cvt_pk_bf16_f32 v49, v34, v35
    v_exp_f32 v40, v40
    v_exp_f32 v41, v41
    v_cvt_pk_bf16_f32 v50, v36, v37
    v_exp_f32 v42, v42
    v_exp_f32 v43, v43
    v_cvt_pk_bf16_f32 v51, v38, v39
    v_exp_f32 v44, v44
    v_cvt_pk_bf16_f32 v52, v40, v41
    v_exp_f32 v45, v45
    v_cvt_pk_bf16_f32 v53, v42, v43
    v_exp_f32 v46, v46
    v_exp_f32 v47, v47
    v_cvt_pk_bf16_f32 v54, v44, v45
    v_cvt_pk_bf16_f32 v55, v46, v47
    v_mfma_f32_32x32x16_bf16 v[88:103], v[152:155], v[48:51], v[88:103]
    global_load_dwordx4 a[164:167], v0, s[28:29] offset:-3072
    v_exp_f32 v16, v16
    v_exp_f32 v17, v17
    v_exp_f32 v18, v18
    v_exp_f32 v19, v19
    v_mfma_f32_32x32x16_bf16 v[32:47], v[148:151], v[68:71], 0
    global_load_dwordx4 a[168:171], v0, s[28:29] offset:-2048
    v_exp_f32 v20, v20
    v_exp_f32 v21, v21
    v_cvt_pk_bf16_f32 v48, v16, v17
    v_exp_f32 v22, v22
    v_exp_f32 v23, v23
    v_mfma_f32_32x32x16_bf16 v[88:103], v[156:159], v[52:55], v[88:103]
    global_load_dwordx4 a[172:175], v0, s[28:29] offset:-1024
    v_cvt_pk_bf16_f32 v49, v18, v19
    v_exp_f32 v24, v24
    v_exp_f32 v25, v25
    v_cvt_pk_bf16_f32 v50, v20, v21
    v_exp_f32 v26, v26
    v_exp_f32 v27, v27
    v_cvt_pk_bf16_f32 v51, v22, v23
    v_exp_f32 v28, v28
    v_cvt_pk_bf16_f32 v52, v24, v25
    v_exp_f32 v29, v29
    v_cvt_pk_bf16_f32 v53, v26, v27
    v_exp_f32 v30, v30
    v_exp_f32 v31, v31
    v_cvt_pk_bf16_f32 v54, v28, v29
    v_cvt_pk_bf16_f32 v55, v30, v31
    v_mfma_f32_32x32x16_bf16 v[104:119], v[152:155], v[48:51], v[104:119]
    s_waitcnt lgkmcnt(0)
    v_exp_f32 v32, v32
    v_exp_f32 v33, v33
    v_exp_f32 v34, v34
    v_exp_f32 v35, v35
    v_mfma_f32_32x32x16_bf16 v[16:31], v[136:139], v[56:59], 0
    global_load_dwordx4 a[176:179], v0, s[28:29] offset:0
    v_exp_f32 v36, v36
    v_exp_f32 v37, v37
    v_cvt_pk_bf16_f32 v48, v32, v33
    v_exp_f32 v38, v38
    v_exp_f32 v39, v39
    v_mfma_f32_32x32x16_bf16 v[104:119], v[156:159], v[52:55], v[104:119]
    global_load_dwordx4 a[180:183], v0, s[28:29] offset:1024
    v_cvt_pk_bf16_f32 v49, v34, v35
    v_exp_f32 v40, v40
    v_exp_f32 v41, v41
    v_cvt_pk_bf16_f32 v50, v36, v37
    v_exp_f32 v42, v42
    v_exp_f32 v43, v43
    v_cvt_pk_bf16_f32 v51, v38, v39
    v_exp_f32 v44, v44
    v_cvt_pk_bf16_f32 v52, v40, v41
    v_exp_f32 v45, v45
    v_cvt_pk_bf16_f32 v53, v42, v43
    v_exp_f32 v46, v46
    v_exp_f32 v47, v47
    v_cvt_pk_bf16_f32 v54, v44, v45
    v_cvt_pk_bf16_f32 v55, v46, v47
    v_mfma_f32_32x32x16_bf16 v[120:135], v[152:155], v[48:51], v[120:135]
    global_load_dwordx4 a[184:187], v0, s[28:29] offset:2048
    v_exp_f32 v16, v16
    v_exp_f32 v17, v17
    v_exp_f32 v18, v18
    v_exp_f32 v19, v19
    v_mfma_f32_32x32x16_bf16 v[32:47], v[136:139], v[60:63], 0
    global_load_dwordx4 a[188:191], v0, s[28:29] offset:3072
    v_add_u32 v0, 0x2000, v0
    v_exp_f32 v20, v20
    v_exp_f32 v21, v21
    v_cvt_pk_bf16_f32 v48, v16, v17
    v_exp_f32 v22, v22
    v_exp_f32 v23, v23
    v_mfma_f32_32x32x16_bf16 v[120:135], v[156:159], v[52:55], v[120:135]
    global_load_dwordx4 a[192:195], v0, s[28:29] offset:-4096
    v_cvt_pk_bf16_f32 v49, v18, v19
    v_exp_f32 v24, v24
    v_exp_f32 v25, v25
    v_cvt_pk_bf16_f32 v50, v20, v21
    v_exp_f32 v26, v26
    v_exp_f32 v27, v27
    v_cvt_pk_bf16_f32 v51, v22, v23
    v_exp_f32 v28, v28
    v_cvt_pk_bf16_f32 v52, v24, v25
    v_exp_f32 v29, v29
    v_cvt_pk_bf16_f32 v53, v26, v27
    v_exp_f32 v30, v30
    v_exp_f32 v31, v31
    v_cvt_pk_bf16_f32 v54, v28, v29
    v_cvt_pk_bf16_f32 v55, v30, v31
    v_mfma_f32_32x32x16_bf16 v[72:87], v[140:143], v[48:51], v[72:87]
    ds_read_b128 v[148:151], v4 offset:14448
    v_exp_f32 v32, v32
    v_exp_f32 v33, v33
    v_exp_f32 v34, v34
    v_exp_f32 v35, v35
    v_mfma_f32_32x32x16_bf16 v[16:31], v[136:139], v[64:67], 0
    ds_read_b128 v[152:155], v5 offset:14448
    v_exp_f32 v36, v36
    v_exp_f32 v37, v37
    v_cvt_pk_bf16_f32 v48, v32, v33
    v_exp_f32 v38, v38
    v_exp_f32 v39, v39
    v_mfma_f32_32x32x16_bf16 v[72:87], v[144:147], v[52:55], v[72:87]
    ds_read_b128 v[156:159], v6 offset:14448
    v_cvt_pk_bf16_f32 v49, v34, v35
    v_exp_f32 v40, v40
    v_exp_f32 v41, v41
    v_cvt_pk_bf16_f32 v50, v36, v37
    v_exp_f32 v42, v42
    v_exp_f32 v43, v43
    v_cvt_pk_bf16_f32 v51, v38, v39
    v_exp_f32 v44, v44
    v_cvt_pk_bf16_f32 v52, v40, v41
    v_exp_f32 v45, v45
    v_cvt_pk_bf16_f32 v53, v42, v43
    v_exp_f32 v46, v46
    s_waitcnt vmcnt(8)
    v_exp_f32 v47, v47
    v_cvt_pk_bf16_f32 v54, v44, v45
    v_cvt_pk_bf16_f32 v55, v46, v47
    v_mfma_f32_32x32x16_bf16 v[88:103], v[140:143], v[48:51], v[88:103]
    global_load_dwordx4 a[196:199], v0, s[28:29] offset:-3072
    v_exp_f32 v16, v16
    v_exp_f32 v17, v17
    v_max_u32 v14, v224, v228
    v_max3_u32 v14, v14, v232, v236
    v_max3_u32 v14, v14, v240, v244
    v_exp_f32 v18, v18
    v_exp_f32 v19, v19
    v_mfma_f32_32x32x16_bf16 v[32:47], v[136:139], v[68:71], 0
    global_load_dwordx4 a[200:203], v0, s[28:29] offset:-2048
    v_exp_f32 v20, v20
    v_exp_f32 v21, v21
    v_cvt_pk_bf16_f32 v48, v16, v17
    v_max3_u32 v14, v14, v248, v252
    v_cmp_eq_u32 vcc, -1, v14
    v_exp_f32 v22, v22
    v_exp_f32 v23, v23
    v_mfma_f32_32x32x16_bf16 v[88:103], v[144:147], v[52:55], v[88:103]
    global_load_dwordx4 a[204:207], v0, s[28:29] offset:-1024
    v_cvt_pk_bf16_f32 v49, v18, v19
    v_exp_f32 v24, v24
    v_exp_f32 v25, v25
    s_cbranch_vccnz adaLN_cond__grouped_kv_mqa__dense_activation_silu__prompt_kernel_st109
adaLN_cond__grouped_kv_mqa__dense_activation_silu__prompt_kernel_bk110:
    v_cvt_pk_bf16_f32 v50, v20, v21
    v_mfma_f32_32x32x16_bf16 a[240:255], v[192:195], v[224:227], 0
    v_exp_f32 v26, v26
    v_exp_f32 v27, v27
    v_cvt_pk_bf16_f32 v51, v22, v23
    v_exp_f32 v28, v28
    v_cvt_pk_bf16_f32 v52, v24, v25
    v_exp_f32 v29, v29
    v_mfma_f32_32x32x16_bf16 a[240:255], v[196:199], v[228:231], a[240:255]
    v_cvt_pk_bf16_f32 v53, v26, v27
    v_exp_f32 v30, v30
    v_exp_f32 v31, v31
    v_cvt_pk_bf16_f32 v54, v28, v29
    v_cvt_pk_bf16_f32 v55, v30, v31
    v_mfma_f32_32x32x16_bf16 v[104:119], v[140:143], v[48:51], v[104:119]
    s_waitcnt lgkmcnt(0)
    v_exp_f32 v32, v32
    v_exp_f32 v33, v33
    v_exp_f32 v34, v34
    v_exp_f32 v35, v35
    v_mfma_f32_32x32x16_bf16 v[16:31], v[148:151], v[56:59], 0
    global_load_dwordx4 a[208:211], v0, s[28:29] offset:0
    v_exp_f32 v36, v36
    v_exp_f32 v37, v37
    v_cvt_pk_bf16_f32 v48, v32, v33
    v_exp_f32 v38, v38
    v_exp_f32 v39, v39
    v_mfma_f32_32x32x16_bf16 v[104:119], v[144:147], v[52:55], v[104:119]
    global_load_dwordx4 a[212:215], v0, s[28:29] offset:1024
    v_cvt_pk_bf16_f32 v49, v34, v35
    v_exp_f32 v40, v40
    v_exp_f32 v41, v41
    v_cvt_pk_bf16_f32 v50, v36, v37
    v_mfma_f32_32x32x16_bf16 a[240:255], v[200:203], v[232:235], a[240:255]
    global_load_dwordx4 a[216:219], v0, s[28:29] offset:2048
    v_exp_f32 v42, v42
    v_exp_f32 v43, v43
    v_cvt_pk_bf16_f32 v51, v38, v39
    v_exp_f32 v44, v44
    v_cvt_pk_bf16_f32 v52, v40, v41
    v_exp_f32 v45, v45
    v_mfma_f32_32x32x16_bf16 a[240:255], v[204:207], v[236:239], a[240:255]
    v_cvt_pk_bf16_f32 v53, v42, v43
    v_exp_f32 v46, v46
    v_exp_f32 v47, v47
    v_cvt_pk_bf16_f32 v54, v44, v45
    v_cvt_pk_bf16_f32 v55, v46, v47
    v_mfma_f32_32x32x16_bf16 v[120:135], v[140:143], v[48:51], v[120:135]
    global_load_dwordx4 a[220:223], v0, s[28:29] offset:3072
    v_add_u32 v0, 0x2000, v0
    v_exp_f32 v16, v16
    v_exp_f32 v17, v17
    v_exp_f32 v18, v18
    v_exp_f32 v19, v19
    v_mfma_f32_32x32x16_bf16 v[32:47], v[148:151], v[60:63], 0
    global_load_dwordx4 a[224:227], v0, s[28:29] offset:-4096
    v_exp_f32 v20, v20
    v_exp_f32 v21, v21
    v_cvt_pk_bf16_f32 v48, v16, v17
    v_exp_f32 v22, v22
    v_exp_f32 v23, v23
    v_mfma_f32_32x32x16_bf16 v[120:135], v[144:147], v[52:55], v[120:135]
    global_load_dwordx4 a[228:231], v0, s[28:29] offset:-3072
    v_cvt_pk_bf16_f32 v49, v18, v19
    v_exp_f32 v24, v24
    v_exp_f32 v25, v25
    v_cvt_pk_bf16_f32 v50, v20, v21
    v_mfma_f32_32x32x16_bf16 a[240:255], v[208:211], v[240:243], a[240:255]
    v_exp_f32 v26, v26
    v_exp_f32 v27, v27
    v_cvt_pk_bf16_f32 v51, v22, v23
    v_exp_f32 v28, v28
    v_cvt_pk_bf16_f32 v52, v24, v25
    v_exp_f32 v29, v29
    v_mfma_f32_32x32x16_bf16 a[240:255], v[212:215], v[244:247], a[240:255]
    v_cvt_pk_bf16_f32 v53, v26, v27
    v_exp_f32 v30, v30
    v_exp_f32 v31, v31
    v_cvt_pk_bf16_f32 v54, v28, v29
    v_cvt_pk_bf16_f32 v55, v30, v31
    v_mfma_f32_32x32x16_bf16 v[72:87], v[152:155], v[48:51], v[72:87]
    ds_read_b128 v[136:139], v4 offset:16512
    v_exp_f32 v32, v32
    v_exp_f32 v33, v33
    v_exp_f32 v34, v34
    v_exp_f32 v35, v35
    v_mfma_f32_32x32x16_bf16 v[16:31], v[148:151], v[64:67], 0
    ds_read_b128 v[140:143], v5 offset:16512
    v_exp_f32 v36, v36
    v_exp_f32 v37, v37
    v_cvt_pk_bf16_f32 v48, v32, v33
    v_exp_f32 v38, v38
    v_exp_f32 v39, v39
    v_mfma_f32_32x32x16_bf16 v[72:87], v[156:159], v[52:55], v[72:87]
    ds_read_b128 v[144:147], v6 offset:16512
    v_cvt_pk_bf16_f32 v49, v34, v35
    v_exp_f32 v40, v40
    v_exp_f32 v41, v41
    v_cvt_pk_bf16_f32 v50, v36, v37
    v_mfma_f32_32x32x16_bf16 a[240:255], v[216:219], v[248:251], a[240:255]
    global_load_dwordx4 a[232:235], v0, s[28:29] offset:-2048
    v_exp_f32 v42, v42
    v_exp_f32 v43, v43
    v_cvt_pk_bf16_f32 v51, v38, v39
    v_exp_f32 v44, v44
    v_cvt_pk_bf16_f32 v52, v40, v41
    v_exp_f32 v45, v45
    v_mfma_f32_32x32x16_bf16 a[240:255], v[220:223], v[252:255], a[240:255]
    global_load_dwordx4 a[236:239], v0, s[28:29] offset:-1024
    v_add_u32 v0, s36, v3
    v_cvt_pk_bf16_f32 v53, v42, v43
    v_exp_f32 v46, v46
    v_exp_f32 v47, v47
    v_cvt_pk_bf16_f32 v54, v44, v45
    v_cvt_pk_bf16_f32 v55, v46, v47
    v_mfma_f32_32x32x16_bf16 v[88:103], v[152:155], v[48:51], v[88:103]
    s_add_u32 m0, s48, 8192
    v_exp_f32 v16, v16
    v_exp_f32 v17, v17
    v_add_u32 v14, s30, v2
    v_exp_f32 v18, v18
    v_exp_f32 v19, v19
    v_mfma_f32_32x32x16_bf16 v[32:47], v[148:151], v[68:71], 0
    global_load_lds_dwordx4 v0, s[28:29] offset:0
    v_exp_f32 v20, v20
    v_exp_f32 v21, v21
    v_cvt_pk_bf16_f32 v48, v16, v17
    v_exp_f32 v22, v22
    v_exp_f32 v23, v23
    v_mfma_f32_32x32x16_bf16 v[88:103], v[156:159], v[52:55], v[88:103]
    ds_write_b128 v14, a[240:243] offset:2048
    v_cvt_pk_bf16_f32 v49, v18, v19
    v_exp_f32 v24, v24
    v_exp_f32 v25, v25
    v_cvt_pk_bf16_f32 v50, v20, v21
    v_mfma_f32_32x32x16_bf16 a[112:127], v[160:163], v[224:227], 0
    ds_write_b128 v14, a[244:247] offset:3072
    v_exp_f32 v26, v26
    v_exp_f32 v27, v27
    v_add_u32 v14, s31, v2
    v_cvt_pk_bf16_f32 v51, v22, v23
    v_exp_f32 v28, v28
    v_cvt_pk_bf16_f32 v52, v24, v25
    v_exp_f32 v29, v29
    v_mfma_f32_32x32x16_bf16 a[112:127], v[164:167], v[228:231], a[112:127]
    ds_write_b128 v14, a[248:251] offset:4096
    v_cvt_pk_bf16_f32 v53, v26, v27
    v_exp_f32 v30, v30
    v_exp_f32 v31, v31
    v_cvt_pk_bf16_f32 v54, v28, v29
    v_cvt_pk_bf16_f32 v55, v30, v31
    v_mfma_f32_32x32x16_bf16 v[104:119], v[152:155], v[48:51], v[104:119]
    s_waitcnt lgkmcnt(3)
    v_exp_f32 v32, v32
    v_exp_f32 v33, v33
    v_exp_f32 v34, v34
    v_exp_f32 v35, v35
    v_mfma_f32_32x32x16_bf16 v[16:31], v[136:139], v[56:59], 0
    ds_write_b128 v14, a[252:255] offset:5120
    v_exp_f32 v36, v36
    v_exp_f32 v37, v37
    v_cvt_pk_bf16_f32 v48, v32, v33
    v_and_b32 v14, 31, v1
    v_lshrrev_b32 v224, 5, v1
    v_exp_f32 v38, v38
    v_exp_f32 v39, v39
    v_mfma_f32_32x32x16_bf16 v[104:119], v[156:159], v[52:55], v[104:119]
    global_load_lds_dwordx4 v0, s[28:29] offset:1024
    v_cvt_pk_bf16_f32 v49, v34, v35
    v_exp_f32 v40, v40
    v_exp_f32 v41, v41
    v_lshlrev_b32 v14, 10, v14
    v_lshl_add_u32 v14, v224, 4, v14
    v_cvt_pk_bf16_f32 v50, v36, v37
    v_mfma_f32_32x32x16_bf16 a[112:127], v[168:171], v[232:235], a[112:127]
    global_load_lds_dwordx4 v0, s[28:29] offset:2048
    v_exp_f32 v42, v42
    v_exp_f32 v43, v43
    v_add_u32 v14, s39, v14
    v_add_u32 v224, s27, v2
    v_cvt_pk_bf16_f32 v51, v38, v39
    v_exp_f32 v44, v44
    v_cvt_pk_bf16_f32 v52, v40, v41
    v_exp_f32 v45, v45
    v_mfma_f32_32x32x16_bf16 a[112:127], v[172:175], v[236:239], a[112:127]
    global_load_lds_dwordx4 v0, s[28:29] offset:3072
    v_add_u32 v0, 0x1000, v0
    v_cvt_pk_bf16_f32 v53, v42, v43
    v_exp_f32 v46, v46
    v_exp_f32 v47, v47
    v_cvt_pk_bf16_f32 v54, v44, v45
    v_cvt_pk_bf16_f32 v55, v46, v47
    v_mfma_f32_32x32x16_bf16 v[120:135], v[152:155], v[48:51], v[120:135]
    s_add_u32 m0, s48, 12288
    v_exp_f32 v16, v16
    v_exp_f32 v17, v17
    v_exp_f32 v18, v18
    v_exp_f32 v19, v19
    v_mfma_f32_32x32x16_bf16 v[32:47], v[136:139], v[60:63], 0
    global_load_lds_dwordx4 v0, s[28:29] offset:0
    v_exp_f32 v20, v20
    v_exp_f32 v21, v21
    v_cvt_pk_bf16_f32 v48, v16, v17
    v_exp_f32 v22, v22
    v_exp_f32 v23, v23
    v_mfma_f32_32x32x16_bf16 v[120:135], v[156:159], v[52:55], v[120:135]
    global_load_lds_dwordx4 v0, s[28:29] offset:1024
    v_cvt_pk_bf16_f32 v49, v18, v19
    v_exp_f32 v24, v24
    v_exp_f32 v25, v25
    v_cvt_pk_bf16_f32 v50, v20, v21
    v_mfma_f32_32x32x16_bf16 a[112:127], v[176:179], v[240:243], a[112:127]
    global_load_lds_dwordx4 v0, s[28:29] offset:2048
    v_exp_f32 v26, v26
    v_exp_f32 v27, v27
    v_cvt_pk_bf16_f32 v51, v22, v23
    v_exp_f32 v28, v28
    v_cvt_pk_bf16_f32 v52, v24, v25
    v_exp_f32 v29, v29
    v_mfma_f32_32x32x16_bf16 a[112:127], v[180:183], v[244:247], a[112:127]
    v_cvt_pk_bf16_f32 v53, v26, v27
    v_exp_f32 v30, v30
    v_exp_f32 v31, v31
    v_cvt_pk_bf16_f32 v54, v28, v29
    v_cvt_pk_bf16_f32 v55, v30, v31
    v_mfma_f32_32x32x16_bf16 v[72:87], v[140:143], v[48:51], v[72:87]
    ds_read_b128 v[148:151], v4 offset:18576
    v_exp_f32 v32, v32
    v_exp_f32 v33, v33
    v_exp_f32 v34, v34
    v_exp_f32 v35, v35
    v_mfma_f32_32x32x16_bf16 v[16:31], v[136:139], v[64:67], 0
    ds_read_b128 v[152:155], v5 offset:18576
    v_exp_f32 v36, v36
    v_exp_f32 v37, v37
    v_cvt_pk_bf16_f32 v48, v32, v33
    v_exp_f32 v38, v38
    v_exp_f32 v39, v39
    v_mfma_f32_32x32x16_bf16 v[72:87], v[144:147], v[52:55], v[72:87]
    ds_read_b128 v[156:159], v6 offset:18576
    v_cvt_pk_bf16_f32 v49, v34, v35
    v_exp_f32 v40, v40
    v_exp_f32 v41, v41
    v_cvt_pk_bf16_f32 v50, v36, v37
    v_mfma_f32_32x32x16_bf16 a[112:127], v[184:187], v[248:251], a[112:127]
    global_load_dwordx4 v[248:251], v14, s[4:5]
    v_exp_f32 v42, v42
    v_exp_f32 v43, v43
    v_cvt_pk_bf16_f32 v51, v38, v39
    v_exp_f32 v44, v44
    v_cvt_pk_bf16_f32 v52, v40, v41
    v_exp_f32 v45, v45
    v_mfma_f32_32x32x16_bf16 a[112:127], v[188:191], v[252:255], a[112:127]
    global_load_lds_dwordx4 v0, s[28:29] offset:3072
    v_add_u32 v0, 0x1000, v0
    v_cvt_pk_bf16_f32 v53, v42, v43
    v_exp_f32 v46, v46
    v_exp_f32 v47, v47
    v_cvt_pk_bf16_f32 v54, v44, v45
    v_cvt_pk_bf16_f32 v55, v46, v47
    v_mfma_f32_32x32x16_bf16 v[88:103], v[140:143], v[48:51], v[88:103]
    s_add_u32 m0, s48, 16384
    v_exp_f32 v16, v16
    v_exp_f32 v17, v17
    v_exp_f32 v18, v18
    v_exp_f32 v19, v19
    v_mfma_f32_32x32x16_bf16 v[32:47], v[136:139], v[68:71], 0
    ds_write_b128 v224, a[120:123] offset:0
    v_exp_f32 v20, v20
    v_exp_f32 v21, v21
    v_cvt_pk_bf16_f32 v48, v16, v17
    v_exp_f32 v22, v22
    v_exp_f32 v23, v23
    v_mfma_f32_32x32x16_bf16 v[88:103], v[144:147], v[52:55], v[88:103]
    ds_write_b128 v224, a[124:127] offset:1024
    v_cvt_pk_bf16_f32 v49, v18, v19
    v_exp_f32 v24, v24
    v_exp_f32 v25, v25
    v_lshrrev_b32 v252, 5, v1
    v_and_b32 v253, 0x1f0, v2
    v_lshl_add_u32 v253, v252, 2, v253
    v_cvt_pk_bf16_f32 v50, v20, v21
    v_exp_f32 v26, v26
    v_exp_f32 v27, v27
    v_add_u32 v253, s43, v253
    v_lshl_add_u32 v252, v252, 5, s48
    v_cvt_pk_bf16_f32 v51, v22, v23
    v_exp_f32 v28, v28
    v_cvt_pk_bf16_f32 v52, v24, v25
    v_exp_f32 v29, v29
    v_cvt_pk_bf16_f32 v53, v26, v27
    v_exp_f32 v30, v30
    v_exp_f32 v31, v31
    v_cvt_pk_bf16_f32 v54, v28, v29
    v_cvt_pk_bf16_f32 v55, v30, v31
    v_mfma_f32_32x32x16_bf16 v[104:119], v[140:143], v[48:51], v[104:119]
    s_waitcnt lgkmcnt(2)
    v_exp_f32 v32, v32
    v_exp_f32 v33, v33
    v_exp_f32 v34, v34
    v_exp_f32 v35, v35
    v_mfma_f32_32x32x16_bf16 v[16:31], v[148:151], v[56:59], 0
    s_waitcnt lgkmcnt(0)
    v_exp_f32 v36, v36
    v_exp_f32 v37, v37
    v_cvt_pk_bf16_f32 v48, v32, v33
    v_exp_f32 v38, v38
    v_exp_f32 v39, v39
    v_mfma_f32_32x32x16_bf16 v[104:119], v[144:147], v[52:55], v[104:119]
    s_barrier
    ds_read_b128 v[224:227], v4 offset:0
    ds_read_b128 v[228:231], v4 offset:1024
    v_cvt_pk_bf16_f32 v49, v34, v35
    v_exp_f32 v40, v40
    v_exp_f32 v41, v41
    v_cvt_pk_bf16_f32 v50, v36, v37
    v_exp_f32 v42, v42
    v_exp_f32 v43, v43
    v_cvt_pk_bf16_f32 v51, v38, v39
    v_exp_f32 v44, v44
    v_cvt_pk_bf16_f32 v52, v40, v41
    v_exp_f32 v45, v45
    v_cvt_pk_bf16_f32 v53, v42, v43
    v_exp_f32 v46, v46
    v_exp_f32 v47, v47
    v_cvt_pk_bf16_f32 v54, v44, v45
    v_cvt_pk_bf16_f32 v55, v46, v47
    v_mfma_f32_32x32x16_bf16 v[120:135], v[140:143], v[48:51], v[120:135]
    ds_read_b128 v[232:235], v4 offset:2048
    ds_read_b128 v[236:239], v4 offset:3072
    v_exp_f32 v16, v16
    v_exp_f32 v17, v17
    v_exp_f32 v18, v18
    v_exp_f32 v19, v19
    v_mfma_f32_32x32x16_bf16 v[32:47], v[148:151], v[60:63], 0
    ds_read_b128 v[240:243], v4 offset:4096
    ds_read_b128 v[244:247], v4 offset:5120
    v_exp_f32 v20, v20
    v_exp_f32 v21, v21
    v_cvt_pk_bf16_f32 v48, v16, v17
    v_exp_f32 v22, v22
    v_exp_f32 v23, v23
    v_mfma_f32_32x32x16_bf16 v[120:135], v[144:147], v[52:55], v[120:135]
    global_load_lds_dwordx4 v0, s[28:29] offset:0
    v_cvt_pk_bf16_f32 v49, v18, v19
    v_exp_f32 v24, v24
    v_exp_f32 v25, v25
    v_cvt_pk_bf16_f32 v50, v20, v21
    v_exp_f32 v26, v26
    v_exp_f32 v27, v27
    v_cvt_pk_bf16_f32 v51, v22, v23
    v_exp_f32 v28, v28
    v_cvt_pk_bf16_f32 v52, v24, v25
    v_exp_f32 v29, v29
    v_cvt_pk_bf16_f32 v53, v26, v27
    v_exp_f32 v30, v30
    v_exp_f32 v31, v31
    v_cvt_pk_bf16_f32 v54, v28, v29
    v_cvt_pk_bf16_f32 v55, v30, v31
    v_mfma_f32_32x32x16_bf16 v[72:87], v[152:155], v[48:51], v[72:87]
    ds_read_b128 v[136:139], v4 offset:20640
    v_exp_f32 v32, v32
    v_exp_f32 v33, v33
    v_exp_f32 v34, v34
    v_exp_f32 v35, v35
    v_mfma_f32_32x32x16_bf16 v[16:31], v[148:151], v[64:67], 0
    ds_read_b128 v[140:143], v5 offset:20640
    v_exp_f32 v36, v36
    v_exp_f32 v37, v37
    v_cvt_pk_bf16_f32 v48, v32, v33
    s_waitcnt lgkmcnt(4)
    v_add_f32 v224, v224, v232
    v_add_f32 v225, v225, v233
    v_exp_f32 v38, v38
    v_exp_f32 v39, v39
    v_mfma_f32_32x32x16_bf16 v[72:87], v[156:159], v[52:55], v[72:87]
    ds_read_b128 v[144:147], v6 offset:20640
    v_cvt_pk_bf16_f32 v49, v34, v35
    v_exp_f32 v40, v40
    v_exp_f32 v41, v41
    v_add_f32 v226, v226, v234
    v_add_f32 v227, v227, v235
    v_add_f32 v228, v228, v236
    v_cvt_pk_bf16_f32 v50, v36, v37
    v_exp_f32 v42, v42
    v_exp_f32 v43, v43
    v_add_f32 v229, v229, v237
    v_add_f32 v230, v230, v238
    v_add_f32 v231, v231, v239
    v_cvt_pk_bf16_f32 v51, v38, v39
    v_exp_f32 v44, v44
    v_cvt_pk_bf16_f32 v52, v40, v41
    s_waitcnt lgkmcnt(3)
    v_add_f32 v224, v224, v240
    v_add_f32 v225, v225, v241
    v_exp_f32 v45, v45
    v_cvt_pk_bf16_f32 v53, v42, v43
    v_exp_f32 v46, v46
    v_add_f32 v226, v226, v242
    v_add_f32 v227, v227, v243
    v_add_f32 v228, v228, v244
    v_exp_f32 v47, v47
    v_cvt_pk_bf16_f32 v54, v44, v45
    v_cvt_pk_bf16_f32 v55, v46, v47
    v_mfma_f32_32x32x16_bf16 v[88:103], v[152:155], v[48:51], v[88:103]
    global_load_lds_dwordx4 v0, s[28:29] offset:1024
    v_exp_f32 v16, v16
    v_exp_f32 v17, v17
    v_add_f32 v229, v229, v245
    v_add_f32 v230, v230, v246
    v_add_f32 v231, v231, v247
    v_exp_f32 v18, v18
    v_exp_f32 v19, v19
    v_mfma_f32_32x32x16_bf16 v[32:47], v[148:151], v[68:71], 0
    global_load_lds_dwordx4 v0, s[28:29] offset:2048
    v_exp_f32 v20, v20
    v_exp_f32 v21, v21
    v_cvt_pk_bf16_f32 v48, v16, v17
    ds_read_b128 v[240:243], v252 offset:33536
    ds_read_b128 v[244:247], v252 offset:33552
    v_accvgpr_read_b32 v232, a112
    v_exp_f32 v22, v22
    v_exp_f32 v23, v23
    v_mfma_f32_32x32x16_bf16 v[88:103], v[156:159], v[52:55], v[88:103]
    global_load_lds_dwordx4 v0, s[28:29] offset:3072
    v_add_u32 v0, 0x1000, v0
    v_cvt_pk_bf16_f32 v49, v18, v19
    v_exp_f32 v24, v24
    v_exp_f32 v25, v25
    v_accvgpr_read_b32 v233, a113
    v_accvgpr_read_b32 v234, a114
    v_accvgpr_read_b32 v235, a115
    v_cvt_pk_bf16_f32 v50, v20, v21
    v_exp_f32 v26, v26
    v_exp_f32 v27, v27
    v_accvgpr_read_b32 v236, a116
    v_accvgpr_read_b32 v237, a117
    v_accvgpr_read_b32 v238, a118
    v_cvt_pk_bf16_f32 v51, v22, v23
    v_exp_f32 v28, v28
    v_cvt_pk_bf16_f32 v52, v24, v25
    v_accvgpr_read_b32 v239, a119
    v_exp_f32 v29, v29
    v_cvt_pk_bf16_f32 v53, v26, v27
    v_exp_f32 v30, v30
    v_add_f32 v224, v224, v232
    v_add_f32 v225, v225, v233
    v_add_f32 v226, v226, v234
    v_exp_f32 v31, v31
    v_cvt_pk_bf16_f32 v54, v28, v29
    v_cvt_pk_bf16_f32 v55, v30, v31
    v_mfma_f32_32x32x16_bf16 v[104:119], v[152:155], v[48:51], v[104:119]
    s_waitcnt lgkmcnt(2)
    v_exp_f32 v32, v32
    v_exp_f32 v33, v33
    v_add_f32 v227, v227, v235
    v_add_f32 v228, v228, v236
    v_add_f32 v229, v229, v237
    v_exp_f32 v34, v34
    v_exp_f32 v35, v35
    v_mfma_f32_32x32x16_bf16 v[16:31], v[136:139], v[56:59], 0
    s_add_u32 m0, s48, 20480
    v_exp_f32 v36, v36
    v_exp_f32 v37, v37
    v_cvt_pk_bf16_f32 v48, v32, v33
    v_add_f32 v230, v230, v238
    v_add_f32 v231, v231, v239
    s_waitcnt vmcnt(5)
    v_exp_f32 v38, v38
    v_exp_f32 v39, v39
    v_mfma_f32_32x32x16_bf16 v[104:119], v[156:159], v[52:55], v[104:119]
    v_cvt_pk_bf16_f32 v49, v34, v35
    v_exp_f32 v40, v40
    v_exp_f32 v41, v41
    v_lshlrev_b32 v232, 16, v248
    v_and_b32 v233, 0xffff0000, v248
    v_lshlrev_b32 v234, 16, v249
    v_cvt_pk_bf16_f32 v50, v36, v37
    v_exp_f32 v42, v42
    v_exp_f32 v43, v43
    v_and_b32 v235, 0xffff0000, v249
    v_lshlrev_b32 v236, 16, v250
    v_and_b32 v237, 0xffff0000, v250
    v_cvt_pk_bf16_f32 v51, v38, v39
    v_exp_f32 v44, v44
    v_cvt_pk_bf16_f32 v52, v40, v41
    v_lshlrev_b32 v238, 16, v251
    v_and_b32 v239, 0xffff0000, v251
    v_exp_f32 v45, v45
    v_cvt_pk_bf16_f32 v53, v42, v43
    v_exp_f32 v46, v46
    s_waitcnt lgkmcnt(0)
    v_fma_f32 v224, v224, v240, v232
    v_fma_f32 v225, v225, v241, v233
    v_exp_f32 v47, v47
    v_cvt_pk_bf16_f32 v54, v44, v45
    v_cvt_pk_bf16_f32 v55, v46, v47
    v_mfma_f32_32x32x16_bf16 v[120:135], v[152:155], v[48:51], v[120:135]
    global_load_lds_dwordx4 v0, s[28:29] offset:0
    v_exp_f32 v16, v16
    v_exp_f32 v17, v17
    v_fma_f32 v226, v226, v242, v234
    v_fma_f32 v227, v227, v243, v235
    v_fma_f32 v228, v228, v244, v236
    v_exp_f32 v18, v18
    v_exp_f32 v19, v19
    v_mfma_f32_32x32x16_bf16 v[32:47], v[136:139], v[60:63], 0
    global_load_lds_dwordx4 v0, s[28:29] offset:1024
    v_exp_f32 v20, v20
    v_exp_f32 v21, v21
    v_cvt_pk_bf16_f32 v48, v16, v17
    v_fma_f32 v229, v229, v245, v237
    v_fma_f32 v230, v230, v246, v238
    v_fma_f32 v231, v231, v247, v239
    s_add_u32 s58, s32, 24576
    s_add_u32 s59, s33, 24576
    v_add_u32 v0, s58, v2
    v_exp_f32 v22, v22
    v_exp_f32 v23, v23
    v_mfma_f32_32x32x16_bf16 v[120:135], v[156:159], v[52:55], v[120:135]
    ds_read_b128 v[240:243], v252 offset:33664
    v_cvt_pk_bf16_f32 v49, v18, v19
    v_exp_f32 v24, v24
    v_exp_f32 v25, v25
    v_cvt_pk_bf16_f32 v248, v224, v225
    v_cvt_pk_bf16_f32 v249, v226, v227
    v_cvt_pk_bf16_f32 v250, v228, v229
    v_cvt_pk_bf16_f32 v50, v20, v21
    v_exp_f32 v26, v26
    v_exp_f32 v27, v27
    v_cvt_pk_bf16_f32 v251, v230, v231
    v_lshlrev_b32 v224, 16, v248
    v_and_b32 v225, 0xffff0000, v248
    v_cvt_pk_bf16_f32 v51, v22, v23
    v_exp_f32 v28, v28
    v_cvt_pk_bf16_f32 v52, v24, v25
    v_lshlrev_b32 v226, 16, v249
    v_and_b32 v227, 0xffff0000, v249
    v_lshlrev_b32 v228, 16, v250
    v_exp_f32 v29, v29
    v_cvt_pk_bf16_f32 v53, v26, v27
    v_exp_f32 v30, v30
    v_and_b32 v229, 0xffff0000, v250
    v_lshlrev_b32 v230, 16, v251
    v_and_b32 v231, 0xffff0000, v251
    v_exp_f32 v31, v31
    v_cvt_pk_bf16_f32 v54, v28, v29
    v_cvt_pk_bf16_f32 v55, v30, v31
    v_mfma_f32_32x32x16_bf16 v[72:87], v[140:143], v[48:51], v[72:87]
    ds_read_b128 v[148:151], v4 offset:22704
    v_exp_f32 v32, v32
    v_exp_f32 v33, v33
    v_sub_f32 v224, v224, v7
    v_sub_f32 v225, v225, v7
    v_sub_f32 v226, v226, v7
    v_exp_f32 v34, v34
    v_exp_f32 v35, v35
    v_mfma_f32_32x32x16_bf16 v[16:31], v[136:139], v[64:67], 0
    ds_read_b128 v[152:155], v5 offset:22704
    v_exp_f32 v36, v36
    v_exp_f32 v37, v37
    v_cvt_pk_bf16_f32 v48, v32, v33
    v_sub_f32 v227, v227, v7
    v_sub_f32 v228, v228, v7
    v_sub_f32 v229, v229, v7
    v_exp_f32 v38, v38
    v_exp_f32 v39, v39
    v_mfma_f32_32x32x16_bf16 v[72:87], v[144:147], v[52:55], v[72:87]
    ds_read_b128 v[156:159], v6 offset:22704
    v_cvt_pk_bf16_f32 v49, v34, v35
    v_exp_f32 v40, v40
    v_exp_f32 v41, v41
    v_sub_f32 v230, v230, v7
    v_sub_f32 v231, v231, v7
    v_add_f32 v232, v224, v228
    v_cvt_pk_bf16_f32 v50, v36, v37
    v_exp_f32 v42, v42
    v_exp_f32 v43, v43
    v_add_f32 v233, v225, v229
    v_add_f32 v234, v226, v230
    v_add_f32 v235, v227, v231
    v_cvt_pk_bf16_f32 v51, v38, v39
    v_exp_f32 v44, v44
    v_cvt_pk_bf16_f32 v52, v40, v41
    v_mul_f32 v236, v224, v224
    v_mul_f32 v237, v225, v225
    v_add_f32 v232, v232, v234
    v_exp_f32 v45, v45
    v_cvt_pk_bf16_f32 v53, v42, v43
    v_exp_f32 v46, v46
    v_add_f32 v233, v233, v235
    v_fma_f32 v236, v226, v226, v236
    v_fma_f32 v237, v227, v227, v237
    v_exp_f32 v47, v47
    v_cvt_pk_bf16_f32 v54, v44, v45
    v_cvt_pk_bf16_f32 v55, v46, v47
    v_mfma_f32_32x32x16_bf16 v[88:103], v[140:143], v[48:51], v[88:103]
    ds_read_b128 v[244:247], v252 offset:33680
    v_exp_f32 v16, v16
    v_exp_f32 v17, v17
    v_fma_f32 v236, v228, v228, v236
    v_fma_f32 v237, v229, v229, v237
    v_fma_f32 v236, v230, v230, v236
    v_exp_f32 v18, v18
    v_exp_f32 v19, v19
    v_mfma_f32_32x32x16_bf16 v[32:47], v[136:139], v[68:71], 0
    global_load_dwordx4 a[112:115], v0, s[28:29] offset:0
    v_exp_f32 v20, v20
    v_exp_f32 v21, v21
    v_cvt_pk_bf16_f32 v48, v16, v17
    v_fma_f32 v237, v231, v231, v237
    v_add_f32 v232, v232, v233
    v_add_f32 v233, v236, v237
    v_exp_f32 v22, v22
    v_exp_f32 v23, v23
    v_mfma_f32_32x32x16_bf16 v[88:103], v[144:147], v[52:55], v[88:103]
    global_load_dwordx4 a[116:119], v0, s[28:29] offset:1024
    v_cvt_pk_bf16_f32 v49, v18, v19
    v_exp_f32 v24, v24
    v_exp_f32 v25, v25
    s_waitcnt lgkmcnt(0)
    v_mul_f32 v240, v224, v240
    v_mul_f32 v241, v225, v241
    v_cvt_pk_bf16_f32 v50, v20, v21
    v_exp_f32 v26, v26
    v_exp_f32 v27, v27
    v_permlane32_swap_b32 v232, v233
    v_mul_f32 v242, v226, v242
    v_mul_f32 v243, v227, v243
    v_cvt_pk_bf16_f32 v51, v22, v23
    v_exp_f32 v28, v28
    v_cvt_pk_bf16_f32 v52, v24, v25
    v_add_f32 v232, v232, v233
    v_mul_f32 v244, v228, v244
    v_mul_f32 v245, v229, v245
    v_exp_f32 v29, v29
    v_cvt_pk_bf16_f32 v53, v26, v27
    v_exp_f32 v30, v30
    v_mul_f32 v246, v230, v246
    v_mul_f32 v247, v231, v247
    v_cmp_u_f32 vcc, v232, v232
    v_exp_f32 v31, v31
    v_cvt_pk_bf16_f32 v54, v28, v29
    v_cvt_pk_bf16_f32 v55, v30, v31
    v_mfma_f32_32x32x16_bf16 v[104:119], v[140:143], v[48:51], v[104:119]
    v_exp_f32 v32, v32
    v_exp_f32 v33, v33
    v_cvt_pk_bf16_f32 v240, v240, v241
    v_cvt_pk_bf16_f32 v241, v242, v243
    v_cvt_pk_bf16_f32 v242, v244, v245
    v_exp_f32 v34, v34
    v_exp_f32 v35, v35
    v_mfma_f32_32x32x16_bf16 v[16:31], v[148:151], v[56:59], 0
    global_load_dwordx4 a[120:123], v0, s[28:29] offset:2048
    v_exp_f32 v36, v36
    v_exp_f32 v37, v37
    v_cvt_pk_bf16_f32 v48, v32, v33
    v_cvt_pk_bf16_f32 v243, v246, v247
    v_exp_f32 v38, v38
    v_exp_f32 v39, v39
    v_mfma_f32_32x32x16_bf16 v[104:119], v[144:147], v[52:55], v[104:119]
    s_or_b64 s[56:57], vcc, s[98:99]
    s_cbranch_scc1 adaLN_cond__grouped_kv_mqa__dense_activation_silu__prompt_kernel_alt114
    global_store_dwordx4 v13, v[240:243], s[8:9]
    global_store_dword v253, v232, s[12:13]
adaLN_cond__grouped_kv_mqa__dense_activation_silu__prompt_kernel_dbk113:
    v_cvt_pk_bf16_f32 v49, v34, v35
    v_exp_f32 v40, v40
    v_exp_f32 v41, v41
    v_cvt_pk_bf16_f32 v50, v36, v37
    v_exp_f32 v42, v42
    v_exp_f32 v43, v43
    v_cvt_pk_bf16_f32 v51, v38, v39
    v_exp_f32 v44, v44
    v_cvt_pk_bf16_f32 v52, v40, v41
    v_exp_f32 v45, v45
    v_cvt_pk_bf16_f32 v53, v42, v43
    v_exp_f32 v46, v46
    v_exp_f32 v47, v47
    v_cvt_pk_bf16_f32 v54, v44, v45
    v_cvt_pk_bf16_f32 v55, v46, v47
    v_mfma_f32_32x32x16_bf16 v[120:135], v[140:143], v[48:51], v[120:135]
    global_load_dwordx4 v[252:255], v14, s[14:15]
    v_exp_f32 v16, v16
    v_exp_f32 v17, v17
    v_and_b32 v244, 0x1f0, v2
    v_lshrrev_b32 v246, 5, v1
    v_exp_f32 v18, v18
    v_exp_f32 v19, v19
    v_mfma_f32_32x32x16_bf16 v[32:47], v[148:151], v[60:63], 0
    global_load_dwordx4 a[124:127], v0, s[28:29] offset:3072
    v_add_u32 v0, s59, v0
    v_exp_f32 v20, v20
    v_exp_f32 v21, v21
    v_cvt_pk_bf16_f32 v48, v16, v17
    s_lshl_b32 s54, s44, 12
    v_lshrrev_b32 v245, 1, v244
    v_exp_f32 v22, v22
    v_exp_f32 v23, v23
    v_mfma_f32_32x32x16_bf16 v[120:135], v[144:147], v[52:55], v[120:135]
    global_load_dwordx4 a[240:243], v0, s[28:29] offset:0
    v_cvt_pk_bf16_f32 v49, v18, v19
    v_exp_f32 v24, v24
    v_exp_f32 v25, v25
    v_lshl_add_u32 v244, v246, 11, v244
    v_add_u32 v244, s54, v244
    v_cvt_pk_bf16_f32 v50, v20, v21
    v_exp_f32 v26, v26
    v_exp_f32 v27, v27
    v_lshl_add_u32 v245, v246, 2, v245
    v_add_u32 v245, s48, v245
    v_cvt_pk_bf16_f32 v51, v22, v23
    v_exp_f32 v28, v28
    v_cvt_pk_bf16_f32 v52, v24, v25
    v_exp_f32 v29, v29
    v_cvt_pk_bf16_f32 v53, v26, v27
    v_exp_f32 v30, v30
    v_exp_f32 v31, v31
    v_cvt_pk_bf16_f32 v54, v28, v29
    v_cvt_pk_bf16_f32 v55, v30, v31
    v_mfma_f32_32x32x16_bf16 v[72:87], v[152:155], v[48:51], v[72:87]
    ds_read_b128 v[136:139], v4 offset:24768
    v_exp_f32 v32, v32
    v_exp_f32 v33, v33
    v_exp_f32 v34, v34
    v_exp_f32 v35, v35
    v_mfma_f32_32x32x16_bf16 v[16:31], v[148:151], v[64:67], 0
    ds_read_b128 v[140:143], v5 offset:24768
    v_exp_f32 v36, v36
    v_exp_f32 v37, v37
    v_cvt_pk_bf16_f32 v48, v32, v33
    v_exp_f32 v38, v38
    v_exp_f32 v39, v39
    v_mfma_f32_32x32x16_bf16 v[72:87], v[156:159], v[52:55], v[72:87]
    ds_read_b128 v[144:147], v6 offset:24768
    v_cvt_pk_bf16_f32 v49, v34, v35
    v_exp_f32 v40, v40
    v_exp_f32 v41, v41
    v_cvt_pk_bf16_f32 v50, v36, v37
    v_exp_f32 v42, v42
    v_exp_f32 v43, v43
    v_cvt_pk_bf16_f32 v51, v38, v39
    v_exp_f32 v44, v44
    v_cvt_pk_bf16_f32 v52, v40, v41
    v_exp_f32 v45, v45
    v_cvt_pk_bf16_f32 v53, v42, v43
    v_exp_f32 v46, v46
    v_exp_f32 v47, v47
    v_cvt_pk_bf16_f32 v54, v44, v45
    v_cvt_pk_bf16_f32 v55, v46, v47
    v_mfma_f32_32x32x16_bf16 v[88:103], v[152:155], v[48:51], v[88:103]
    global_load_dwordx4 a[244:247], v0, s[28:29] offset:1024
    v_exp_f32 v16, v16
    v_exp_f32 v17, v17
    v_exp_f32 v18, v18
    v_exp_f32 v19, v19
    v_mfma_f32_32x32x16_bf16 v[32:47], v[148:151], v[68:71], 0
    global_load_dwordx4 a[248:251], v0, s[28:29] offset:2048
    v_exp_f32 v20, v20
    v_exp_f32 v21, v21
    v_cvt_pk_bf16_f32 v48, v16, v17
    v_exp_f32 v22, v22
    v_exp_f32 v23, v23
    v_mfma_f32_32x32x16_bf16 v[88:103], v[156:159], v[52:55], v[88:103]
    global_load_dwordx4 a[252:255], v0, s[28:29] offset:3072
    v_cvt_pk_bf16_f32 v49, v18, v19
    v_exp_f32 v24, v24
    v_exp_f32 v25, v25
    s_add_u32 s58, s36, 18432
    v_add_u32 v0, s58, v3
    v_cvt_pk_bf16_f32 v50, v20, v21
    v_exp_f32 v26, v26
    v_exp_f32 v27, v27
    v_cvt_pk_bf16_f32 v51, v22, v23
    v_exp_f32 v28, v28
    v_cvt_pk_bf16_f32 v52, v24, v25
    v_exp_f32 v29, v29
    v_cvt_pk_bf16_f32 v53, v26, v27
    v_exp_f32 v30, v30
    v_exp_f32 v31, v31
    v_cvt_pk_bf16_f32 v54, v28, v29
    v_cvt_pk_bf16_f32 v55, v30, v31
    v_mfma_f32_32x32x16_bf16 v[104:119], v[152:155], v[48:51], v[104:119]
    s_waitcnt lgkmcnt(0)
    v_exp_f32 v32, v32
    v_exp_f32 v33, v33
    v_exp_f32 v34, v34
    v_exp_f32 v35, v35
    v_mfma_f32_32x32x16_bf16 v[16:31], v[136:139], v[56:59], 0
    v_exp_f32 v36, v36
    v_exp_f32 v37, v37
    v_cvt_pk_bf16_f32 v48, v32, v33
    v_exp_f32 v38, v38
    v_exp_f32 v39, v39
    v_mfma_f32_32x32x16_bf16 v[104:119], v[156:159], v[52:55], v[104:119]
    v_cvt_pk_bf16_f32 v49, v34, v35
    v_exp_f32 v40, v40
    v_exp_f32 v41, v41
    v_cvt_pk_bf16_f32 v50, v36, v37
    v_exp_f32 v42, v42
    v_exp_f32 v43, v43
    v_cvt_pk_bf16_f32 v51, v38, v39
    v_exp_f32 v44, v44
    v_cvt_pk_bf16_f32 v52, v40, v41
    v_exp_f32 v45, v45
    v_cvt_pk_bf16_f32 v53, v42, v43
    v_exp_f32 v46, v46
    s_add_u32 m0, s48, 28864
    v_exp_f32 v47, v47
    v_cvt_pk_bf16_f32 v54, v44, v45
    v_cvt_pk_bf16_f32 v55, v46, v47
    v_mfma_f32_32x32x16_bf16 v[120:135], v[152:155], v[48:51], v[120:135]
    global_load_lds_dwordx4 v0, s[28:29] offset:-4096
    v_exp_f32 v16, v16
    v_exp_f32 v17, v17
    v_exp_f32 v18, v18
    v_exp_f32 v19, v19
    v_mfma_f32_32x32x16_bf16 v[32:47], v[136:139], v[60:63], 0
    global_load_lds_dwordx4 v0, s[28:29] offset:-3072
    v_exp_f32 v20, v20
    v_exp_f32 v21, v21
    v_cvt_pk_bf16_f32 v48, v16, v17
    v_exp_f32 v22, v22
    v_exp_f32 v23, v23
    v_mfma_f32_32x32x16_bf16 v[120:135], v[156:159], v[52:55], v[120:135]
    v_cvt_pk_bf16_f32 v49, v18, v19
    v_exp_f32 v24, v24
    v_exp_f32 v25, v25
    v_cvt_pk_bf16_f32 v50, v20, v21
    v_exp_f32 v26, v26
    v_exp_f32 v27, v27
    v_cvt_pk_bf16_f32 v51, v22, v23
    v_exp_f32 v28, v28
    v_cvt_pk_bf16_f32 v52, v24, v25
    v_exp_f32 v29, v29
    v_cvt_pk_bf16_f32 v53, v26, v27
    v_exp_f32 v30, v30
    v_exp_f32 v31, v31
    v_cvt_pk_bf16_f32 v54, v28, v29
    v_cvt_pk_bf16_f32 v55, v30, v31
    v_mfma_f32_32x32x16_bf16 v[72:87], v[140:143], v[48:51], v[72:87]
    ds_read_b128 v[148:151], v4 offset:26832
    v_exp_f32 v32, v32
    v_exp_f32 v33, v33
    v_exp_f32 v34, v34
    v_exp_f32 v35, v35
    v_mfma_f32_32x32x16_bf16 v[16:31], v[136:139], v[64:67], 0
    ds_read_b128 v[152:155], v5 offset:26832
    v_exp_f32 v36, v36
    v_exp_f32 v37, v37
    v_cvt_pk_bf16_f32 v48, v32, v33
    v_exp_f32 v38, v38
    v_exp_f32 v39, v39
    v_mfma_f32_32x32x16_bf16 v[72:87], v[144:147], v[52:55], v[72:87]
    ds_read_b128 v[156:159], v6 offset:26832
    v_cvt_pk_bf16_f32 v49, v34, v35
    v_exp_f32 v40, v40
    v_exp_f32 v41, v41
    v_cvt_pk_bf16_f32 v50, v36, v37
    v_exp_f32 v42, v42
    v_exp_f32 v43, v43
    v_cvt_pk_bf16_f32 v51, v38, v39
    v_exp_f32 v44, v44
    v_cvt_pk_bf16_f32 v52, v40, v41
    v_exp_f32 v45, v45
    v_cvt_pk_bf16_f32 v53, v42, v43
    v_exp_f32 v46, v46
    s_add_u32 m0, s48, 4096
    v_exp_f32 v47, v47
    v_cvt_pk_bf16_f32 v54, v44, v45
    v_cvt_pk_bf16_f32 v55, v46, v47
    v_mfma_f32_32x32x16_bf16 v[88:103], v[140:143], v[48:51], v[88:103]
    global_load_lds_dwordx4 v15, s[8:9] offset:-4096 sc1
    v_exp_f32 v16, v16
    v_exp_f32 v17, v17
    v_exp_f32 v18, v18
    v_exp_f32 v19, v19
    v_mfma_f32_32x32x16_bf16 v[32:47], v[136:139], v[68:71], 0
    global_load_lds_dwordx4 v15, s[8:9] offset:-3072 sc1
    v_exp_f32 v20, v20
    v_exp_f32 v21, v21
    v_cvt_pk_bf16_f32 v48, v16, v17
    v_exp_f32 v22, v22
    v_exp_f32 v23, v23
    v_mfma_f32_32x32x16_bf16 v[88:103], v[144:147], v[52:55], v[88:103]
    global_load_lds_dwordx4 v15, s[8:9] offset:-2048 sc1
    v_cvt_pk_bf16_f32 v49, v18, v19
    v_exp_f32 v24, v24
    v_exp_f32 v25, v25
    v_cvt_pk_bf16_f32 v50, v20, v21
    v_exp_f32 v26, v26
    v_exp_f32 v27, v27
    v_cvt_pk_bf16_f32 v51, v22, v23
    v_exp_f32 v28, v28
    v_cvt_pk_bf16_f32 v52, v24, v25
    v_exp_f32 v29, v29
    v_cvt_pk_bf16_f32 v53, v26, v27
    v_exp_f32 v30, v30
    v_exp_f32 v31, v31
    v_cvt_pk_bf16_f32 v54, v28, v29
    v_cvt_pk_bf16_f32 v55, v30, v31
    v_mfma_f32_32x32x16_bf16 v[104:119], v[140:143], v[48:51], v[104:119]
    s_waitcnt lgkmcnt(0)
    v_exp_f32 v32, v32
    v_exp_f32 v33, v33
    v_exp_f32 v34, v34
    v_exp_f32 v35, v35
    v_mfma_f32_32x32x16_bf16 v[16:31], v[148:151], v[56:59], 0
    global_load_lds_dwordx4 v15, s[8:9] offset:-1024 sc1
    v_exp_f32 v36, v36
    v_exp_f32 v37, v37
    v_cvt_pk_bf16_f32 v48, v32, v33
    v_exp_f32 v38, v38
    v_exp_f32 v39, v39
    v_mfma_f32_32x32x16_bf16 v[104:119], v[144:147], v[52:55], v[104:119]
    global_load_lds_dwordx4 v15, s[8:9] offset:0 sc1
    v_cvt_pk_bf16_f32 v49, v34, v35
    v_exp_f32 v40, v40
    v_exp_f32 v41, v41
    v_cvt_pk_bf16_f32 v50, v36, v37
    v_exp_f32 v42, v42
    v_exp_f32 v43, v43
    v_cvt_pk_bf16_f32 v51, v38, v39
    v_exp_f32 v44, v44
    v_cvt_pk_bf16_f32 v52, v40, v41
    v_exp_f32 v45, v45
    v_cvt_pk_bf16_f32 v53, v42, v43
    v_exp_f32 v46, v46
    v_exp_f32 v47, v47
    v_cvt_pk_bf16_f32 v54, v44, v45
    v_cvt_pk_bf16_f32 v55, v46, v47
    v_mfma_f32_32x32x16_bf16 v[120:135], v[140:143], v[48:51], v[120:135]
    global_load_lds_dwordx4 v15, s[8:9] offset:1024 sc1
    v_exp_f32 v16, v16
    v_exp_f32 v17, v17
    v_exp_f32 v18, v18
    v_exp_f32 v19, v19
    v_mfma_f32_32x32x16_bf16 v[32:47], v[148:151], v[60:63], 0
    global_load_lds_dwordx4 v15, s[8:9] offset:2048 sc1
    v_exp_f32 v20, v20
    v_exp_f32 v21, v21
    v_cvt_pk_bf16_f32 v48, v16, v17
    v_exp_f32 v22, v22
    v_exp_f32 v23, v23
    v_mfma_f32_32x32x16_bf16 v[120:135], v[144:147], v[52:55], v[120:135]
    global_load_lds_dwordx4 v15, s[8:9] offset:3072 sc1
    v_cvt_pk_bf16_f32 v49, v18, v19
    v_exp_f32 v24, v24
    v_exp_f32 v25, v25
    s_add_u32 m0, s48, 28864
    v_cvt_pk_bf16_f32 v50, v20, v21
    v_exp_f32 v26, v26
    v_exp_f32 v27, v27
    v_cvt_pk_bf16_f32 v51, v22, v23
    v_exp_f32 v28, v28
    v_cvt_pk_bf16_f32 v52, v24, v25
    v_exp_f32 v29, v29
    v_cvt_pk_bf16_f32 v53, v26, v27
    v_exp_f32 v30, v30
    v_exp_f32 v31, v31
    v_cvt_pk_bf16_f32 v54, v28, v29
    v_cvt_pk_bf16_f32 v55, v30, v31
    v_mfma_f32_32x32x16_bf16 v[72:87], v[152:155], v[48:51], v[72:87]
    ds_read_b128 v[136:139], v4 offset:28896
    v_exp_f32 v32, v32
    v_exp_f32 v33, v33
    v_exp_f32 v34, v34
    v_exp_f32 v35, v35
    v_mfma_f32_32x32x16_bf16 v[16:31], v[148:151], v[64:67], 0
    ds_read_b128 v[140:143], v5 offset:28896
    v_exp_f32 v36, v36
    v_exp_f32 v37, v37
    v_cvt_pk_bf16_f32 v48, v32, v33
    v_exp_f32 v38, v38
    v_exp_f32 v39, v39
    v_mfma_f32_32x32x16_bf16 v[72:87], v[156:159], v[52:55], v[72:87]
    ds_read_b128 v[144:147], v6 offset:28896
    v_cvt_pk_bf16_f32 v49, v34, v35
    v_exp_f32 v40, v40
    v_exp_f32 v41, v41
    v_cvt_pk_bf16_f32 v50, v36, v37
    v_exp_f32 v42, v42
    v_exp_f32 v43, v43
    v_cvt_pk_bf16_f32 v51, v38, v39
    v_exp_f32 v44, v44
    v_cvt_pk_bf16_f32 v52, v40, v41
    v_exp_f32 v45, v45
    v_cvt_pk_bf16_f32 v53, v42, v43
    v_exp_f32 v46, v46
    v_exp_f32 v47, v47
    v_cvt_pk_bf16_f32 v54, v44, v45
    v_cvt_pk_bf16_f32 v55, v46, v47
    v_mfma_f32_32x32x16_bf16 v[88:103], v[152:155], v[48:51], v[88:103]
    global_load_dwordx4 v[224:227], v244, s[12:13] offset:0 sc1
    v_exp_f32 v16, v16
    v_exp_f32 v17, v17
    v_exp_f32 v18, v18
    v_exp_f32 v19, v19
    v_mfma_f32_32x32x16_bf16 v[32:47], v[148:151], v[68:71], 0
    global_load_dwordx4 v[228:231], v244, s[12:13] offset:1024 sc1
    v_exp_f32 v20, v20
    v_exp_f32 v21, v21
    v_cvt_pk_bf16_f32 v48, v16, v17
    v_exp_f32 v22, v22
    v_exp_f32 v23, v23
    v_mfma_f32_32x32x16_bf16 v[88:103], v[156:159], v[52:55], v[88:103]
    global_load_lds_dwordx4 v0, s[28:29] offset:-2048
    v_cvt_pk_bf16_f32 v49, v18, v19
    v_exp_f32 v24, v24
    v_exp_f32 v25, v25
    v_cvt_pk_bf16_f32 v50, v20, v21
    v_exp_f32 v26, v26
    v_exp_f32 v27, v27
    v_cvt_pk_bf16_f32 v51, v22, v23
    v_exp_f32 v28, v28
    v_cvt_pk_bf16_f32 v52, v24, v25
    v_exp_f32 v29, v29
    v_cvt_pk_bf16_f32 v53, v26, v27
    v_exp_f32 v30, v30
    v_exp_f32 v31, v31
    v_cvt_pk_bf16_f32 v54, v28, v29
    v_cvt_pk_bf16_f32 v55, v30, v31
    v_mfma_f32_32x32x16_bf16 v[104:119], v[152:155], v[48:51], v[104:119]
    s_waitcnt lgkmcnt(0)
    v_exp_f32 v32, v32
    v_exp_f32 v33, v33
    v_exp_f32 v34, v34
    v_exp_f32 v35, v35
    v_mfma_f32_32x32x16_bf16 v[16:31], v[136:139], v[60:63], 0
    global_load_lds_dwordx4 v0, s[28:29] offset:-1024
    v_exp_f32 v36, v36
    v_exp_f32 v37, v37
    v_cvt_pk_bf16_f32 v48, v32, v33
    v_exp_f32 v38, v38
    v_exp_f32 v39, v39
    v_mfma_f32_32x32x16_bf16 v[104:119], v[156:159], v[52:55], v[104:119]
    v_cvt_pk_bf16_f32 v49, v34, v35
    v_exp_f32 v40, v40
    v_exp_f32 v41, v41
    v_cvt_pk_bf16_f32 v50, v36, v37
    v_exp_f32 v42, v42
    v_exp_f32 v43, v43
    v_cvt_pk_bf16_f32 v51, v38, v39
    v_exp_f32 v44, v44
    v_cvt_pk_bf16_f32 v52, v40, v41
    v_exp_f32 v45, v45
    v_cvt_pk_bf16_f32 v53, v42, v43
    v_exp_f32 v46, v46
    v_exp_f32 v47, v47
    v_cvt_pk_bf16_f32 v54, v44, v45
    v_cvt_pk_bf16_f32 v55, v46, v47
    v_mfma_f32_32x32x16_bf16 v[120:135], v[152:155], v[48:51], v[120:135]
    global_load_lds_dwordx4 v0, s[28:29] offset:0
    v_exp_f32 v16, v16
    v_exp_f32 v17, v17
    v_exp_f32 v18, v18
    v_exp_f32 v19, v19
    v_mfma_f32_32x32x16_bf16 v[32:47], v[136:139], v[64:67], 0
    global_load_lds_dwordx4 v0, s[28:29] offset:1024
    v_exp_f32 v20, v20
    v_exp_f32 v21, v21
    v_cvt_pk_bf16_f32 v48, v16, v17
    v_exp_f32 v22, v22
    v_exp_f32 v23, v23
    v_mfma_f32_32x32x16_bf16 v[120:135], v[156:159], v[52:55], v[120:135]
    v_cvt_pk_bf16_f32 v49, v18, v19
    v_exp_f32 v24, v24
    v_exp_f32 v25, v25
    v_cvt_pk_bf16_f32 v50, v20, v21
    v_exp_f32 v26, v26
    v_exp_f32 v27, v27
    v_cvt_pk_bf16_f32 v51, v22, v23
    v_exp_f32 v28, v28
    v_cvt_pk_bf16_f32 v52, v24, v25
    v_exp_f32 v29, v29
    v_cvt_pk_bf16_f32 v53, v26, v27
    v_exp_f32 v30, v30
    v_exp_f32 v31, v31
    v_cvt_pk_bf16_f32 v54, v28, v29
    v_cvt_pk_bf16_f32 v55, v30, v31
    v_mfma_f32_32x32x16_bf16 v[88:103], v[140:143], v[48:51], v[88:103]
    ds_read_b128 v[148:151], v4 offset:30960
    v_exp_f32 v32, v32
    v_exp_f32 v33, v33
    v_exp_f32 v34, v34
    v_exp_f32 v35, v35
    v_mfma_f32_32x32x16_bf16 v[16:31], v[136:139], v[68:71], 0
    ds_read_b128 v[152:155], v5 offset:30960
    v_exp_f32 v36, v36
    v_exp_f32 v37, v37
    v_cvt_pk_bf16_f32 v48, v32, v33
    v_exp_f32 v38, v38
    v_exp_f32 v39, v39
    v_mfma_f32_32x32x16_bf16 v[88:103], v[144:147], v[52:55], v[88:103]
    ds_read_b128 v[156:159], v6 offset:30960
    v_cvt_pk_bf16_f32 v49, v34, v35
    v_exp_f32 v40, v40
    v_exp_f32 v41, v41
    v_cvt_pk_bf16_f32 v50, v36, v37
    v_exp_f32 v42, v42
    v_exp_f32 v43, v43
    v_cvt_pk_bf16_f32 v51, v38, v39
    v_exp_f32 v44, v44
    v_cvt_pk_bf16_f32 v52, v40, v41
    v_exp_f32 v45, v45
    v_cvt_pk_bf16_f32 v53, v42, v43
    v_exp_f32 v46, v46
    v_exp_f32 v47, v47
    v_cvt_pk_bf16_f32 v54, v44, v45
    v_cvt_pk_bf16_f32 v55, v46, v47
    v_mfma_f32_32x32x16_bf16 v[104:119], v[140:143], v[48:51], v[104:119]
    s_waitcnt lgkmcnt(0)
    v_exp_f32 v16, v16
    v_exp_f32 v17, v17
    v_exp_f32 v18, v18
    v_exp_f32 v19, v19
    v_mfma_f32_32x32x16_bf16 v[32:47], v[148:151], v[60:63], 0
    v_exp_f32 v20, v20
    v_exp_f32 v21, v21
    v_cvt_pk_bf16_f32 v48, v16, v17
    v_exp_f32 v22, v22
    v_exp_f32 v23, v23
    v_mfma_f32_32x32x16_bf16 v[104:119], v[144:147], v[52:55], v[104:119]
    v_cvt_pk_bf16_f32 v49, v18, v19
    v_exp_f32 v24, v24
    v_exp_f32 v25, v25
    v_cvt_pk_bf16_f32 v50, v20, v21
    v_exp_f32 v26, v26
    v_exp_f32 v27, v27
    v_cvt_pk_bf16_f32 v51, v22, v23
    v_exp_f32 v28, v28
    v_cvt_pk_bf16_f32 v52, v24, v25
    v_exp_f32 v29, v29
    v_cvt_pk_bf16_f32 v53, v26, v27
    v_exp_f32 v30, v30
    s_waitcnt vmcnt(4)
    v_exp_f32 v31, v31
    v_cvt_pk_bf16_f32 v54, v28, v29
    v_cvt_pk_bf16_f32 v55, v30, v31
    v_mfma_f32_32x32x16_bf16 v[120:135], v[140:143], v[48:51], v[120:135]
    ds_read2st64_b32 v[232:233], v4 offset0:0 offset1:4
    v_exp_f32 v32, v32
    v_exp_f32 v33, v33
    v_exp_f32 v34, v34
    v_exp_f32 v35, v35
    v_mfma_f32_32x32x16_bf16 v[16:31], v[148:151], v[64:67], 0
    ds_read2st64_b32 v[234:235], v4 offset0:8 offset1:12
    v_exp_f32 v36, v36
    v_exp_f32 v37, v37
    v_cvt_pk_bf16_f32 v48, v32, v33
    v_exp_f32 v38, v38
    v_exp_f32 v39, v39
    v_mfma_f32_32x32x16_bf16 v[120:135], v[144:147], v[52:55], v[120:135]
    ds_read2st64_b32 v[236:237], v4 offset0:16 offset1:20
    v_cvt_pk_bf16_f32 v49, v34, v35
    v_exp_f32 v40, v40
    v_exp_f32 v41, v41
    v_cvt_pk_bf16_f32 v50, v36, v37
    v_exp_f32 v42, v42
    v_exp_f32 v43, v43
    v_cvt_pk_bf16_f32 v51, v38, v39
    v_exp_f32 v44, v44
    v_cvt_pk_bf16_f32 v52, v40, v41
    v_exp_f32 v45, v45
    v_cvt_pk_bf16_f32 v53, v42, v43
    v_exp_f32 v46, v46
    v_exp_f32 v47, v47
    v_cvt_pk_bf16_f32 v54, v44, v45
    v_cvt_pk_bf16_f32 v55, v46, v47
    v_mfma_f32_32x32x16_bf16 v[88:103], v[152:155], v[48:51], v[88:103]
    ds_read2st64_b32 v[238:239], v4 offset0:24 offset1:28
    v_exp_f32 v16, v16
    v_exp_f32 v17, v17
    v_add_f32 v224, v224, v226
    v_add_f32 v225, v225, v227
    v_exp_f32 v18, v18
    v_exp_f32 v19, v19
    v_mfma_f32_32x32x16_bf16 v[32:47], v[148:151], v[68:71], 0
    global_load_lds_dwordx4 v0, s[28:29] offset:2048
    v_exp_f32 v20, v20
    v_exp_f32 v21, v21
    v_cvt_pk_bf16_f32 v48, v16, v17
    v_add_f32 v228, v228, v230
    v_add_f32 v229, v229, v231
    v_exp_f32 v22, v22
    v_exp_f32 v23, v23
    v_mfma_f32_32x32x16_bf16 v[88:103], v[156:159], v[52:55], v[88:103]
    global_load_lds_dwordx4 v0, s[28:29] offset:3072
    v_cvt_pk_bf16_f32 v49, v18, v19
    v_exp_f32 v24, v24
    v_exp_f32 v25, v25
    v_add_f32 v224, v224, v228
    v_add_f32 v225, v225, v229
    v_cvt_pk_bf16_f32 v50, v20, v21
    v_exp_f32 v26, v26
    v_exp_f32 v27, v27
    s_waitcnt lgkmcnt(0)
    v_max_u32 v240, v232, v233
    v_cvt_pk_bf16_f32 v51, v22, v23
    v_exp_f32 v28, v28
    v_cvt_pk_bf16_f32 v52, v24, v25
    v_max3_u32 v240, v240, v234, v235
    v_max3_u32 v240, v240, v236, v237
    v_exp_f32 v29, v29
    v_cvt_pk_bf16_f32 v53, v26, v27
    v_exp_f32 v30, v30
    v_max3_u32 v240, v240, v238, v239
    v_cmp_eq_u32 vcc, -1, v240
    v_exp_f32 v31, v31
    v_cvt_pk_bf16_f32 v54, v28, v29
    v_cvt_pk_bf16_f32 v55, v30, v31
    v_mfma_f32_32x32x16_bf16 v[104:119], v[152:155], v[48:51], v[104:119]
    ds_write_b128 v10, v[96:99] offset:0
    v_exp_f32 v32, v32
    v_exp_f32 v33, v33
    v_cmp_u_f32 s[56:57], v224, v225
    s_or_b64 vcc, vcc, s[56:57]
    v_exp_f32 v34, v34
    v_exp_f32 v35, v35
    v_mfma_f32_32x32x16_bf16 v[16:31], v[136:139], v[56:59], 0
    ds_write_b128 v10, v[100:103] offset:1024
    v_exp_f32 v36, v36
    v_exp_f32 v37, v37
    v_cvt_pk_bf16_f32 v48, v32, v33
    v_permlane32_swap_b32 v224, v225
    v_add_f32 v224, v224, v225
    v_exp_f32 v38, v38
    v_exp_f32 v39, v39
    v_mfma_f32_32x32x16_bf16 v[104:119], v[156:159], v[52:55], v[104:119]
    ds_write_b32 v10, v88 offset:6144
    v_cvt_pk_bf16_f32 v49, v34, v35
    v_exp_f32 v40, v40
    v_exp_f32 v41, v41
    ds_write_b32 v245, v224 offset:22704
    s_cbranch_vccnz adaLN_cond__grouped_kv_mqa__dense_activation_silu__prompt_kernel_st115
adaLN_cond__grouped_kv_mqa__dense_activation_silu__prompt_kernel_bk117:
    v_cvt_pk_bf16_f32 v50, v36, v37
    v_exp_f32 v42, v42
    v_exp_f32 v43, v43
    v_cvt_pk_bf16_f32 v51, v38, v39
    v_exp_f32 v44, v44
    v_cvt_pk_bf16_f32 v52, v40, v41
    v_exp_f32 v45, v45
    v_cvt_pk_bf16_f32 v53, v42, v43
    v_exp_f32 v46, v46
    v_exp_f32 v47, v47
    v_cvt_pk_bf16_f32 v54, v44, v45
    v_cvt_pk_bf16_f32 v55, v46, v47
    v_mfma_f32_32x32x16_bf16 v[120:135], v[152:155], v[48:51], v[120:135]
    ds_write_b128 v11, v[112:115] offset:2048
    v_exp_f32 v16, v16
    v_exp_f32 v17, v17
    v_exp_f32 v18, v18
    v_exp_f32 v19, v19
    v_mfma_f32_32x32x16_bf16 v[32:47], v[148:151], v[56:59], 0
    ds_write_b128 v11, v[116:119] offset:3072
    v_exp_f32 v20, v20
    v_exp_f32 v21, v21
    v_cvt_pk_bf16_f32 v48, v16, v17
    v_exp_f32 v22, v22
    v_exp_f32 v23, v23
    v_mfma_f32_32x32x16_bf16 v[120:135], v[156:159], v[52:55], v[120:135]
    ds_write_b32 v11, v104 offset:6148
    v_cvt_pk_bf16_f32 v49, v18, v19
    v_exp_f32 v24, v24
    v_exp_f32 v25, v25
    v_cvt_pk_bf16_f32 v50, v20, v21
    v_exp_f32 v26, v26
    v_exp_f32 v27, v27
    v_cvt_pk_bf16_f32 v51, v22, v23
    v_exp_f32 v28, v28
    v_cvt_pk_bf16_f32 v52, v24, v25
    v_exp_f32 v29, v29
    v_cvt_pk_bf16_f32 v53, v26, v27
    v_exp_f32 v30, v30
    v_exp_f32 v31, v31
    v_cvt_pk_bf16_f32 v54, v28, v29
    v_cvt_pk_bf16_f32 v55, v30, v31
    v_mfma_f32_32x32x16_bf16 v[72:87], v[140:143], v[48:51], v[72:87]
    ds_write_b128 v12, v[128:131] offset:4096
    ds_write_b128 v12, v[132:135] offset:5120
    ds_write_b32 v12, v120 offset:6152
    v_exp_f32 v32, v32
    v_exp_f32 v33, v33
    v_exp_f32 v34, v34
    v_exp_f32 v35, v35
    v_exp_f32 v36, v36
    v_exp_f32 v37, v37
    v_cvt_pk_bf16_f32 v48, v32, v33
    v_exp_f32 v38, v38
    v_exp_f32 v39, v39
    v_mfma_f32_32x32x16_bf16 v[72:87], v[144:147], v[52:55], v[72:87]
    s_waitcnt lgkmcnt(0)
    s_barrier
    ds_read_b128 v[112:115], v9 offset:6144
    ds_read_b128 v[88:91], v9 offset:0
    ds_read_b128 v[92:95], v9 offset:1024
    ds_read_b128 v[96:99], v9 offset:2048
    ds_read_b128 v[100:103], v9 offset:3072
    ds_read_b128 v[104:107], v9 offset:4096
    ds_read_b128 v[108:111], v9 offset:5120
    v_cvt_pk_bf16_f32 v49, v34, v35
    v_exp_f32 v40, v40
    v_exp_f32 v41, v41
    v_cvt_pk_bf16_f32 v50, v36, v37
    v_exp_f32 v42, v42
    v_exp_f32 v43, v43
    ds_read_b128 v[224:227], v2 offset:0
    v_cvt_pk_bf16_f32 v51, v38, v39
    v_exp_f32 v44, v44
    v_cvt_pk_bf16_f32 v52, v40, v41
    v_mfma_f32_32x32x16_bf16 v[72:87], v[152:155], v[48:51], v[72:87]
    ds_read_b128 v[228:231], v2 offset:1024
    v_exp_f32 v45, v45
    v_cvt_pk_bf16_f32 v53, v42, v43
    v_exp_f32 v46, v46
    ds_read_b128 v[232:235], v2 offset:2048
    v_exp_f32 v47, v47
    v_cvt_pk_bf16_f32 v54, v44, v45
    v_cvt_pk_bf16_f32 v55, v46, v47
    s_waitcnt lgkmcnt(3)
    v_cmp_ne_u32 vcc, 0, v115
    v_add_f32 v112, v112, v113
    v_mfma_f32_32x32x16_bf16 v[72:87], v[156:159], v[52:55], v[72:87]
    s_or_b64 vcc, vcc, s[98:99]
    s_cbranch_scc1 adaLN_cond__grouped_kv_mqa__dense_activation_silu__prompt_kernel_slow123
    ds_read_b128 v[236:239], v2 offset:3072
    ds_read_b128 v[240:243], v2 offset:4096
    ds_read_b128 v[244:247], v2 offset:5120
    s_waitcnt lgkmcnt(5)
    v_mfma_f32_32x32x16_bf16 v[16:31], a[0:3], v[224:227], 0
    v_add_f32 v88, v88, v96
    v_add_f32 v89, v89, v97
    v_add_f32 v90, v90, v98
    v_add_f32 v91, v91, v99
    v_add_f32 v92, v92, v100
    v_add_f32 v93, v93, v101
    v_add_f32 v94, v94, v102
    v_add_f32 v95, v95, v103
    v_add_f32 v112, v112, v114
    v_mfma_f32_32x32x16_bf16 v[32:47], a[128:131], v[224:227], 0
    ds_read_b128 v[224:227], v2 offset:6144
    v_add_f32 v88, v88, v104
    v_add_f32 v89, v89, v105
    v_add_f32 v90, v90, v106
    v_add_f32 v91, v91, v107
    v_add_f32 v92, v92, v108
    v_add_f32 v93, v93, v109
    v_add_f32 v94, v94, v110
    v_add_f32 v95, v95, v111
    v_add_f32 v112, v112, v72
    s_waitcnt lgkmcnt(5)
    v_mfma_f32_32x32x16_bf16 v[16:31], a[4:7], v[228:231], v[16:31]
    v_rcp_f32 v113, v112
    v_subrev_u32 v114, 0x21800000, v112
    v_add_f32 v88, v88, v80
    v_add_f32 v89, v89, v81
    v_add_f32 v90, v90, v82
    v_add_f32 v91, v91, v83
    v_add_f32 v92, v92, v84
    v_add_f32 v93, v93, v85
    v_mfma_f32_32x32x16_bf16 v[32:47], a[132:135], v[228:231], v[32:47]
    ds_read_b128 v[228:231], v2 offset:7168
    v_add_f32 v94, v94, v86
    v_add_f32 v95, v95, v87
    v_cmp_lt_u32 vcc, 0x3c000000, v114
    v_mul_f32 v88, v88, v113
    v_mul_f32 v89, v89, v113
    v_mul_f32 v90, v90, v113
    v_mul_f32 v91, v91, v113
    v_mul_f32 v92, v92, v113
    v_mul_f32 v93, v93, v113
    s_waitcnt lgkmcnt(5)
    v_mfma_f32_32x32x16_bf16 v[16:31], a[8:11], v[232:235], v[16:31]
    v_mul_f32 v94, v94, v113
    v_mul_f32 v95, v95, v113
    v_cvt_pk_bf16_f32 v116, v88, v89
    v_cvt_pk_bf16_f32 v117, v90, v91
    v_cvt_pk_bf16_f32 v118, v92, v93
    v_cvt_pk_bf16_f32 v119, v94, v95
    s_cbranch_vccnz adaLN_cond__grouped_kv_mqa__dense_activation_silu__prompt_kernel_obad128
    global_store_dwordx4 v13, v[116:119], s[6:7]
adaLN_cond__grouped_kv_mqa__dense_activation_silu__prompt_kernel_obk129:
    v_mfma_f32_32x32x16_bf16 v[32:47], a[136:139], v[232:235], v[32:47]
    ds_read_b128 v[232:235], v2 offset:33792
    s_waitcnt lgkmcnt(5)
    v_mfma_f32_32x32x16_bf16 v[16:31], a[12:15], v[236:239], v[16:31]
    v_mfma_f32_32x32x16_bf16 v[32:47], a[140:143], v[236:239], v[32:47]
    ds_read_b128 v[236:239], v2 offset:34816
    s_waitcnt lgkmcnt(5)
    v_mfma_f32_32x32x16_bf16 v[16:31], a[16:19], v[240:243], v[16:31]
    s_add_u32 s0, s28, s3
    s_addc_u32 s1, s29, 0
    v_add_u32 v5, 67584, v2
    v_and_b32 v54, 31, v1
    v_lshlrev_b32 v54, 3, v54
    v_add_u32 v54, 22704, v54
    v_mfma_f32_32x32x16_bf16 v[32:47], a[144:147], v[240:243], v[32:47]
    global_load_dwordx4 v[60:63], v2, s[0:1] offset:0 sc1
    ds_read_b128 v[240:243], v2 offset:35840
    ds_read2st64_b64 v[72:75], v54 offset0:0 offset1:66
    s_waitcnt lgkmcnt(6)
    v_mfma_f32_32x32x16_bf16 v[16:31], a[20:23], v[244:247], v[16:31]
    global_load_dwordx4 v[156:159], v2, s[0:1] offset:1024 sc1
    ds_read2st64_b64 v[76:79], v54 offset0:132 offset1:198
    v_add_u32 v48, s27, v2
    v_add_u32 v49, s30, v2
    v_mfma_f32_32x32x16_bf16 v[32:47], a[148:151], v[244:247], v[32:47]
    global_load_dwordx4 v[68:71], v2, s[0:1] offset:2048 sc1
    ds_read_b128 v[244:247], v2 offset:36864
    v_add_u32 v50, s31, v2
    v_lshrrev_b32 v52, 5, v1
    v_and_b32 v55, 0x1f0, v2
    s_waitcnt lgkmcnt(7)
    v_mfma_f32_32x32x16_bf16 v[16:31], a[24:27], v[224:227], v[16:31]
    global_load_dwordx4 v[152:155], v2, s[0:1] offset:3072 sc1
    v_lshl_add_u32 v55, v52, 2, v55
    v_add_u32 v55, s43, v55
    v_lshl_add_u32 v52, v52, 5, s48
    v_mfma_f32_32x32x16_bf16 v[32:47], a[152:155], v[224:227], v[32:47]
    ds_read_b128 v[224:227], v2 offset:37888
    ds_read_b128 v[112:115], v52 offset:33536
    ds_read_b128 v[116:119], v52 offset:33552
    s_add_u32 s54, s37, 4096
    s_waitcnt lgkmcnt(9)
    v_mfma_f32_32x32x16_bf16 v[16:31], a[28:31], v[228:231], v[16:31]
    global_load_dwordx4 v[120:123], v15, s[6:7] offset:-4096 sc1
    v_add_u32 v0, s54, v3
    s_mov_b32 s62, 0
    s_mov_b32 s63, -1
    s_mov_b32 s55, 0x07060706
    v_mfma_f32_32x32x16_bf16 v[32:47], a[156:159], v[228:231], v[32:47]
    global_load_dwordx4 v[124:127], v15, s[6:7] offset:-3072 sc1
    ds_read_b128 v[228:231], v2 offset:38912
    s_barrier
    s_waitcnt lgkmcnt(5)
    v_add_f32 v72, v72, v76
    v_mfma_f32_32x32x16_bf16 v[16:31], a[32:35], v[232:235], v[16:31]
    global_load_dwordx4 v[128:131], v15, s[6:7] offset:-2048 sc1
    v_add_f32 v73, v73, v77
    v_add_f32 v74, v74, v78
    v_add_f32 v75, v75, v79
    v_add_f32 v72, v72, v74
    v_mfma_f32_32x32x16_bf16 v[32:47], a[160:163], v[232:235], v[32:47]
    global_load_dwordx4 v[132:135], v15, s[6:7] offset:-1024 sc1
    ds_read_b128 v[232:235], v2 offset:39936
    v_add_f32 v73, v73, v75
    v_mul_f32 v72, 0xbb000000, v72
    v_mul_f32 v73, 0x3b000000, v73
    v_mfma_f32_32x32x16_bf16 v[16:31], a[36:39], v[236:239], v[16:31]
    global_load_dwordx4 v[136:139], v15, s[6:7] offset:0 sc1
    v_fma_f32 v73, -v72, v72, v73
    v_max_f32 v73, 0, v73
    v_add_f32 v73, 0x3727c5ac, v73
    v_mfma_f32_32x32x16_bf16 v[32:47], a[164:167], v[236:239], v[32:47]
    global_load_dwordx4 v[140:143], v15, s[6:7] offset:1024 sc1
    ds_read_b128 v[236:239], v2 offset:40960
    v_rsq_f32 v74, v73
    v_mfma_f32_32x32x16_bf16 v[16:31], a[40:43], v[240:243], v[16:31]
    global_load_dwordx4 v[144:147], v15, s[6:7] offset:2048 sc1
    v_log_f32 v105, v73
    v_mul_f32 v106, v73, v74
    v_mul_f32 v104, 0xbfb8aa3b, v74
    v_mfma_f32_32x32x16_bf16 v[32:47], a[168:171], v[240:243], v[32:47]
    global_load_dwordx4 v[148:151], v15, s[6:7] offset:3072 sc1
    ds_read_b128 v[240:243], v5 offset:0
    v_mul_f32 v105, 0.5, v105
    v_cndmask_b32 v72, v72, v106, s[62:63]
    v_and_b32 v73, 0xffff0000, v72
    s_waitcnt lgkmcnt(7)
    v_mfma_f32_32x32x16_bf16 v[16:31], a[44:47], v[244:247], v[16:31]
    v_and_b32 v6, 0x1f0, v2
    v_lshrrev_b32 v53, 5, v1
    s_lshl_b32 s54, s44, 12
    v_lshrrev_b32 v7, 1, v6
    v_lshl_add_u32 v6, v53, 11, v6
    v_mfma_f32_32x32x16_bf16 v[32:47], a[172:175], v[244:247], v[32:47]
    ds_read_b128 v[244:247], v5 offset:1024
    v_add_u32 v6, s54, v6
    v_lshl_add_u32 v7, v53, 2, v7
    v_add_u32 v7, s48, v7
    v_add_u32 v53, 135168, v2
    v_lshrrev_b32 v65, 16, v72
    s_waitcnt lgkmcnt(7)
    v_mfma_f32_32x32x16_bf16 v[16:31], a[48:51], v[224:227], v[16:31]
    v_sub_f32 v72, v72, v73
    v_cvt_pk_bf16_f32 v64, v73, v72
    s_waitcnt vmcnt(8)
    v_add_f32 v60, v60, v156
    v_add_f32 v61, v61, v157
    v_mfma_f32_32x32x16_bf16 v[32:47], a[176:179], v[224:227], v[32:47]
    ds_read_b128 v[224:227], v5 offset:2048
    v_add_f32 v62, v62, v158
    v_add_f32 v63, v63, v159
    v_add_f32 v60, v60, v62
    v_add_f32 v61, v61, v63
    v_add_f32 v156, v60, v61
    v_add_f32 v68, v68, v152
    v_add_f32 v69, v69, v153
    v_add_f32 v70, v70, v154
    v_add_f32 v71, v71, v155
    v_add_f32 v68, v68, v70
    v_add_f32 v69, v69, v71
    v_add_f32 v158, v68, v69
    v_cmp_u_f32 vcc, v156, v158
    s_cbranch_vccnz adaLN_cond__grouped_kv_mqa__dense_activation_silu__prompt_kernel_st130
adaLN_cond__grouped_kv_mqa__dense_activation_silu__prompt_kernel_bk131:
    s_waitcnt lgkmcnt(5)
    v_mfma_f32_32x32x16_bf16 v[16:31], a[52:55], v[228:231], v[16:31]
    s_waitcnt vmcnt(0)
    v_max_u32 v72, v120, v124
    v_max3_u32 v72, v72, v128, v132
    v_max3_u32 v72, v72, v136, v140
    v_max3_u32 v72, v72, v144, v148
    v_mfma_f32_32x32x16_bf16 v[32:47], a[180:183], v[228:231], v[32:47]
    ds_read_b128 v[228:231], v5 offset:3072
    v_cmp_eq_u32 vcc, -1, v72
    s_cbranch_vccnz adaLN_cond__grouped_kv_mqa__dense_activation_silu__prompt_kernel_st133
adaLN_cond__grouped_kv_mqa__dense_activation_silu__prompt_kernel_bk134:
    v_mfma_f32_32x32x16_bf16 v[88:103], v[192:195], v[120:123], 0
    v_mfma_f32_32x32x16_bf16 v[88:103], v[196:199], v[124:127], v[88:103]
    global_load_dwordx4 v[192:195], v0, s[28:29] offset:-4096
    v_mfma_f32_32x32x16_bf16 v[88:103], v[200:203], v[128:131], v[88:103]
    global_load_dwordx4 v[196:199], v0, s[28:29] offset:-3072
    v_mfma_f32_32x32x16_bf16 v[88:103], v[204:207], v[132:135], v[88:103]
    global_load_dwordx4 v[200:203], v0, s[28:29] offset:-2048
    v_mfma_f32_32x32x16_bf16 v[88:103], v[208:211], v[136:139], v[88:103]
    global_load_dwordx4 v[204:207], v0, s[28:29] offset:-1024
    v_mfma_f32_32x32x16_bf16 v[88:103], v[212:215], v[140:143], v[88:103]
    global_load_dwordx4 v[208:211], v0, s[28:29] offset:0
    v_mfma_f32_32x32x16_bf16 v[88:103], v[216:219], v[144:147], v[88:103]
    global_load_dwordx4 v[212:215], v0, s[28:29] offset:1024
    v_mfma_f32_32x32x16_bf16 v[88:103], v[220:223], v[148:151], v[88:103]
    global_load_dwordx4 v[216:219], v0, s[28:29] offset:2048
    v_and_b32 v157, 0xffff0000, v156
    v_perm_b32 v56, v156, v156, s55
    v_sub_f32 v156, v156, v157
    v_cvt_pk_bf16_f32 v57, v156, 0
    v_mov_b32 v58, 0
    v_mfma_f32_32x32x16_bf16 v[72:87], v[160:163], v[120:123], 0
    global_load_dwordx4 v[220:223], v0, s[28:29] offset:3072
    v_add_u32 v0, 0x2000, v0
    v_mov_b32 v59, 0
    v_and_b32 v159, 0xffff0000, v158
    v_perm_b32 v60, v158, v158, s55
    v_sub_f32 v158, v158, v159
    v_mfma_f32_32x32x16_bf16 v[72:87], v[164:167], v[124:127], v[72:87]
    v_cvt_pk_bf16_f32 v61, v158, 0
    v_mov_b32 v62, 0
    v_mov_b32 v63, 0
    v_mov_b32 v66, 0
    v_mov_b32 v67, 0
    v_mov_b32 v70, 0
    v_mfma_f32_32x32x16_bf16 v[72:87], v[168:171], v[128:131], v[72:87]
    ds_write_b128 v11, v[88:91] offset:2048
    v_mov_b32 v71, 0
    v_mfma_f32_32x32x16_bf16 v[72:87], v[172:175], v[132:135], v[72:87]
    ds_write_b128 v11, v[92:95] offset:3072
    v_mfma_f32_32x32x16_bf16 v[72:87], v[176:179], v[136:139], v[72:87]
    ds_write_b128 v12, v[96:99] offset:4096
    v_mfma_f32_32x32x16_bf16 v[72:87], v[180:183], v[140:143], v[72:87]
    ds_write_b128 v12, v[100:103] offset:5120
    v_mfma_f32_32x32x16_bf16 v[72:87], v[184:187], v[144:147], v[72:87]
    ds_read_b128 v[120:123], v52 offset:33664
    v_mfma_f32_32x32x16_bf16 v[72:87], v[188:191], v[148:151], v[72:87]
    ds_read_b128 v[124:127], v52 offset:33680
    v_mfma_f32_32x32x16_bf16 v[16:31], v[56:59], v[64:67], v[16:31]
    global_load_dwordx4 v[160:163], v0, s[28:29] offset:-4096
    v_lshlrev_b32 v128, 16, v252
    v_and_b32 v129, 0xffff0000, v252
    v_lshlrev_b32 v130, 16, v253
    v_and_b32 v131, 0xffff0000, v253
    v_lshlrev_b32 v132, 16, v254
    v_and_b32 v133, 0xffff0000, v254
    v_lshlrev_b32 v134, 16, v255
    v_and_b32 v135, 0xffff0000, v255
    v_mfma_f32_32x32x16_bf16 v[32:47], v[60:63], v[64:67], v[32:47]
    ds_write_b128 v10, v[80:83] offset:0
    ds_write_b128 v10, v[84:87] offset:1024
    s_waitcnt lgkmcnt(0)
    s_barrier
    ds_read_b128 v[80:83], v9 offset:0
    ds_read_b128 v[84:87], v9 offset:1024
    v_mfma_f32_32x32x16_bf16 v[16:31], a[56:59], v[232:235], v[16:31]
    global_load_dwordx4 v[164:167], v0, s[28:29] offset:-3072
    ds_read_b128 v[88:91], v9 offset:2048
    ds_read_b128 v[92:95], v9 offset:3072
    ds_read_b128 v[96:99], v9 offset:4096
    ds_read_b128 v[100:103], v9 offset:5120
    v_mfma_f32_32x32x16_bf16 v[32:47], a[184:187], v[232:235], v[32:47]
    ds_read_b128 v[232:235], v5 offset:4096
    s_waitcnt lgkmcnt(5)
    v_add_f32 v72, v72, v80
    v_add_f32 v73, v73, v81
    v_add_f32 v74, v74, v82
    v_add_f32 v75, v75, v83
    v_add_f32 v76, v76, v84
    v_add_f32 v77, v77, v85
    v_add_f32 v78, v78, v86
    v_add_f32 v79, v79, v87
    v_mfma_f32_32x32x16_bf16 v[16:31], a[60:63], v[236:239], v[16:31]
    global_load_dwordx4 v[168:171], v0, s[28:29] offset:-2048
    s_waitcnt lgkmcnt(3)
    v_add_f32 v72, v72, v88
    v_add_f32 v73, v73, v89
    v_add_f32 v74, v74, v90
    v_add_f32 v75, v75, v91
    v_add_f32 v76, v76, v92
    v_add_f32 v77, v77, v93
    v_add_f32 v78, v78, v94
    v_mfma_f32_32x32x16_bf16 v[32:47], a[188:191], v[236:239], v[32:47]
    ds_read_b128 v[236:239], v5 offset:5120
    v_add_f32 v79, v79, v95
    s_waitcnt lgkmcnt(2)
    v_add_f32 v72, v72, v96
    v_add_f32 v73, v73, v97
    v_add_f32 v74, v74, v98
    v_add_f32 v75, v75, v99
    v_add_f32 v76, v76, v100
    v_add_f32 v77, v77, v101
    v_add_f32 v78, v78, v102
    v_mfma_f32_32x32x16_bf16 v[16:31], a[64:67], v[240:243], v[16:31]
    global_load_dwordx4 v[172:175], v0, s[28:29] offset:-1024
    v_add_f32 v79, v79, v103
    v_fma_f32 v72, v72, v112, v128
    v_fma_f32 v73, v73, v113, v129
    v_fma_f32 v74, v74, v114, v130
    v_fma_f32 v75, v75, v115, v131
    v_fma_f32 v76, v76, v116, v132
    v_fma_f32 v77, v77, v117, v133
    v_fma_f32 v78, v78, v118, v134
    v_mfma_f32_32x32x16_bf16 v[32:47], a[192:195], v[240:243], v[32:47]
    ds_read_b128 v[240:243], v5 offset:6144
    v_fma_f32 v79, v79, v119, v135
    v_cvt_pk_bf16_f32 v252, v72, v73
    v_cvt_pk_bf16_f32 v253, v74, v75
    v_cvt_pk_bf16_f32 v254, v76, v77
    v_cvt_pk_bf16_f32 v255, v78, v79
    v_lshlrev_b32 v72, 16, v252
    v_and_b32 v73, 0xffff0000, v252
    v_lshlrev_b32 v74, 16, v253
    v_and_b32 v75, 0xffff0000, v253
    v_mfma_f32_32x32x16_bf16 v[16:31], a[68:71], v[244:247], v[16:31]
    global_load_dwordx4 v[176:179], v0, s[28:29] offset:0
    v_lshlrev_b32 v76, 16, v254
    v_and_b32 v77, 0xffff0000, v254
    v_lshlrev_b32 v78, 16, v255
    v_and_b32 v79, 0xffff0000, v255
    v_sub_f32 v72, v72, v8
    v_sub_f32 v73, v73, v8
    v_sub_f32 v74, v74, v8
    v_sub_f32 v75, v75, v8
    v_mfma_f32_32x32x16_bf16 v[32:47], a[196:199], v[244:247], v[32:47]
    ds_read_b128 v[244:247], v5 offset:7168
    v_sub_f32 v76, v76, v8
    v_sub_f32 v77, v77, v8
    v_sub_f32 v78, v78, v8
    v_sub_f32 v79, v79, v8
    v_mul_f32 v120, v72, v120
    v_mul_f32 v121, v73, v121
    v_mul_f32 v122, v74, v122
    v_mul_f32 v123, v75, v123
    v_mul_f32 v124, v76, v124
    v_mfma_f32_32x32x16_bf16 v[16:31], a[72:75], v[224:227], v[16:31]
    global_load_dwordx4 v[180:183], v0, s[28:29] offset:1024
    v_mul_f32 v125, v77, v125
    v_mul_f32 v126, v78, v126
    v_mul_f32 v127, v79, v127
    v_cvt_pk_bf16_f32 v120, v120, v121
    v_cvt_pk_bf16_f32 v121, v122, v123
    v_cvt_pk_bf16_f32 v122, v124, v125
    v_cvt_pk_bf16_f32 v123, v126, v127
    v_mfma_f32_32x32x16_bf16 v[32:47], a[200:203], v[224:227], v[32:47]
    ds_read_b128 v[224:227], v5 offset:33792
    global_store_dwordx4 v13, v[120:123], s[10:11]
    v_add_f32 v80, v72, v76
    v_add_f32 v81, v73, v77
    v_add_f32 v82, v74, v78
    v_add_f32 v83, v75, v79
    v_mul_f32 v84, v72, v72
    v_mul_f32 v85, v73, v73
    v_add_f32 v80, v80, v82
    v_mfma_f32_32x32x16_bf16 v[16:31], a[76:79], v[228:231], v[16:31]
    global_load_dwordx4 v[184:187], v0, s[28:29] offset:2048
    v_add_f32 v81, v81, v83
    v_fma_f32 v84, v74, v74, v84
    v_fma_f32 v85, v75, v75, v85
    v_fma_f32 v84, v76, v76, v84
    v_fma_f32 v85, v77, v77, v85
    v_fma_f32 v84, v78, v78, v84
    v_fma_f32 v85, v79, v79, v85
    v_add_f32 v80, v80, v81
    v_mfma_f32_32x32x16_bf16 v[32:47], a[204:207], v[228:231], v[32:47]
    ds_read_b128 v[228:231], v5 offset:34816
    v_add_f32 v81, v84, v85
    v_add_u32 v8, s38, v2
    v_add_u32 v13, s22, v8
    v_permlane32_swap_b32 v80, v81
    v_add_f32 v80, v80, v81
    global_store_dword v55, v80, s[12:13] offset:512
    s_waitcnt lgkmcnt(5)
    v_mfma_f32_32x32x16_bf16 v[16:31], a[80:83], v[232:235], v[16:31]
    global_load_dwordx4 v[188:191], v0, s[28:29] offset:3072
    v_add_u32 v0, 0x2000, v0
    v_mfma_f32_32x32x16_bf16 v[32:47], a[208:211], v[232:235], v[32:47]
    ds_read_b128 v[232:235], v5 offset:35840
    s_waitcnt lgkmcnt(5)
    v_mfma_f32_32x32x16_bf16 v[16:31], a[84:87], v[236:239], v[16:31]
    v_mfma_f32_32x32x16_bf16 v[32:47], a[212:215], v[236:239], v[32:47]
    ds_read_b128 v[236:239], v5 offset:36864
    s_waitcnt lgkmcnt(5)
    v_mfma_f32_32x32x16_bf16 v[16:31], a[88:91], v[240:243], v[16:31]
    global_load_dwordx4 v[136:139], v0, s[28:29] offset:-4096
    v_mfma_f32_32x32x16_bf16 v[32:47], a[216:219], v[240:243], v[32:47]
    ds_read_b128 v[240:243], v5 offset:37888
    s_waitcnt lgkmcnt(5)
    v_mfma_f32_32x32x16_bf16 v[16:31], a[92:95], v[244:247], v[16:31]
    global_load_dwordx4 v[140:143], v0, s[28:29] offset:-3072
    v_mfma_f32_32x32x16_bf16 v[32:47], a[220:223], v[244:247], v[32:47]
    ds_read_b128 v[244:247], v5 offset:38912
    s_waitcnt lgkmcnt(5)
    v_mfma_f32_32x32x16_bf16 v[16:31], a[96:99], v[224:227], v[16:31]
    s_add_u32 m0, s49, 4096
    s_nop 0
    global_load_lds_dwordx4 v15, s[10:11] offset:-4096 sc1
    v_mfma_f32_32x32x16_bf16 v[32:47], a[224:227], v[224:227], v[32:47]
    global_load_lds_dwordx4 v15, s[10:11] offset:-3072 sc1
    ds_read_b128 v[224:227], v5 offset:39936
    s_waitcnt lgkmcnt(5)
    v_mfma_f32_32x32x16_bf16 v[16:31], a[100:103], v[228:231], v[16:31]
    global_load_lds_dwordx4 v15, s[10:11] offset:-2048 sc1
    v_mfma_f32_32x32x16_bf16 v[32:47], a[228:231], v[228:231], v[32:47]
    global_load_lds_dwordx4 v15, s[10:11] offset:-1024 sc1
    ds_read_b128 v[228:231], v5 offset:40960
    s_waitcnt lgkmcnt(5)
    v_mfma_f32_32x32x16_bf16 v[16:31], a[104:107], v[232:235], v[16:31]
    global_load_lds_dwordx4 v15, s[10:11] offset:0 sc1
    v_mfma_f32_32x32x16_bf16 v[32:47], a[232:235], v[232:235], v[32:47]
    global_load_lds_dwordx4 v15, s[10:11] offset:1024 sc1
    s_waitcnt lgkmcnt(4)
    v_mfma_f32_32x32x16_bf16 v[16:31], a[108:111], v[236:239], v[16:31]
    global_load_lds_dwordx4 v15, s[10:11] offset:2048 sc1
    s_add_u32 m0, s48, 20672
    v_mfma_f32_32x32x16_bf16 v[32:47], a[236:239], v[236:239], v[32:47]
    global_load_lds_dwordx4 v15, s[10:11] offset:3072 sc1
    s_waitcnt lgkmcnt(3)
    v_mfma_f32_32x32x16_bf16 v[16:31], a[112:115], v[240:243], v[16:31]
    global_load_dwordx4 v[84:87], v6, s[12:13] offset:512 sc1
    v_mfma_f32_32x32x16_bf16 v[32:47], a[240:243], v[240:243], v[32:47]
    global_load_dwordx4 v[88:91], v6, s[12:13] offset:1536 sc1
    s_waitcnt lgkmcnt(2)
    v_mfma_f32_32x32x16_bf16 v[16:31], a[116:119], v[244:247], v[16:31]
    global_load_dwordx4 v[144:147], v0, s[28:29] offset:-2048
    v_mfma_f32_32x32x16_bf16 v[32:47], a[244:247], v[244:247], v[32:47]
    s_waitcnt lgkmcnt(1)
    v_mfma_f32_32x32x16_bf16 v[16:31], a[120:123], v[224:227], v[16:31]
    global_load_dwordx4 v[148:151], v0, s[28:29] offset:-1024
    v_mfma_f32_32x32x16_bf16 v[32:47], a[248:251], v[224:227], v[32:47]
    s_waitcnt lgkmcnt(0)
    v_mfma_f32_32x32x16_bf16 v[16:31], a[124:127], v[228:231], v[16:31]
    global_load_dwordx4 v[152:155], v0, s[28:29] offset:0
    v_mfma_f32_32x32x16_bf16 v[32:47], a[252:255], v[228:231], v[32:47]
    s_mul_i32 s54, s44, 29696
    s_add_u32 s54, s54, 4096
    v_add_u32 v110, s54, v2
    v_add_u32 v111, 8192, v110
    v_add_u32 v52, 16384, v110
    v_add_u32 v51, 24576, v110
    s_nop 3
    v_fma_f32 v112, v16, v104, v105
    v_fma_f32 v113, v17, v104, v105
    v_fma_f32 v114, v18, v104, v105
    v_fma_f32 v115, v19, v104, v105
    v_fma_f32 v116, v20, v104, v105
    v_fma_f32 v117, v21, v104, v105
    v_fma_f32 v118, v22, v104, v105
    v_fma_f32 v119, v23, v104, v105
    v_exp_f32 v112, v112
    v_exp_f32 v113, v113
    v_exp_f32 v114, v114
    global_load_dwordx4 v[156:159], v0, s[28:29] offset:1024
    v_exp_f32 v115, v115
    v_exp_f32 v116, v116
    v_exp_f32 v117, v117
    v_exp_f32 v118, v118
    v_exp_f32 v119, v119
    v_add_f32 v112, v112, v106
    v_add_f32 v113, v113, v106
    v_add_f32 v114, v114, v106
    v_add_f32 v115, v115, v106
    global_load_dwordx4 v[128:131], v0, s[28:29] offset:2048
    v_add_f32 v116, v116, v106
    v_add_f32 v117, v117, v106
    v_add_f32 v118, v118, v106
    v_add_f32 v119, v119, v106
    s_waitcnt vmcnt(5)
    ds_read2st64_b32 v[92:93], v9 offset0:0 offset1:4
    ds_read2st64_b32 v[94:95], v9 offset0:8 offset1:12
    ds_read2st64_b32 v[96:97], v9 offset0:16 offset1:20
    ds_read_b32 v98, v9 offset:6144
    ds_read_b32 v99, v4 offset:23744
    v_add_f32 v84, v84, v86
    v_add_f32 v85, v85, v87
    v_add_f32 v88, v88, v90
    v_add_f32 v89, v89, v91
    v_add_f32 v84, v84, v88
    v_add_f32 v85, v85, v89
    v_rcp_f32 v112, v112
    v_rcp_f32 v113, v113
    v_rcp_f32 v114, v114
    v_rcp_f32 v115, v115
    v_rcp_f32 v116, v116
    v_rcp_f32 v117, v117
    v_rcp_f32 v118, v118
    global_load_dwordx4 v[132:135], v0, s[28:29] offset:3072
    v_add_u32 v0, 0x2000, v0
    v_rcp_f32 v119, v119
    s_waitcnt lgkmcnt(0)
    v_max_u32 v100, v92, v93
    v_max3_u32 v100, v100, v94, v95
    v_max3_u32 v100, v100, v96, v97
    v_max3_u32 v100, v100, v98, v99
    v_cmp_eq_u32 vcc, -1, v100
    v_cmp_u_f32 s[56:57], v84, v85
    s_or_b64 vcc, vcc, s[56:57]
    v_permlane32_swap_b32 v84, v85
    v_add_f32 v84, v84, v85
    ds_write_b32 v7, v84 offset:23216
    s_cbranch_vccnz adaLN_cond__grouped_kv_mqa__dense_activation_silu__prompt_kernel_st136
adaLN_cond__grouped_kv_mqa__dense_activation_silu__prompt_kernel_bk138:
    s_waitcnt lgkmcnt(0)
    s_barrier
    ds_read_b128 v[232:235], v53 offset:0
    ds_read_b128 v[236:239], v53 offset:1024
    ds_read_b128 v[240:243], v53 offset:2048
    ds_read_b128 v[244:247], v53 offset:3072
    ds_read_b128 v[224:227], v53 offset:4096
    ds_read_b128 v[228:231], v53 offset:5120
    v_mul_f32 v16, v16, v112
    v_mul_f32 v17, v17, v113
    v_mul_f32 v18, v18, v114
    v_mul_f32 v19, v19, v115
    v_mul_f32 v20, v20, v116
    v_mul_f32 v21, v21, v117
    v_mul_f32 v22, v22, v118
    v_mul_f32 v23, v23, v119
    s_waitcnt lgkmcnt(5)
    v_mfma_f32_32x32x16_bf16 v[72:87], a[0:3], v[232:235], 0
    global_load_dwordx4 v[120:123], v0, s[28:29] offset:-4096
    v_cvt_pk_bf16_f32 v16, v16, v17
    v_cvt_pk_bf16_f32 v17, v18, v19
    v_cvt_pk_bf16_f32 v18, v20, v21
    v_cvt_pk_bf16_f32 v19, v22, v23
    v_mfma_f32_32x32x16_bf16 v[88:103], a[128:131], v[232:235], 0
    ds_read_b128 v[232:235], v53 offset:6144
    global_store_dwordx4 v8, v[16:19], s[18:19] offset:0
    v_fma_f32 v112, v24, v104, v105
    v_fma_f32 v113, v25, v104, v105
    v_fma_f32 v114, v26, v104, v105
    s_waitcnt lgkmcnt(5)
    v_mfma_f32_32x32x16_bf16 v[72:87], a[4:7], v[236:239], v[72:87]
    global_load_dwordx4 v[124:127], v0, s[28:29] offset:-3072
    v_fma_f32 v115, v27, v104, v105
    v_fma_f32 v116, v28, v104, v105
    v_fma_f32 v117, v29, v104, v105
    v_fma_f32 v118, v30, v104, v105
    v_mfma_f32_32x32x16_bf16 v[88:103], a[132:135], v[236:239], v[88:103]
    ds_read_b128 v[236:239], v2 offset:23744
    v_fma_f32 v119, v31, v104, v105
    v_exp_f32 v112, v112
    v_exp_f32 v113, v113
    s_waitcnt lgkmcnt(5)
    v_mfma_f32_32x32x16_bf16 v[72:87], a[8:11], v[240:243], v[72:87]
    v_exp_f32 v114, v114
    v_exp_f32 v115, v115
    v_mfma_f32_32x32x16_bf16 v[88:103], a[136:139], v[240:243], v[88:103]
    ds_read_b128 v[240:243], v53 offset:7168
    v_exp_f32 v116, v116
    v_exp_f32 v117, v117
    s_waitcnt lgkmcnt(5)
    v_mfma_f32_32x32x16_bf16 v[72:87], a[12:15], v[244:247], v[72:87]
    v_exp_f32 v118, v118
    v_exp_f32 v119, v119
    v_add_f32 v112, v112, v106
    v_mfma_f32_32x32x16_bf16 v[88:103], a[140:143], v[244:247], v[88:103]
    ds_read_b128 v[244:247], v53 offset:8192
    v_add_f32 v113, v113, v106
    v_add_f32 v114, v114, v106
    v_add_f32 v115, v115, v106
    v_add_f32 v116, v116, v106
    v_add_f32 v117, v117, v106
    s_waitcnt lgkmcnt(5)
    v_mfma_f32_32x32x16_bf16 v[72:87], a[16:19], v[224:227], v[72:87]
    global_load_dwordx4 a[0:3], v0, s[28:29] offset:-2048
    v_add_f32 v118, v118, v106
    v_add_f32 v119, v119, v106
    v_rcp_f32 v112, v112
    v_mfma_f32_32x32x16_bf16 v[88:103], a[144:147], v[224:227], v[88:103]
    ds_read_b128 v[224:227], v53 offset:9216
    v_rcp_f32 v113, v113
    v_rcp_f32 v114, v114
    s_waitcnt lgkmcnt(5)
    v_mfma_f32_32x32x16_bf16 v[72:87], a[20:23], v[228:231], v[72:87]
    global_load_dwordx4 a[128:131], v0, s[28:29] offset:-1024
    s_add_u32 s55, s36, 24576
    v_add_u32 v0, s55, v3
    v_rcp_f32 v115, v115
    v_mfma_f32_32x32x16_bf16 v[88:103], a[148:151], v[228:231], v[88:103]
    ds_read_b128 v[228:231], v53 offset:10240
    v_rcp_f32 v116, v116
    v_rcp_f32 v117, v117
    s_waitcnt lgkmcnt(5)
    v_mfma_f32_32x32x16_bf16 v[72:87], a[24:27], v[232:235], v[72:87]
    global_load_dwordx4 a[4:7], v0, s[28:29] offset:-2048
    v_rcp_f32 v118, v118
    v_rcp_f32 v119, v119
    v_mfma_f32_32x32x16_bf16 v[88:103], a[152:155], v[232:235], v[88:103]
    ds_read_b128 v[232:235], v53 offset:11264
    v_mul_f32 v24, v24, v112
    v_mul_f32 v25, v25, v113
    v_mul_f32 v26, v26, v114
    v_mul_f32 v27, v27, v115
    v_mul_f32 v28, v28, v116
    s_waitcnt lgkmcnt(5)
    v_mfma_f32_32x32x16_bf16 v[72:87], a[28:31], v[236:239], v[72:87]
    global_load_dwordx4 a[132:135], v0, s[28:29] offset:-1024
    v_mul_f32 v29, v29, v117
    v_mul_f32 v30, v30, v118
    v_mul_f32 v31, v31, v119
    v_cvt_pk_bf16_f32 v24, v24, v25
    v_mfma_f32_32x32x16_bf16 v[88:103], a[156:159], v[236:239], v[88:103]
    ds_read_b128 v[236:239], v53 offset:12288
    v_cvt_pk_bf16_f32 v25, v26, v27
    v_cvt_pk_bf16_f32 v26, v28, v29
    v_cvt_pk_bf16_f32 v27, v30, v31
    global_store_dwordx4 v8, v[24:27], s[18:19] offset:1024
    s_waitcnt lgkmcnt(5)
    v_mfma_f32_32x32x16_bf16 v[72:87], a[32:35], v[240:243], v[72:87]
    global_load_dwordx4 a[8:11], v0, s[28:29] offset:0
    v_fma_f32 v112, v32, v104, v105
    v_fma_f32 v113, v33, v104, v105
    v_fma_f32 v114, v34, v104, v105
    v_fma_f32 v115, v35, v104, v105
    v_mfma_f32_32x32x16_bf16 v[88:103], a[160:163], v[240:243], v[88:103]
    ds_read_b128 v[240:243], v53 offset:13312
    v_fma_f32 v116, v36, v104, v105
    v_fma_f32 v117, v37, v104, v105
    v_fma_f32 v118, v38, v104, v105
    v_fma_f32 v119, v39, v104, v105
    s_waitcnt lgkmcnt(5)
    v_mfma_f32_32x32x16_bf16 v[72:87], a[36:39], v[244:247], v[72:87]
    global_load_dwordx4 a[136:139], v0, s[28:29] offset:1024
    v_exp_f32 v112, v112
    v_exp_f32 v113, v113
    v_mfma_f32_32x32x16_bf16 v[88:103], a[164:167], v[244:247], v[88:103]
    ds_read_b128 v[244:247], v2 offset:57536
    v_exp_f32 v114, v114
    v_exp_f32 v115, v115
    s_waitcnt lgkmcnt(5)
    v_mfma_f32_32x32x16_bf16 v[72:87], a[40:43], v[224:227], v[72:87]
    global_load_dwordx4 a[12:15], v0, s[28:29] offset:2048
    v_exp_f32 v116, v116
    v_exp_f32 v117, v117
    v_mfma_f32_32x32x16_bf16 v[88:103], a[168:171], v[224:227], v[88:103]
    ds_read_b128 v[224:227], v53 offset:14336
    v_exp_f32 v118, v118
    v_exp_f32 v119, v119
    v_add_f32 v112, v112, v106
    s_waitcnt lgkmcnt(5)
    v_mfma_f32_32x32x16_bf16 v[72:87], a[44:47], v[228:231], v[72:87]
    global_load_dwordx4 a[140:143], v0, s[28:29] offset:3072
    v_add_f32 v113, v113, v106
    v_add_f32 v114, v114, v106
    v_add_f32 v115, v115, v106
    v_add_f32 v116, v116, v106
    v_mfma_f32_32x32x16_bf16 v[88:103], a[172:175], v[228:231], v[88:103]
    ds_read_b128 v[228:231], v53 offset:15360
    v_add_f32 v117, v117, v106
    v_add_f32 v118, v118, v106
    v_add_f32 v119, v119, v106
    v_rcp_f32 v112, v112
    s_waitcnt lgkmcnt(5)
    v_mfma_f32_32x32x16_bf16 v[72:87], a[48:51], v[232:235], v[72:87]
    v_rcp_f32 v113, v113
    v_rcp_f32 v114, v114
    v_mfma_f32_32x32x16_bf16 v[88:103], a[176:179], v[232:235], v[88:103]
    ds_read_b128 v[232:235], v53 offset:16384
    v_rcp_f32 v115, v115
    v_rcp_f32 v116, v116
    s_waitcnt lgkmcnt(5)
    v_mfma_f32_32x32x16_bf16 v[72:87], a[52:55], v[236:239], v[72:87]
    v_rcp_f32 v117, v117
    v_rcp_f32 v118, v118
    v_mfma_f32_32x32x16_bf16 v[88:103], a[180:183], v[236:239], v[88:103]
    ds_read_b128 v[236:239], v53 offset:17408
    v_rcp_f32 v119, v119
    v_mul_f32 v32, v32, v112
    v_mul_f32 v33, v33, v113
    v_mul_f32 v34, v34, v114
    s_waitcnt lgkmcnt(5)
    v_mfma_f32_32x32x16_bf16 v[72:87], a[56:59], v[240:243], v[72:87]
    v_mul_f32 v35, v35, v115
    v_mul_f32 v36, v36, v116
    v_mul_f32 v37, v37, v117
    v_mul_f32 v38, v38, v118
    v_mul_f32 v39, v39, v119
    v_mfma_f32_32x32x16_bf16 v[88:103], a[184:187], v[240:243], v[88:103]
    ds_read_b128 v[240:243], v53 offset:18432
    v_cvt_pk_bf16_f32 v32, v32, v33
    v_cvt_pk_bf16_f32 v33, v34, v35
    v_cvt_pk_bf16_f32 v34, v36, v37
    v_cvt_pk_bf16_f32 v35, v38, v39
    s_waitcnt lgkmcnt(5)
    v_mfma_f32_32x32x16_bf16 v[72:87], a[60:63], v[244:247], v[72:87]
    global_store_dwordx4 v13, v[32:35], s[18:19] offset:0
    v_fma_f32 v112, v40, v104, v105
    v_fma_f32 v113, v41, v104, v105
    v_fma_f32 v114, v42, v104, v105
    v_mfma_f32_32x32x16_bf16 v[88:103], a[188:191], v[244:247], v[88:103]
    ds_read_b128 v[244:247], v53 offset:19456
    v_fma_f32 v115, v43, v104, v105
    v_fma_f32 v116, v44, v104, v105
    v_fma_f32 v117, v45, v104, v105
    v_fma_f32 v118, v46, v104, v105
    v_fma_f32 v119, v47, v104, v105
    s_waitcnt lgkmcnt(5)
    v_mfma_f32_32x32x16_bf16 v[72:87], a[64:67], v[224:227], v[72:87]
    global_load_dwordx4 a[16:19], v110, s[18:19] offset:-4096 sc1
    v_exp_f32 v112, v112
    v_exp_f32 v113, v113
    v_mfma_f32_32x32x16_bf16 v[88:103], a[192:195], v[224:227], v[88:103]
    ds_read_b128 v[224:227], v53 offset:20480
    v_exp_f32 v114, v114
    v_exp_f32 v115, v115
    s_waitcnt lgkmcnt(5)
    v_mfma_f32_32x32x16_bf16 v[72:87], a[68:71], v[228:231], v[72:87]
    global_load_dwordx4 a[144:147], v110, s[18:19] offset:0 sc1
    v_exp_f32 v116, v116
    v_exp_f32 v117, v117
    v_mfma_f32_32x32x16_bf16 v[88:103], a[196:199], v[228:231], v[88:103]
    ds_read_b128 v[228:231], v5 offset:23744
    v_exp_f32 v118, v118
    v_exp_f32 v119, v119
    v_add_f32 v112, v112, v106
    s_waitcnt lgkmcnt(5)
    v_mfma_f32_32x32x16_bf16 v[72:87], a[72:75], v[232:235], v[72:87]
    global_load_dwordx4 a[20:23], v111, s[18:19] offset:-4096 sc1
    v_add_f32 v113, v113, v106
    v_add_f32 v114, v114, v106
    v_add_f32 v115, v115, v106
    v_add_f32 v116, v116, v106
    v_mfma_f32_32x32x16_bf16 v[88:103], a[200:203], v[232:235], v[88:103]
    ds_read_b128 v[232:235], v53 offset:21504
    v_add_f32 v117, v117, v106
    v_add_f32 v118, v118, v106
    v_add_f32 v119, v119, v106
    v_rcp_f32 v112, v112
    s_waitcnt lgkmcnt(5)
    v_mfma_f32_32x32x16_bf16 v[72:87], a[76:79], v[236:239], v[72:87]
    global_load_dwordx4 a[148:151], v111, s[18:19] offset:0 sc1
    v_rcp_f32 v113, v113
    v_rcp_f32 v114, v114
    v_mfma_f32_32x32x16_bf16 v[88:103], a[204:207], v[236:239], v[88:103]
    ds_read_b128 v[236:239], v53 offset:22528
    v_rcp_f32 v115, v115
    v_rcp_f32 v116, v116
    s_waitcnt lgkmcnt(5)
    v_mfma_f32_32x32x16_bf16 v[72:87], a[80:83], v[240:243], v[72:87]
    global_load_dwordx4 a[24:27], v111, s[18:19] offset:2048 sc1
    v_rcp_f32 v117, v117
    v_rcp_f32 v118, v118
    v_mfma_f32_32x32x16_bf16 v[88:103], a[208:211], v[240:243], v[88:103]
    ds_read_b128 v[240:243], v53 offset:23552
    v_rcp_f32 v119, v119
    v_mul_f32 v40, v40, v112
    v_mul_f32 v41, v41, v113
    v_mul_f32 v42, v42, v114
    s_waitcnt lgkmcnt(5)
    v_mfma_f32_32x32x16_bf16 v[72:87], a[84:87], v[244:247], v[72:87]
    global_load_dwordx4 a[152:155], v52, s[18:19] offset:-2048 sc1
    v_mul_f32 v43, v43, v115
    v_mul_f32 v44, v44, v116
    v_mul_f32 v45, v45, v117
    v_mul_f32 v46, v46, v118
    v_mfma_f32_32x32x16_bf16 v[88:103], a[212:215], v[244:247], v[88:103]
    ds_read_b128 v[244:247], v53 offset:24576
    v_mul_f32 v47, v47, v119
    ds_read2st64_b64 v[112:115], v54 offset0:1 offset1:67
    ds_read2st64_b64 v[116:119], v54 offset0:133 offset1:199
    s_waitcnt lgkmcnt(7)
    v_mfma_f32_32x32x16_bf16 v[72:87], a[88:91], v[224:227], v[72:87]
    global_load_dwordx4 a[28:31], v52, s[18:19] offset:2048 sc1
    v_cvt_pk_bf16_f32 v40, v40, v41
    v_cvt_pk_bf16_f32 v41, v42, v43
    v_cvt_pk_bf16_f32 v42, v44, v45
    v_cvt_pk_bf16_f32 v43, v46, v47
    v_mfma_f32_32x32x16_bf16 v[88:103], a[216:219], v[224:227], v[88:103]
    ds_read_b128 v[224:227], v53 offset:25600
    global_store_dwordx4 v13, v[40:43], s[18:19] offset:1024
    s_waitcnt lgkmcnt(1)
    v_add_f32 v112, v112, v116
    v_add_f32 v113, v113, v117
    v_mfma_f32_32x32x16_bf16 v[72:87], a[92:95], v[228:231], v[72:87]
    global_load_dwordx4 a[156:159], v51, s[18:19] offset:-2048 sc1
    v_add_f32 v114, v114, v118
    v_add_f32 v115, v115, v119
    v_add_f32 v112, v112, v114
    v_add_f32 v113, v113, v115
    v_mfma_f32_32x32x16_bf16 v[88:103], a[220:223], v[228:231], v[88:103]
    ds_read_b128 v[228:231], v53 offset:26624
    v_mul_f32 v112, 0xbb000000, v112
    v_mul_f32 v113, 0x3b000000, v113
    v_fma_f32 v113, -v112, v112, v113
    v_max_f32 v113, 0, v113
    v_add_f32 v113, 0x3727c5ac, v113
    v_mfma_f32_32x32x16_bf16 v[72:87], a[96:99], v[232:235], v[72:87]
    global_load_dwordx4 a[32:35], v110, s[18:19] offset:-3072 sc1
    v_rsq_f32 v114, v113
    v_log_f32 v108, v113
    v_mfma_f32_32x32x16_bf16 v[88:103], a[224:227], v[232:235], v[88:103]
    ds_read_b128 v[232:235], v53 offset:27648
    v_mul_f32 v109, v113, v114
    v_mul_f32 v107, 0xbfb8aa3b, v114
    v_mul_f32 v108, 0.5, v108
    v_cndmask_b32 v112, v112, v109, s[62:63]
    v_and_b32 v113, 0xffff0000, v112
    v_mfma_f32_32x32x16_bf16 v[72:87], a[100:103], v[236:239], v[72:87]
    global_load_dwordx4 a[160:163], v110, s[18:19] offset:1024 sc1
    v_lshrrev_b32 v69, 16, v112
    v_sub_f32 v112, v112, v113
    v_cvt_pk_bf16_f32 v68, v113, v112
    v_mfma_f32_32x32x16_bf16 v[88:103], a[228:231], v[236:239], v[88:103]
    ds_read_b128 v[236:239], v5 offset:57536
    v_mfma_f32_32x32x16_bf16 v[72:87], a[104:107], v[240:243], v[72:87]
    global_load_dwordx4 a[36:39], v111, s[18:19] offset:-3072 sc1
    v_mfma_f32_32x32x16_bf16 v[88:103], a[232:235], v[240:243], v[88:103]
    ds_read_b128 v[240:243], v4 offset:8192
    v_mfma_f32_32x32x16_bf16 v[72:87], a[108:111], v[244:247], v[72:87]
    global_load_dwordx4 a[164:167], v111, s[18:19] offset:1024 sc1
    v_mfma_f32_32x32x16_bf16 v[88:103], a[236:239], v[244:247], v[88:103]
    ds_read_b128 v[244:247], v4 offset:12288
    s_waitcnt lgkmcnt(5)
    v_mfma_f32_32x32x16_bf16 v[72:87], a[112:115], v[224:227], v[72:87]
    global_load_dwordx4 a[40:43], v111, s[18:19] offset:3072 sc1
    v_mfma_f32_32x32x16_bf16 v[88:103], a[240:243], v[224:227], v[88:103]
    ds_read_b128 v[224:227], v4 offset:16384
    s_waitcnt lgkmcnt(5)
    v_mfma_f32_32x32x16_bf16 v[72:87], a[116:119], v[228:231], v[72:87]
    global_load_dwordx4 a[168:171], v52, s[18:19] offset:-1024 sc1
    v_mfma_f32_32x32x16_bf16 v[88:103], a[244:247], v[228:231], v[88:103]
    ds_read_b128 v[228:231], v4 offset:20480
    s_waitcnt lgkmcnt(5)
    v_mfma_f32_32x32x16_bf16 v[72:87], a[120:123], v[232:235], v[72:87]
    global_load_dwordx4 a[44:47], v52, s[18:19] offset:3072 sc1
    v_mfma_f32_32x32x16_bf16 v[88:103], a[248:251], v[232:235], v[88:103]
    ds_read_b128 v[232:235], v4 offset:24768
    s_waitcnt lgkmcnt(5)
    v_mfma_f32_32x32x16_bf16 v[72:87], a[124:127], v[236:239], v[72:87]
    global_load_dwordx4 a[172:175], v51, s[18:19] offset:-1024 sc1
    v_mfma_f32_32x32x16_bf16 v[88:103], a[252:255], v[236:239], v[88:103]
    ds_read_b128 v[236:239], v4 offset:28864
    v_mfma_f32_32x32x16_bf16 v[72:87], v[56:59], v[68:71], v[72:87]
    global_load_dwordx4 a[48:51], v110, s[18:19] offset:-2048 sc1
    v_mfma_f32_32x32x16_bf16 v[88:103], v[60:63], v[68:71], v[88:103]
    v_lshrrev_b32 v104, 5, v1
    v_lshl_add_u32 v104, v104, 5, s48
    s_nop 7
    v_fma_f32 v112, v72, v107, v108
    v_fma_f32 v113, v73, v107, v108
    v_fma_f32 v114, v74, v107, v108
    v_fma_f32 v115, v75, v107, v108
    v_fma_f32 v116, v76, v107, v108
    v_fma_f32 v117, v77, v107, v108
    v_fma_f32 v118, v78, v107, v108
    v_fma_f32 v119, v79, v107, v108
    v_exp_f32 v112, v112
    v_exp_f32 v113, v113
    global_load_dwordx4 a[176:179], v110, s[18:19] offset:2048 sc1
    v_exp_f32 v114, v114
    v_exp_f32 v115, v115
    v_exp_f32 v116, v116
    v_exp_f32 v117, v117
    v_exp_f32 v118, v118
    v_exp_f32 v119, v119
    v_add_f32 v112, v112, v109
    v_add_f32 v113, v113, v109
    global_load_dwordx4 a[52:55], v111, s[18:19] offset:-2048 sc1
    v_add_f32 v114, v114, v109
    v_add_f32 v115, v115, v109
    v_add_f32 v116, v116, v109
    v_add_f32 v117, v117, v109
    v_add_f32 v118, v118, v109
    v_add_f32 v119, v119, v109
    v_rcp_f32 v112, v112
    v_rcp_f32 v113, v113
    v_rcp_f32 v114, v114
    v_rcp_f32 v115, v115
    global_load_dwordx4 a[180:183], v52, s[18:19] offset:-4096 sc1
    v_rcp_f32 v116, v116
    v_rcp_f32 v117, v117
    v_rcp_f32 v118, v118
    v_rcp_f32 v119, v119
    v_mul_f32 v72, v72, v112
    v_mul_f32 v73, v73, v113
    v_mul_f32 v74, v74, v114
    v_mul_f32 v75, v75, v115
    v_mul_f32 v76, v76, v116
    v_mul_f32 v77, v77, v117
    global_load_dwordx4 a[56:59], v52, s[18:19] offset:0 sc1
    v_mul_f32 v78, v78, v118
    v_mul_f32 v79, v79, v119
    v_cvt_pk_bf16_f32 v72, v72, v73
    v_cvt_pk_bf16_f32 v73, v74, v75
    v_cvt_pk_bf16_f32 v74, v76, v77
    v_cvt_pk_bf16_f32 v75, v78, v79
    global_store_dwordx4 v8, v[72:75], s[20:21] offset:0
    ds_read_b128 v[56:59], v104 offset:33728
    ds_read_b128 v[60:63], v104 offset:33744
    s_waitcnt vmcnt(19)
    v_accvgpr_read_b32 v64, a16
    v_accvgpr_read_b32 v65, a144
    v_accvgpr_read_b32 v66, a20
    v_accvgpr_read_b32 v67, a148
    v_max_u32 v64, v64, v65
    v_max3_u32 v64, v64, v66, v67
    v_cmp_eq_u32 vcc, -1, v64
    s_cbranch_vccnz adaLN_cond__grouped_kv_mqa__dense_activation_silu__prompt_kernel_st140
adaLN_cond__grouped_kv_mqa__dense_activation_silu__prompt_kernel_bk141:
    v_mfma_f32_32x32x16_bf16 v[32:47], v[192:195], a[16:19], 0
    global_load_dwordx4 a[184:187], v51, s[18:19] offset:-4096 sc1
    v_fma_f32 v112, v80, v107, v108
    v_fma_f32 v113, v81, v107, v108
    v_fma_f32 v114, v82, v107, v108
    v_fma_f32 v115, v83, v107, v108
    v_fma_f32 v116, v84, v107, v108
    s_waitcnt lgkmcnt(7)
    v_mfma_f32_32x32x16_bf16 v[16:31], v[240:243], a[16:19], 0
    ds_read_b128 v[240:243], v4 offset:9216
    v_fma_f32 v117, v85, v107, v108
    v_fma_f32 v118, v86, v107, v108
    v_fma_f32 v119, v87, v107, v108
    v_mfma_f32_32x32x16_bf16 v[32:47], v[208:211], a[144:147], v[32:47]
    global_load_dwordx4 a[60:63], v110, s[18:19] offset:-1024 sc1
    v_exp_f32 v112, v112
    v_exp_f32 v113, v113
    s_waitcnt lgkmcnt(7)
    v_mfma_f32_32x32x16_bf16 v[16:31], v[244:247], a[144:147], v[16:31]
    ds_read_b128 v[244:247], v4 offset:13312
    v_exp_f32 v114, v114
    v_exp_f32 v115, v115
    v_mfma_f32_32x32x16_bf16 v[32:47], v[160:163], a[20:23], v[32:47]
    global_load_dwordx4 a[188:191], v110, s[18:19] offset:3072 sc1
    v_exp_f32 v116, v116
    v_exp_f32 v117, v117
    s_waitcnt lgkmcnt(7)
    v_mfma_f32_32x32x16_bf16 v[16:31], v[224:227], a[20:23], v[16:31]
    ds_read_b128 v[224:227], v4 offset:17408
    s_waitcnt vmcnt(17)
    v_accvgpr_read_b32 v64, a24
    v_accvgpr_read_b32 v65, a152
    v_accvgpr_read_b32 v66, a28
    v_mfma_f32_32x32x16_bf16 v[32:47], v[176:179], a[148:151], v[32:47]
    global_load_dwordx4 a[64:67], v111, s[18:19] offset:-1024 sc1
    v_accvgpr_read_b32 v67, a156
    v_max_u32 v64, v64, v65
    v_max3_u32 v64, v64, v66, v67
    v_exp_f32 v118, v118
    s_waitcnt lgkmcnt(7)
    v_mfma_f32_32x32x16_bf16 v[16:31], v[228:231], a[148:151], v[16:31]
    ds_read_b128 v[228:231], v4 offset:21504
    v_cmp_eq_u32 vcc, -1, v64
    s_cbranch_vccnz adaLN_cond__grouped_kv_mqa__dense_activation_silu__prompt_kernel_st143
adaLN_cond__grouped_kv_mqa__dense_activation_silu__prompt_kernel_bk144:
    v_exp_f32 v119, v119
    v_mfma_f32_32x32x16_bf16 v[32:47], v[184:187], a[24:27], v[32:47]
    global_load_dwordx4 a[192:195], v52, s[18:19] offset:-3072 sc1
    v_add_f32 v112, v112, v109
    v_add_f32 v113, v113, v109
    v_add_f32 v114, v114, v109
    v_add_f32 v115, v115, v109
    v_add_f32 v116, v116, v109
    s_waitcnt lgkmcnt(7)
    v_mfma_f32_32x32x16_bf16 v[16:31], v[232:235], a[24:27], v[16:31]
    ds_read_b128 v[232:235], v4 offset:25792
    v_add_f32 v117, v117, v109
    v_add_f32 v118, v118, v109
    v_add_f32 v119, v119, v109
    v_mfma_f32_32x32x16_bf16 v[32:47], v[144:147], a[152:155], v[32:47]
    global_load_dwordx4 a[68:71], v52, s[18:19] offset:1024 sc1
    v_rcp_f32 v112, v112
    v_rcp_f32 v113, v113
    s_waitcnt lgkmcnt(7)
    v_mfma_f32_32x32x16_bf16 v[16:31], v[236:239], a[152:155], v[16:31]
    ds_read_b128 v[236:239], v4 offset:29888
    v_rcp_f32 v114, v114
    v_rcp_f32 v115, v115
    v_mfma_f32_32x32x16_bf16 v[32:47], v[128:131], a[28:31], v[32:47]
    global_load_dwordx4 a[196:199], v51, s[18:19] offset:-3072 sc1
    v_rcp_f32 v116, v116
    v_rcp_f32 v117, v117
    v_mfma_f32_32x32x16_bf16 v[16:31], a[4:7], a[28:31], v[16:31]
    s_waitcnt vmcnt(13)
    v_accvgpr_read_b32 v64, a32
    v_accvgpr_read_b32 v65, a160
    v_accvgpr_read_b32 v66, a36
    v_accvgpr_read_b32 v67, a164
    v_accvgpr_read_b32 v68, a40
    v_mfma_f32_32x32x16_bf16 v[32:47], a[0:3], a[156:159], v[32:47]
    v_accvgpr_read_b32 v69, a168
    v_accvgpr_read_b32 v70, a44
    v_accvgpr_read_b32 v71, a172
    v_max_u32 v64, v64, v65
    v_max3_u32 v64, v64, v66, v67
    v_rcp_f32 v118, v118
    v_mfma_f32_32x32x16_bf16 v[16:31], a[12:15], a[156:159], v[16:31]
    v_max3_u32 v64, v64, v68, v69
    v_max3_u32 v64, v64, v70, v71
    v_cmp_eq_u32 vcc, -1, v64
    s_cbranch_vccnz adaLN_cond__grouped_kv_mqa__dense_activation_silu__prompt_kernel_st146
adaLN_cond__grouped_kv_mqa__dense_activation_silu__prompt_kernel_bk147:
    v_rcp_f32 v119, v119
    v_mul_f32 v80, v80, v112
    v_mfma_f32_32x32x16_bf16 v[32:47], v[196:199], a[32:35], v[32:47]
    v_mul_f32 v81, v81, v113
    v_mul_f32 v82, v82, v114
    v_mul_f32 v83, v83, v115
    v_mul_f32 v84, v84, v116
    v_mul_f32 v85, v85, v117
    v_mul_f32 v86, v86, v118
    s_waitcnt lgkmcnt(5)
    v_mfma_f32_32x32x16_bf16 v[16:31], v[240:243], a[32:35], v[16:31]
    ds_read_b128 v[240:243], v4 offset:10240
    v_mul_f32 v87, v87, v119
    v_cvt_pk_bf16_f32 v80, v80, v81
    v_cvt_pk_bf16_f32 v81, v82, v83
    v_cvt_pk_bf16_f32 v82, v84, v85
    v_mfma_f32_32x32x16_bf16 v[32:47], v[212:215], a[160:163], v[32:47]
    v_cvt_pk_bf16_f32 v83, v86, v87
    global_store_dwordx4 v8, v[80:83], s[20:21] offset:1024
    v_fma_f32 v112, v88, v107, v108
    v_fma_f32 v113, v89, v107, v108
    v_fma_f32 v114, v90, v107, v108
    s_waitcnt lgkmcnt(5)
    v_mfma_f32_32x32x16_bf16 v[16:31], v[244:247], a[160:163], v[16:31]
    ds_read_b128 v[244:247], v4 offset:14336
    v_fma_f32 v115, v91, v107, v108
    v_fma_f32 v116, v92, v107, v108
    v_fma_f32 v117, v93, v107, v108
    v_fma_f32 v118, v94, v107, v108
    v_mfma_f32_32x32x16_bf16 v[32:47], v[164:167], a[36:39], v[32:47]
    global_load_dwordx4 a[72:75], v110, s[20:21] offset:-4096 sc1
    v_fma_f32 v119, v95, v107, v108
    v_exp_f32 v112, v112
    v_exp_f32 v113, v113
    s_waitcnt lgkmcnt(5)
    v_mfma_f32_32x32x16_bf16 v[16:31], v[224:227], a[36:39], v[16:31]
    ds_read_b128 v[224:227], v4 offset:18432
    v_exp_f32 v114, v114
    v_exp_f32 v115, v115
    v_mfma_f32_32x32x16_bf16 v[32:47], v[180:183], a[164:167], v[32:47]
    global_load_dwordx4 a[200:203], v110, s[20:21] offset:0 sc1
    v_exp_f32 v116, v116
    v_exp_f32 v117, v117
    s_waitcnt lgkmcnt(5)
    v_mfma_f32_32x32x16_bf16 v[16:31], v[228:231], a[164:167], v[16:31]
    ds_read_b128 v[228:231], v4 offset:26816
    v_exp_f32 v118, v118
    v_exp_f32 v119, v119
    v_mfma_f32_32x32x16_bf16 v[32:47], v[188:191], a[40:43], v[32:47]
    global_load_dwordx4 a[76:79], v111, s[20:21] offset:-4096 sc1
    v_add_f32 v112, v112, v109
    v_add_f32 v113, v113, v109
    v_add_f32 v114, v114, v109
    v_add_f32 v115, v115, v109
    v_add_f32 v116, v116, v109
    s_waitcnt lgkmcnt(5)
    v_mfma_f32_32x32x16_bf16 v[16:31], v[232:235], a[40:43], v[16:31]
    ds_read_b128 v[232:235], v4 offset:30912
    v_add_f32 v117, v117, v109
    v_add_f32 v118, v118, v109
    v_add_f32 v119, v119, v109
    v_mfma_f32_32x32x16_bf16 v[32:47], v[148:151], a[168:171], v[32:47]
    global_load_dwordx4 a[204:207], v111, s[20:21] offset:0 sc1
    v_rcp_f32 v112, v112
    v_rcp_f32 v113, v113
    s_waitcnt lgkmcnt(5)
    v_mfma_f32_32x32x16_bf16 v[16:31], v[236:239], a[168:171], v[16:31]
    ds_read_b128 v[236:239], v4 offset:11264
    v_rcp_f32 v114, v114
    v_rcp_f32 v115, v115
    v_mfma_f32_32x32x16_bf16 v[32:47], v[132:135], a[44:47], v[32:47]
    global_load_dwordx4 a[80:83], v111, s[20:21] offset:2048 sc1
    v_rcp_f32 v116, v116
    v_rcp_f32 v117, v117
    v_mfma_f32_32x32x16_bf16 v[16:31], a[132:135], a[44:47], v[16:31]
    s_waitcnt vmcnt(12)
    v_accvgpr_read_b32 v64, a48
    v_accvgpr_read_b32 v65, a176
    v_accvgpr_read_b32 v66, a52
    v_accvgpr_read_b32 v67, a180
    v_rcp_f32 v118, v118
    v_mfma_f32_32x32x16_bf16 v[32:47], a[128:131], a[172:175], v[32:47]
    global_load_dwordx4 a[208:211], v52, s[20:21] offset:-2048 sc1
    v_accvgpr_read_b32 v68, a56
    v_accvgpr_read_b32 v69, a184
    v_max_u32 v64, v64, v65
    v_max3_u32 v64, v64, v66, v67
    v_mfma_f32_32x32x16_bf16 v[16:31], a[140:143], a[172:175], v[16:31]
    v_max3_u32 v64, v64, v68, v69
    v_cmp_eq_u32 vcc, -1, v64
    s_cbranch_vccnz adaLN_cond__grouped_kv_mqa__dense_activation_silu__prompt_kernel_st149
adaLN_cond__grouped_kv_mqa__dense_activation_silu__prompt_kernel_bk150:
    v_rcp_f32 v119, v119
    v_mul_f32 v88, v88, v112
    v_mul_f32 v89, v89, v113
    v_mfma_f32_32x32x16_bf16 v[32:47], v[200:203], a[48:51], v[32:47]
    global_load_dwordx4 a[84:87], v52, s[20:21] offset:2048 sc1
    v_mul_f32 v90, v90, v114
    v_mul_f32 v91, v91, v115
    v_mul_f32 v92, v92, v116
    v_mul_f32 v93, v93, v117
    v_mul_f32 v94, v94, v118
    s_waitcnt lgkmcnt(5)
    v_mfma_f32_32x32x16_bf16 v[16:31], v[240:243], a[48:51], v[16:31]
    ds_read_b128 v[240:243], v4 offset:15360
    v_mul_f32 v95, v95, v119
    v_cvt_pk_bf16_f32 v88, v88, v89
    v_cvt_pk_bf16_f32 v89, v90, v91
    v_cvt_pk_bf16_f32 v90, v92, v93
    v_mfma_f32_32x32x16_bf16 v[32:47], v[216:219], a[176:179], v[32:47]
    global_load_dwordx4 a[212:215], v51, s[20:21] offset:-2048 sc1
    v_cvt_pk_bf16_f32 v91, v94, v95
    global_store_dwordx4 v13, v[88:91], s[20:21] offset:0
    v_fma_f32 v112, v96, v107, v108
    v_fma_f32 v113, v97, v107, v108
    s_waitcnt lgkmcnt(5)
    v_mfma_f32_32x32x16_bf16 v[16:31], v[244:247], a[176:179], v[16:31]
    ds_read_b128 v[244:247], v4 offset:19456
    v_fma_f32 v114, v98, v107, v108
    v_fma_f32 v115, v99, v107, v108
    v_fma_f32 v116, v100, v107, v108
    v_fma_f32 v117, v101, v107, v108
    v_mfma_f32_32x32x16_bf16 v[32:47], v[168:171], a[52:55], v[32:47]
    global_load_dwordx4 a[88:91], v110, s[20:21] offset:-3072 sc1
    v_fma_f32 v118, v102, v107, v108
    v_fma_f32 v119, v103, v107, v108
    v_exp_f32 v112, v112
    s_waitcnt lgkmcnt(5)
    v_mfma_f32_32x32x16_bf16 v[16:31], v[224:227], a[52:55], v[16:31]
    ds_read_b128 v[224:227], v4 offset:27840
    v_exp_f32 v113, v113
    v_exp_f32 v114, v114
    v_mfma_f32_32x32x16_bf16 v[32:47], v[136:139], a[180:183], v[32:47]
    global_load_dwordx4 a[216:219], v110, s[20:21] offset:1024 sc1
    v_exp_f32 v115, v115
    v_exp_f32 v116, v116
    s_waitcnt lgkmcnt(5)
    v_mfma_f32_32x32x16_bf16 v[16:31], v[228:231], a[180:183], v[16:31]
    ds_read_b128 v[228:231], v4 offset:31936
    v_exp_f32 v117, v117
    v_exp_f32 v118, v118
    v_mfma_f32_32x32x16_bf16 v[32:47], v[152:155], a[56:59], v[32:47]
    global_load_dwordx4 a[92:95], v111, s[20:21] offset:-3072 sc1
    v_exp_f32 v119, v119
    v_add_f32 v112, v112, v109
    v_add_f32 v113, v113, v109
    v_add_f32 v114, v114, v109
    s_waitcnt lgkmcnt(5)
    v_mfma_f32_32x32x16_bf16 v[16:31], v[232:235], a[56:59], v[16:31]
    ds_read_b128 v[232:235], v4 offset:8192
    s_waitcnt vmcnt(13)
    v_accvgpr_read_b32 v64, a60
    v_accvgpr_read_b32 v65, a188
    v_accvgpr_read_b32 v66, a64
    v_accvgpr_read_b32 v67, a192
    v_mfma_f32_32x32x16_bf16 v[32:47], v[120:123], a[184:187], v[32:47]
    global_load_dwordx4 a[220:223], v111, s[20:21] offset:1024 sc1
    v_accvgpr_read_b32 v68, a68
    v_accvgpr_read_b32 v69, a196
    v_max_u32 v64, v64, v65
    v_max3_u32 v64, v64, v66, v67
    v_mfma_f32_32x32x16_bf16 v[16:31], a[8:11], a[184:187], v[16:31]
    v_max3_u32 v64, v64, v68, v69
    v_cmp_eq_u32 vcc, -1, v64
    s_cbranch_vccnz adaLN_cond__grouped_kv_mqa__dense_activation_silu__prompt_kernel_st152
adaLN_cond__grouped_kv_mqa__dense_activation_silu__prompt_kernel_bk153:
    v_add_f32 v115, v115, v109
    v_add_f32 v116, v116, v109
    v_add_f32 v117, v117, v109
    v_add_f32 v118, v118, v109
    v_mfma_f32_32x32x16_bf16 v[32:47], v[204:207], a[60:63], v[32:47]
    global_load_dwordx4 a[96:99], v111, s[20:21] offset:3072 sc1
    v_add_f32 v119, v119, v109
    v_rcp_f32 v112, v112
    v_rcp_f32 v113, v113
    s_waitcnt lgkmcnt(5)
    v_mfma_f32_32x32x16_bf16 v[16:31], v[236:239], a[60:63], v[16:31]
    ds_read_b128 v[236:239], v4 offset:12288
    v_rcp_f32 v114, v114
    v_rcp_f32 v115, v115
    v_mfma_f32_32x32x16_bf16 v[32:47], v[220:223], a[188:191], v[32:47]
    global_load_dwordx4 a[224:227], v52, s[20:21] offset:-1024 sc1
    v_rcp_f32 v116, v116
    v_rcp_f32 v117, v117
    s_waitcnt lgkmcnt(5)
    v_mfma_f32_32x32x16_bf16 v[16:31], v[240:243], a[188:191], v[16:31]
    ds_read_b128 v[240:243], v4 offset:16384
    v_rcp_f32 v118, v118
    v_rcp_f32 v119, v119
    v_mfma_f32_32x32x16_bf16 v[32:47], v[172:175], a[64:67], v[32:47]
    global_load_dwordx4 a[100:103], v52, s[20:21] offset:3072 sc1
    v_mul_f32 v96, v96, v112
    v_mul_f32 v97, v97, v113
    v_mul_f32 v98, v98, v114
    v_mul_f32 v99, v99, v115
    v_mul_f32 v100, v100, v116
    s_waitcnt lgkmcnt(5)
    v_mfma_f32_32x32x16_bf16 v[16:31], v[244:247], a[64:67], v[16:31]
    ds_read_b128 v[244:247], v4 offset:20480
    v_mul_f32 v101, v101, v117
    v_mul_f32 v102, v102, v118
    v_mul_f32 v103, v103, v119
    v_cvt_pk_bf16_f32 v96, v96, v97
    v_mfma_f32_32x32x16_bf16 v[32:47], v[140:143], a[192:195], v[32:47]
    global_load_dwordx4 a[228:231], v51, s[20:21] offset:-1024 sc1
    v_cvt_pk_bf16_f32 v97, v98, v99
    v_cvt_pk_bf16_f32 v98, v100, v101
    v_cvt_pk_bf16_f32 v99, v102, v103
    global_store_dwordx4 v13, v[96:99], s[20:21] offset:1024
    s_waitcnt lgkmcnt(5)
    v_mfma_f32_32x32x16_bf16 v[16:31], v[224:227], a[192:195], v[16:31]
    ds_read_b128 v[224:227], v4 offset:24768
    v_mfma_f32_32x32x16_bf16 v[32:47], v[156:159], a[68:71], v[32:47]
    global_load_dwordx4 a[104:107], v110, s[20:21] offset:-2048 sc1
    s_waitcnt lgkmcnt(5)
    v_mfma_f32_32x32x16_bf16 v[16:31], v[228:231], a[68:71], v[16:31]
    ds_read_b128 v[228:231], v4 offset:28864
    v_mfma_f32_32x32x16_bf16 v[32:47], v[124:127], a[196:199], v[32:47]
    global_load_dwordx4 a[232:235], v110, s[20:21] offset:2048 sc1
    v_mfma_f32_32x32x16_bf16 v[16:31], a[136:139], a[196:199], v[16:31]
    s_waitcnt vmcnt(16)
    v_accvgpr_read_b32 v64, a72
    v_accvgpr_read_b32 v65, a200
    v_accvgpr_read_b32 v66, a76
    v_accvgpr_read_b32 v67, a204
    v_max_u32 v64, v64, v65
    v_max3_u32 v64, v64, v66, v67
    v_cmp_eq_u32 vcc, -1, v64
    s_cbranch_vccnz adaLN_cond__grouped_kv_mqa__dense_activation_silu__prompt_kernel_st155
adaLN_cond__grouped_kv_mqa__dense_activation_silu__prompt_kernel_bk156:
    v_mfma_f32_32x32x16_bf16 v[88:103], v[192:195], a[72:75], 0
    global_load_dwordx4 a[108:111], v111, s[20:21] offset:-2048 sc1
    s_nop 0
    ds_write_b128 v48, v[24:27] offset:0
    ds_write_b128 v48, v[28:31] offset:1024
    s_waitcnt lgkmcnt(7)
    v_mfma_f32_32x32x16_bf16 v[72:87], v[232:235], a[72:75], 0
    ds_read_b128 v[232:235], v4 offset:9216
    ds_write_b128 v49, v[32:35] offset:2048
    ds_write_b128 v49, v[36:39] offset:3072
    v_mfma_f32_32x32x16_bf16 v[88:103], v[208:211], a[200:203], v[88:103]
    global_load_dwordx4 a[236:239], v52, s[20:21] offset:-4096 sc1
    ds_write_b128 v50, v[40:43] offset:4096
    ds_write_b128 v50, v[44:47] offset:5120
    s_waitcnt lgkmcnt(0)
    v_mfma_f32_32x32x16_bf16 v[72:87], v[236:239], a[200:203], v[72:87]
    ds_read_b128 v[236:239], v4 offset:13312
    s_barrier
    ds_read_b128 v[24:27], v4 offset:0
    v_mfma_f32_32x32x16_bf16 v[88:103], v[160:163], a[76:79], v[88:103]
    global_load_dwordx4 a[112:115], v52, s[20:21] offset:0 sc1
    ds_read_b128 v[28:31], v4 offset:1024
    ds_read_b128 v[32:35], v4 offset:2048
    v_mfma_f32_32x32x16_bf16 v[72:87], v[240:243], a[76:79], v[72:87]
    ds_read_b128 v[240:243], v4 offset:17408
    s_waitcnt vmcnt(15)
    v_accvgpr_read_b32 v112, a80
    v_accvgpr_read_b32 v113, a208
    v_accvgpr_read_b32 v114, a84
    v_mfma_f32_32x32x16_bf16 v[88:103], v[176:179], a[204:207], v[88:103]
    global_load_dwordx4 a[240:243], v51, s[20:21] offset:-4096 sc1
    v_accvgpr_read_b32 v115, a212
    v_max_u32 v112, v112, v113
    v_max3_u32 v112, v112, v114, v115
    ds_read_b128 v[36:39], v4 offset:3072
    v_mfma_f32_32x32x16_bf16 v[72:87], v[244:247], a[204:207], v[72:87]
    ds_read_b128 v[244:247], v4 offset:21504
    v_cmp_eq_u32 vcc, -1, v112
    s_cbranch_vccnz adaLN_cond__grouped_kv_mqa__dense_activation_silu__prompt_kernel_st158
adaLN_cond__grouped_kv_mqa__dense_activation_silu__prompt_kernel_bk159:
    ds_read_b128 v[40:43], v4 offset:4096
    v_mfma_f32_32x32x16_bf16 v[88:103], v[184:187], a[80:83], v[88:103]
    global_load_dwordx4 a[116:119], v110, s[20:21] offset:-1024 sc1
    ds_read_b128 v[44:47], v4 offset:5120
    v_lshlrev_b32 v64, 16, v248
    v_and_b32 v65, 0xffff0000, v248
    v_lshlrev_b32 v66, 16, v249
    v_mfma_f32_32x32x16_bf16 v[72:87], v[224:227], a[80:83], v[72:87]
    ds_read_b128 v[224:227], v4 offset:25792
    v_and_b32 v67, 0xffff0000, v249
    v_lshlrev_b32 v68, 16, v250
    v_and_b32 v69, 0xffff0000, v250
    v_lshlrev_b32 v70, 16, v251
    v_mfma_f32_32x32x16_bf16 v[88:103], v[144:147], a[208:211], v[88:103]
    global_load_dwordx4 a[244:247], v110, s[20:21] offset:3072 sc1
    v_and_b32 v71, 0xffff0000, v251
    s_waitcnt lgkmcnt(7)
    v_add_f32 v16, v16, v24
    v_add_f32 v17, v17, v25
    v_add_f32 v18, v18, v26
    v_mfma_f32_32x32x16_bf16 v[72:87], v[228:231], a[208:211], v[72:87]
    ds_read_b128 v[228:231], v4 offset:29888
    v_add_f32 v19, v19, v27
    v_add_f32 v20, v20, v28
    v_add_f32 v21, v21, v29
    v_add_f32 v22, v22, v30
    v_mfma_f32_32x32x16_bf16 v[88:103], v[128:131], a[84:87], v[88:103]
    global_load_dwordx4 a[120:123], v111, s[20:21] offset:-1024 sc1
    v_add_f32 v23, v23, v31
    s_waitcnt lgkmcnt(5)
    v_add_f32 v16, v16, v32
    v_add_f32 v17, v17, v33
    v_add_f32 v18, v18, v34
    v_mfma_f32_32x32x16_bf16 v[72:87], a[4:7], a[84:87], v[72:87]
    s_waitcnt vmcnt(10)
    v_accvgpr_read_b32 v112, a88
    v_accvgpr_read_b32 v113, a216
    v_accvgpr_read_b32 v114, a92
    v_accvgpr_read_b32 v115, a220
    v_accvgpr_read_b32 v116, a96
    v_add_f32 v19, v19, v35
    v_mfma_f32_32x32x16_bf16 v[88:103], a[0:3], a[212:215], v[88:103]
    global_load_dwordx4 a[248:251], v52, s[20:21] offset:-3072 sc1
    v_accvgpr_read_b32 v117, a224
    v_accvgpr_read_b32 v118, a100
    v_accvgpr_read_b32 v119, a228
    v_max_u32 v112, v112, v113
    v_max3_u32 v112, v112, v114, v115
    v_mfma_f32_32x32x16_bf16 v[72:87], a[12:15], a[212:215], v[72:87]
    v_max3_u32 v112, v112, v116, v117
    v_max3_u32 v112, v112, v118, v119
    v_cmp_eq_u32 vcc, -1, v112
    s_cbranch_vccnz adaLN_cond__grouped_kv_mqa__dense_activation_silu__prompt_kernel_st161
adaLN_cond__grouped_kv_mqa__dense_activation_silu__prompt_kernel_bk162:
    v_add_f32 v20, v20, v36
    v_add_f32 v21, v21, v37
    v_add_f32 v22, v22, v38
    v_mfma_f32_32x32x16_bf16 v[88:103], v[196:199], a[88:91], v[88:103]
    global_load_dwordx4 a[124:127], v52, s[20:21] offset:1024 sc1
    v_add_f32 v23, v23, v39
    s_waitcnt lgkmcnt(2)
    v_add_f32 v16, v16, v40
    v_add_f32 v17, v17, v41
    v_add_f32 v18, v18, v42
    v_mfma_f32_32x32x16_bf16 v[72:87], v[232:235], a[88:91], v[72:87]
    ds_read_b128 v[232:235], v4 offset:10240
    v_add_f32 v19, v19, v43
    v_add_f32 v20, v20, v44
    v_add_f32 v21, v21, v45
    v_add_f32 v22, v22, v46
    v_mfma_f32_32x32x16_bf16 v[88:103], v[212:215], a[216:219], v[88:103]
    global_load_dwordx4 a[252:255], v51, s[20:21] offset:-3072 sc1
    v_add_f32 v23, v23, v47
    v_fma_f32 v16, v16, v56, v64
    v_fma_f32 v17, v17, v57, v65
    v_fma_f32 v18, v18, v58, v66
    v_fma_f32 v19, v19, v59, v67
    v_mfma_f32_32x32x16_bf16 v[72:87], v[236:239], a[216:219], v[72:87]
    ds_read_b128 v[236:239], v4 offset:14336
    v_fma_f32 v20, v20, v60, v68
    v_fma_f32 v21, v21, v61, v69
    v_fma_f32 v22, v22, v62, v70
    v_fma_f32 v23, v23, v63, v71
    v_mfma_f32_32x32x16_bf16 v[88:103], v[164:167], a[92:95], v[88:103]
    v_cvt_pk_bf16_f32 v24, v16, v17
    v_cvt_pk_bf16_f32 v25, v18, v19
    v_cvt_pk_bf16_f32 v26, v20, v21
    v_cvt_pk_bf16_f32 v27, v22, v23
    global_store_dwordx4 v14, v[24:27], s[24:25]
    v_mfma_f32_32x32x16_bf16 v[72:87], v[240:243], a[92:95], v[72:87]
    ds_read_b128 v[240:243], v4 offset:18432
    v_mfma_f32_32x32x16_bf16 v[88:103], v[180:183], a[220:223], v[88:103]
    v_mfma_f32_32x32x16_bf16 v[72:87], v[244:247], a[220:223], v[72:87]
    ds_read_b128 v[244:247], v4 offset:26816
    v_mfma_f32_32x32x16_bf16 v[88:103], v[188:191], a[96:99], v[88:103]
    s_waitcnt lgkmcnt(5)
    v_mfma_f32_32x32x16_bf16 v[72:87], v[224:227], a[96:99], v[72:87]
    ds_read_b128 v[224:227], v4 offset:30912
    v_mfma_f32_32x32x16_bf16 v[88:103], v[148:151], a[224:227], v[88:103]
    s_waitcnt lgkmcnt(5)
    v_mfma_f32_32x32x16_bf16 v[72:87], v[228:231], a[224:227], v[72:87]
    ds_read_b128 v[228:231], v4 offset:11264
    v_mfma_f32_32x32x16_bf16 v[88:103], v[132:135], a[100:103], v[88:103]
    v_mfma_f32_32x32x16_bf16 v[72:87], a[132:135], a[100:103], v[72:87]
    s_waitcnt vmcnt(7)
    v_accvgpr_read_b32 v112, a104
    v_accvgpr_read_b32 v113, a232
    v_accvgpr_read_b32 v114, a108
    v_accvgpr_read_b32 v115, a236
    v_mfma_f32_32x32x16_bf16 v[88:103], a[128:131], a[228:231], v[88:103]
    v_accvgpr_read_b32 v116, a112
    v_accvgpr_read_b32 v117, a240
    v_max_u32 v112, v112, v113
    v_max3_u32 v112, v112, v114, v115
    v_mfma_f32_32x32x16_bf16 v[72:87], a[140:143], a[228:231], v[72:87]
    v_max3_u32 v112, v112, v116, v117
    v_cmp_eq_u32 vcc, -1, v112
    s_cbranch_vccnz adaLN_cond__grouped_kv_mqa__dense_activation_silu__prompt_kernel_st164
adaLN_cond__grouped_kv_mqa__dense_activation_silu__prompt_kernel_bk165:
    v_mfma_f32_32x32x16_bf16 v[88:103], v[200:203], a[104:107], v[88:103]
    s_waitcnt lgkmcnt(5)
    v_mfma_f32_32x32x16_bf16 v[72:87], v[232:235], a[104:107], v[72:87]
    ds_read_b128 v[232:235], v4 offset:15360
    v_mfma_f32_32x32x16_bf16 v[88:103], v[216:219], a[232:235], v[88:103]
    s_waitcnt lgkmcnt(5)
    v_mfma_f32_32x32x16_bf16 v[72:87], v[236:239], a[232:235], v[72:87]
    ds_read_b128 v[236:239], v4 offset:19456
    v_mfma_f32_32x32x16_bf16 v[88:103], v[168:171], a[108:111], v[88:103]
    s_waitcnt lgkmcnt(5)
    v_mfma_f32_32x32x16_bf16 v[72:87], v[240:243], a[108:111], v[72:87]
    ds_read_b128 v[240:243], v4 offset:27840
    v_mfma_f32_32x32x16_bf16 v[88:103], v[136:139], a[236:239], v[88:103]
    s_waitcnt lgkmcnt(5)
    v_mfma_f32_32x32x16_bf16 v[72:87], v[244:247], a[236:239], v[72:87]
    ds_read_b128 v[244:247], v4 offset:31936
    v_mfma_f32_32x32x16_bf16 v[88:103], v[152:155], a[112:115], v[88:103]
    s_waitcnt lgkmcnt(5)
    v_mfma_f32_32x32x16_bf16 v[72:87], v[224:227], a[112:115], v[72:87]
    s_waitcnt vmcnt(1)
    v_accvgpr_read_b32 v112, a116
    v_accvgpr_read_b32 v113, a244
    v_accvgpr_read_b32 v114, a120
    v_accvgpr_read_b32 v115, a248
    v_mfma_f32_32x32x16_bf16 v[88:103], v[120:123], a[240:243], v[88:103]
    v_accvgpr_read_b32 v116, a124
    v_accvgpr_read_b32 v117, a252
    v_max_u32 v112, v112, v113
    v_max3_u32 v112, v112, v114, v115
    v_mfma_f32_32x32x16_bf16 v[72:87], a[8:11], a[240:243], v[72:87]
    v_max3_u32 v112, v112, v116, v117
    v_cmp_eq_u32 vcc, -1, v112
    s_cbranch_vccnz adaLN_cond__grouped_kv_mqa__dense_activation_silu__prompt_kernel_st167
adaLN_cond__grouped_kv_mqa__dense_activation_silu__prompt_kernel_bk168:
    v_mfma_f32_32x32x16_bf16 v[88:103], v[204:207], a[116:119], v[88:103]
    v_mfma_f32_32x32x16_bf16 v[88:103], v[220:223], a[244:247], v[88:103]
    v_mfma_f32_32x32x16_bf16 v[88:103], v[172:175], a[120:123], v[88:103]
    v_mfma_f32_32x32x16_bf16 v[88:103], v[140:143], a[248:251], v[88:103]
    v_mfma_f32_32x32x16_bf16 v[88:103], v[156:159], a[124:127], v[88:103]
    v_mfma_f32_32x32x16_bf16 v[88:103], v[124:127], a[252:255], v[88:103]
    s_waitcnt lgkmcnt(4)
    v_mfma_f32_32x32x16_bf16 v[72:87], v[228:231], a[116:119], v[72:87]
    v_lshlrev_b32 v64, 16, v252
    v_and_b32 v65, 0xffff0000, v252
    v_lshlrev_b32 v66, 16, v253
    v_and_b32 v67, 0xffff0000, v253
    s_waitcnt lgkmcnt(3)
    v_mfma_f32_32x32x16_bf16 v[72:87], v[232:235], a[244:247], v[72:87]
    v_lshlrev_b32 v68, 16, v254
    v_and_b32 v69, 0xffff0000, v254
    v_lshlrev_b32 v70, 16, v255
    v_and_b32 v71, 0xffff0000, v255
    ds_write_b128 v11, v[88:91] offset:2048
    ds_write_b128 v11, v[92:95] offset:3072
    s_waitcnt lgkmcnt(4)
    v_mfma_f32_32x32x16_bf16 v[72:87], v[236:239], a[120:123], v[72:87]
    ds_write_b128 v12, v[96:99] offset:4096
    ds_write_b128 v12, v[100:103] offset:5120
    s_waitcnt lgkmcnt(5)
    v_mfma_f32_32x32x16_bf16 v[72:87], v[240:243], a[248:251], v[72:87]
    s_waitcnt lgkmcnt(4)
    v_mfma_f32_32x32x16_bf16 v[72:87], v[244:247], a[124:127], v[72:87]
    s_waitcnt lgkmcnt(0)
    s_barrier
    v_mfma_f32_32x32x16_bf16 v[72:87], a[136:139], a[252:255], v[72:87]
    ds_read_b128 v[88:91], v9 offset:2048
    ds_read_b128 v[92:95], v9 offset:3072
    ds_read_b128 v[96:99], v9 offset:4096
    ds_read_b128 v[100:103], v9 offset:5120
    s_nop 7
    ds_write_b128 v10, v[80:83] offset:0
    ds_write_b128 v10, v[84:87] offset:1024
    s_waitcnt lgkmcnt(0)
    s_barrier
    ds_read_b128 v[80:83], v9 offset:0
    ds_read_b128 v[84:87], v9 offset:1024
    v_pk_add_f32 v[72:73], v[72:73], v[88:89]
    v_pk_add_f32 v[74:75], v[74:75], v[90:91]
    v_pk_add_f32 v[76:77], v[76:77], v[92:93]
    v_pk_add_f32 v[78:79], v[78:79], v[94:95]
    v_pk_add_f32 v[72:73], v[72:73], v[96:97]
    v_pk_add_f32 v[74:75], v[74:75], v[98:99]
    v_pk_add_f32 v[76:77], v[76:77], v[100:101]
    v_pk_add_f32 v[78:79], v[78:79], v[102:103]
    v_pk_fma_f32 v[72:73], v[72:73], v[56:57], v[64:65]
    v_pk_fma_f32 v[74:75], v[74:75], v[58:59], v[66:67]
    v_pk_fma_f32 v[76:77], v[76:77], v[60:61], v[68:69]
    v_pk_fma_f32 v[78:79], v[78:79], v[62:63], v[70:71]
    s_waitcnt lgkmcnt(1)
    v_pk_fma_f32 v[72:73], v[80:81], v[56:57], v[72:73]
    v_pk_fma_f32 v[74:75], v[82:83], v[58:59], v[74:75]
    s_waitcnt lgkmcnt(0)
    v_pk_fma_f32 v[76:77], v[84:85], v[60:61], v[76:77]
    v_pk_fma_f32 v[78:79], v[86:87], v[62:63], v[78:79]
    v_cvt_pk_bf16_f32 v80, v72, v73
    v_cvt_pk_bf16_f32 v81, v74, v75
    v_cvt_pk_bf16_f32 v82, v76, v77
    v_cvt_pk_bf16_f32 v83, v78, v79
    global_store_dwordx4 v14, v[80:83], s[16:17]
adaLN_cond__grouped_kv_mqa__dense_activation_silu__prompt_kernel_fin2:
adaLN_cond__grouped_kv_mqa__dense_activation_silu__prompt_kernel_end1:
    s_endpgm
adaLN_cond__grouped_kv_mqa__dense_activation_silu__prompt_kernel_kvs32:
    s_mov_b32 s101, m0
    s_add_u32 m0, s48, 2064
    v_add_u32 v241, 2048, v2
adaLN_cond__grouped_kv_mqa__dense_activation_silu__prompt_kernel_kvl33:
    global_load_lds_dwordx4 v241, s[52:53] offset:0 sc1
    global_load_lds_dwordx4 v241, s[52:53] offset:1024 sc1
    s_waitcnt vmcnt(0)
    ds_read_b128 v[148:151], v4 offset:2064
    ds_read_b128 v[152:155], v5 offset:2064
    ds_read_b128 v[156:159], v6 offset:2064
    s_waitcnt lgkmcnt(0)
    v_max3_u32 v240, v148, v152, v156
    v_cmp_eq_u32 vcc, -1, v240
    s_cbranch_vccz adaLN_cond__grouped_kv_mqa__dense_activation_silu__prompt_kernel_ok35
    s_add_u32 s96, s96, 1
    s_cmp_lt_u32 s96, 131072
    s_cbranch_scc1 adaLN_cond__grouped_kv_mqa__dense_activation_silu__prompt_kernel_kvl33
adaLN_cond__grouped_kv_mqa__dense_activation_silu__prompt_kernel_ok35:
    s_mov_b32 m0, s101
    s_branch adaLN_cond__grouped_kv_mqa__dense_activation_silu__prompt_kernel_kvb34
adaLN_cond__grouped_kv_mqa__dense_activation_silu__prompt_kernel_kvs36:
    s_mov_b32 s101, m0
    s_add_u32 m0, s48, 4128
    v_add_u32 v241, 4096, v2
adaLN_cond__grouped_kv_mqa__dense_activation_silu__prompt_kernel_kvl37:
    global_load_lds_dwordx4 v241, s[52:53] offset:0 sc1
    global_load_lds_dwordx4 v241, s[52:53] offset:1024 sc1
    s_waitcnt vmcnt(0)
    ds_read_b128 v[136:139], v4 offset:4128
    ds_read_b128 v[140:143], v5 offset:4128
    ds_read_b128 v[144:147], v6 offset:4128
    s_waitcnt lgkmcnt(0)
    v_max3_u32 v240, v136, v140, v144
    v_cmp_eq_u32 vcc, -1, v240
    s_cbranch_vccz adaLN_cond__grouped_kv_mqa__dense_activation_silu__prompt_kernel_ok39
    s_add_u32 s96, s96, 1
    s_cmp_lt_u32 s96, 131072
    s_cbranch_scc1 adaLN_cond__grouped_kv_mqa__dense_activation_silu__prompt_kernel_kvl37
adaLN_cond__grouped_kv_mqa__dense_activation_silu__prompt_kernel_ok39:
    s_mov_b32 m0, s101
    s_branch adaLN_cond__grouped_kv_mqa__dense_activation_silu__prompt_kernel_kvb38
adaLN_cond__grouped_kv_mqa__dense_activation_silu__prompt_kernel_kvs40:
    s_mov_b32 s101, m0
    s_add_u32 m0, s48, 6192
    v_add_u32 v241, 6144, v2
adaLN_cond__grouped_kv_mqa__dense_activation_silu__prompt_kernel_kvl41:
    global_load_lds_dwordx4 v241, s[52:53] offset:0 sc1
    global_load_lds_dwordx4 v241, s[52:53] offset:1024 sc1
    s_waitcnt vmcnt(0)
    ds_read_b128 v[148:151], v4 offset:6192
    ds_read_b128 v[152:155], v5 offset:6192
    ds_read_b128 v[156:159], v6 offset:6192
    s_waitcnt lgkmcnt(0)
    v_max3_u32 v240, v148, v152, v156
    v_cmp_eq_u32 vcc, -1, v240
    s_cbranch_vccz adaLN_cond__grouped_kv_mqa__dense_activation_silu__prompt_kernel_ok43
    s_add_u32 s96, s96, 1
    s_cmp_lt_u32 s96, 131072
    s_cbranch_scc1 adaLN_cond__grouped_kv_mqa__dense_activation_silu__prompt_kernel_kvl41
adaLN_cond__grouped_kv_mqa__dense_activation_silu__prompt_kernel_ok43:
    s_mov_b32 m0, s101
    s_branch adaLN_cond__grouped_kv_mqa__dense_activation_silu__prompt_kernel_kvb42
adaLN_cond__grouped_kv_mqa__dense_activation_silu__prompt_kernel_kvs44:
    s_mov_b32 s101, m0
    s_add_u32 m0, s48, 8256
    v_add_u32 v241, 8192, v2
adaLN_cond__grouped_kv_mqa__dense_activation_silu__prompt_kernel_kvl45:
    global_load_lds_dwordx4 v241, s[52:53] offset:0 sc1
    global_load_lds_dwordx4 v241, s[52:53] offset:1024 sc1
    s_waitcnt vmcnt(0)
    ds_read_b128 v[136:139], v4 offset:8256
    ds_read_b128 v[140:143], v5 offset:8256
    ds_read_b128 v[144:147], v6 offset:8256
    s_waitcnt lgkmcnt(0)
    v_max3_u32 v240, v136, v140, v144
    v_cmp_eq_u32 vcc, -1, v240
    s_cbranch_vccz adaLN_cond__grouped_kv_mqa__dense_activation_silu__prompt_kernel_ok47
    s_add_u32 s96, s96, 1
    s_cmp_lt_u32 s96, 131072
    s_cbranch_scc1 adaLN_cond__grouped_kv_mqa__dense_activation_silu__prompt_kernel_kvl45
adaLN_cond__grouped_kv_mqa__dense_activation_silu__prompt_kernel_ok47:
    s_mov_b32 m0, s101
    s_branch adaLN_cond__grouped_kv_mqa__dense_activation_silu__prompt_kernel_kvb46
adaLN_cond__grouped_kv_mqa__dense_activation_silu__prompt_kernel_kvs48:
    s_mov_b32 s101, m0
    s_add_u32 m0, s48, 10320
    v_add_u32 v241, 10240, v2
adaLN_cond__grouped_kv_mqa__dense_activation_silu__prompt_kernel_kvl49:
    global_load_lds_dwordx4 v241, s[52:53] offset:0 sc1
    global_load_lds_dwordx4 v241, s[52:53] offset:1024 sc1
    s_waitcnt vmcnt(0)
    ds_read_b128 v[148:151], v4 offset:10320
    ds_read_b128 v[152:155], v5 offset:10320
    ds_read_b128 v[156:159], v6 offset:10320
    s_waitcnt lgkmcnt(0)
    v_max3_u32 v240, v148, v152, v156
    v_cmp_eq_u32 vcc, -1, v240
    s_cbranch_vccz adaLN_cond__grouped_kv_mqa__dense_activation_silu__prompt_kernel_ok51
    s_add_u32 s96, s96, 1
    s_cmp_lt_u32 s96, 131072
    s_cbranch_scc1 adaLN_cond__grouped_kv_mqa__dense_activation_silu__prompt_kernel_kvl49
adaLN_cond__grouped_kv_mqa__dense_activation_silu__prompt_kernel_ok51:
    s_mov_b32 m0, s101
    s_branch adaLN_cond__grouped_kv_mqa__dense_activation_silu__prompt_kernel_kvb50
adaLN_cond__grouped_kv_mqa__dense_activation_silu__prompt_kernel_kvs52:
    s_mov_b32 s101, m0
    s_add_u32 m0, s48, 12384
    v_add_u32 v241, 12288, v2
adaLN_cond__grouped_kv_mqa__dense_activation_silu__prompt_kernel_kvl53:
    global_load_lds_dwordx4 v241, s[52:53] offset:0 sc1
    global_load_lds_dwordx4 v241, s[52:53] offset:1024 sc1
    s_waitcnt vmcnt(0)
    ds_read_b128 v[136:139], v4 offset:12384
    ds_read_b128 v[140:143], v5 offset:12384
    ds_read_b128 v[144:147], v6 offset:12384
    s_waitcnt lgkmcnt(0)
    v_max3_u32 v240, v136, v140, v144
    v_cmp_eq_u32 vcc, -1, v240
    s_cbranch_vccz adaLN_cond__grouped_kv_mqa__dense_activation_silu__prompt_kernel_ok55
    s_add_u32 s96, s96, 1
    s_cmp_lt_u32 s96, 131072
    s_cbranch_scc1 adaLN_cond__grouped_kv_mqa__dense_activation_silu__prompt_kernel_kvl53
adaLN_cond__grouped_kv_mqa__dense_activation_silu__prompt_kernel_ok55:
    s_mov_b32 m0, s101
    s_branch adaLN_cond__grouped_kv_mqa__dense_activation_silu__prompt_kernel_kvb54
adaLN_cond__grouped_kv_mqa__dense_activation_silu__prompt_kernel_kvs56:
    s_mov_b32 s101, m0
    s_add_u32 m0, s48, 14448
    v_add_u32 v241, 14336, v2
adaLN_cond__grouped_kv_mqa__dense_activation_silu__prompt_kernel_kvl57:
    global_load_lds_dwordx4 v241, s[52:53] offset:0 sc1
    global_load_lds_dwordx4 v241, s[52:53] offset:1024 sc1
    s_waitcnt vmcnt(0)
    ds_read_b128 v[148:151], v4 offset:14448
    ds_read_b128 v[152:155], v5 offset:14448
    ds_read_b128 v[156:159], v6 offset:14448
    s_waitcnt lgkmcnt(0)
    v_max3_u32 v240, v148, v152, v156
    v_cmp_eq_u32 vcc, -1, v240
    s_cbranch_vccz adaLN_cond__grouped_kv_mqa__dense_activation_silu__prompt_kernel_ok59
    s_add_u32 s96, s96, 1
    s_cmp_lt_u32 s96, 131072
    s_cbranch_scc1 adaLN_cond__grouped_kv_mqa__dense_activation_silu__prompt_kernel_kvl57
adaLN_cond__grouped_kv_mqa__dense_activation_silu__prompt_kernel_ok59:
    s_mov_b32 m0, s101
    s_branch adaLN_cond__grouped_kv_mqa__dense_activation_silu__prompt_kernel_kvb58
adaLN_cond__grouped_kv_mqa__dense_activation_silu__prompt_kernel_kvs60:
    s_mov_b32 s101, m0
    s_add_u32 m0, s48, 16512
    v_add_u32 v241, 16384, v2
adaLN_cond__grouped_kv_mqa__dense_activation_silu__prompt_kernel_kvl61:
    global_load_lds_dwordx4 v241, s[52:53] offset:0 sc1
    global_load_lds_dwordx4 v241, s[52:53] offset:1024 sc1
    s_waitcnt vmcnt(0)
    ds_read_b128 v[136:139], v4 offset:16512
    ds_read_b128 v[140:143], v5 offset:16512
    ds_read_b128 v[144:147], v6 offset:16512
    s_waitcnt lgkmcnt(0)
    v_max3_u32 v240, v136, v140, v144
    v_cmp_eq_u32 vcc, -1, v240
    s_cbranch_vccz adaLN_cond__grouped_kv_mqa__dense_activation_silu__prompt_kernel_ok63
    s_add_u32 s96, s96, 1
    s_cmp_lt_u32 s96, 131072
    s_cbranch_scc1 adaLN_cond__grouped_kv_mqa__dense_activation_silu__prompt_kernel_kvl61
adaLN_cond__grouped_kv_mqa__dense_activation_silu__prompt_kernel_ok63:
    s_mov_b32 m0, s101
    s_branch adaLN_cond__grouped_kv_mqa__dense_activation_silu__prompt_kernel_kvb62
adaLN_cond__grouped_kv_mqa__dense_activation_silu__prompt_kernel_kvs64:
    s_mov_b32 s101, m0
    s_add_u32 m0, s48, 18576
    v_add_u32 v241, 18432, v2
adaLN_cond__grouped_kv_mqa__dense_activation_silu__prompt_kernel_kvl65:
    global_load_lds_dwordx4 v241, s[52:53] offset:0 sc1
    global_load_lds_dwordx4 v241, s[52:53] offset:1024 sc1
    s_waitcnt vmcnt(0)
    ds_read_b128 v[148:151], v4 offset:18576
    ds_read_b128 v[152:155], v5 offset:18576
    ds_read_b128 v[156:159], v6 offset:18576
    s_waitcnt lgkmcnt(0)
    v_max3_u32 v240, v148, v152, v156
    v_cmp_eq_u32 vcc, -1, v240
    s_cbranch_vccz adaLN_cond__grouped_kv_mqa__dense_activation_silu__prompt_kernel_ok67
    s_add_u32 s96, s96, 1
    s_cmp_lt_u32 s96, 131072
    s_cbranch_scc1 adaLN_cond__grouped_kv_mqa__dense_activation_silu__prompt_kernel_kvl65
adaLN_cond__grouped_kv_mqa__dense_activation_silu__prompt_kernel_ok67:
    s_mov_b32 m0, s101
    s_branch adaLN_cond__grouped_kv_mqa__dense_activation_silu__prompt_kernel_kvb66
adaLN_cond__grouped_kv_mqa__dense_activation_silu__prompt_kernel_kvs68:
    s_mov_b32 s101, m0
    s_add_u32 m0, s48, 20640
    v_add_u32 v241, 20480, v2
adaLN_cond__grouped_kv_mqa__dense_activation_silu__prompt_kernel_kvl69:
    global_load_lds_dwordx4 v241, s[52:53] offset:0 sc1
    global_load_lds_dwordx4 v241, s[52:53] offset:1024 sc1
    s_waitcnt vmcnt(0)
    ds_read_b128 v[136:139], v4 offset:20640
    ds_read_b128 v[140:143], v5 offset:20640
    ds_read_b128 v[144:147], v6 offset:20640
    s_waitcnt lgkmcnt(0)
    v_max3_u32 v240, v136, v140, v144
    v_cmp_eq_u32 vcc, -1, v240
    s_cbranch_vccz adaLN_cond__grouped_kv_mqa__dense_activation_silu__prompt_kernel_ok71
    s_add_u32 s96, s96, 1
    s_cmp_lt_u32 s96, 131072
    s_cbranch_scc1 adaLN_cond__grouped_kv_mqa__dense_activation_silu__prompt_kernel_kvl69
adaLN_cond__grouped_kv_mqa__dense_activation_silu__prompt_kernel_ok71:
    s_mov_b32 m0, s101
    s_branch adaLN_cond__grouped_kv_mqa__dense_activation_silu__prompt_kernel_kvb70
adaLN_cond__grouped_kv_mqa__dense_activation_silu__prompt_kernel_kvs72:
    s_mov_b32 s101, m0
    s_add_u32 m0, s48, 22704
    v_add_u32 v241, 22528, v2
adaLN_cond__grouped_kv_mqa__dense_activation_silu__prompt_kernel_kvl73:
    global_load_lds_dwordx4 v241, s[52:53] offset:0 sc1
    global_load_lds_dwordx4 v241, s[52:53] offset:1024 sc1
    s_waitcnt vmcnt(0)
    ds_read_b128 v[148:151], v4 offset:22704
    ds_read_b128 v[152:155], v5 offset:22704
    ds_read_b128 v[156:159], v6 offset:22704
    s_waitcnt lgkmcnt(0)
    v_max3_u32 v240, v148, v152, v156
    v_cmp_eq_u32 vcc, -1, v240
    s_cbranch_vccz adaLN_cond__grouped_kv_mqa__dense_activation_silu__prompt_kernel_ok75
    s_add_u32 s96, s96, 1
    s_cmp_lt_u32 s96, 131072
    s_cbranch_scc1 adaLN_cond__grouped_kv_mqa__dense_activation_silu__prompt_kernel_kvl73
adaLN_cond__grouped_kv_mqa__dense_activation_silu__prompt_kernel_ok75:
    s_mov_b32 m0, s101
    s_branch adaLN_cond__grouped_kv_mqa__dense_activation_silu__prompt_kernel_kvb74
adaLN_cond__grouped_kv_mqa__dense_activation_silu__prompt_kernel_kvs76:
    s_mov_b32 s101, m0
    s_add_u32 m0, s48, 24768
    v_add_u32 v241, 24576, v2
adaLN_cond__grouped_kv_mqa__dense_activation_silu__prompt_kernel_kvl77:
    global_load_lds_dwordx4 v241, s[52:53] offset:0 sc1
    global_load_lds_dwordx4 v241, s[52:53] offset:1024 sc1
    s_waitcnt vmcnt(0)
    ds_read_b128 v[136:139], v4 offset:24768
    ds_read_b128 v[140:143], v5 offset:24768
    ds_read_b128 v[144:147], v6 offset:24768
    s_waitcnt lgkmcnt(0)
    v_max3_u32 v240, v136, v140, v144
    v_cmp_eq_u32 vcc, -1, v240
    s_cbranch_vccz adaLN_cond__grouped_kv_mqa__dense_activation_silu__prompt_kernel_ok79
    s_add_u32 s96, s96, 1
    s_cmp_lt_u32 s96, 131072
    s_cbranch_scc1 adaLN_cond__grouped_kv_mqa__dense_activation_silu__prompt_kernel_kvl77
adaLN_cond__grouped_kv_mqa__dense_activation_silu__prompt_kernel_ok79:
    s_mov_b32 m0, s101
    s_branch adaLN_cond__grouped_kv_mqa__dense_activation_silu__prompt_kernel_kvb78
adaLN_cond__grouped_kv_mqa__dense_activation_silu__prompt_kernel_kvs80:
    s_mov_b32 s101, m0
    s_add_u32 m0, s48, 26832
    v_add_u32 v241, 26624, v2
adaLN_cond__grouped_kv_mqa__dense_activation_silu__prompt_kernel_kvl81:
    global_load_lds_dwordx4 v241, s[52:53] offset:0 sc1
    global_load_lds_dwordx4 v241, s[52:53] offset:1024 sc1
    s_waitcnt vmcnt(0)
    ds_read_b128 v[148:151], v4 offset:26832
    ds_read_b128 v[152:155], v5 offset:26832
    ds_read_b128 v[156:159], v6 offset:26832
    s_waitcnt lgkmcnt(0)
    v_max3_u32 v240, v148, v152, v156
    v_cmp_eq_u32 vcc, -1, v240
    s_cbranch_vccz adaLN_cond__grouped_kv_mqa__dense_activation_silu__prompt_kernel_ok83
    s_add_u32 s96, s96, 1
    s_cmp_lt_u32 s96, 131072
    s_cbranch_scc1 adaLN_cond__grouped_kv_mqa__dense_activation_silu__prompt_kernel_kvl81
adaLN_cond__grouped_kv_mqa__dense_activation_silu__prompt_kernel_ok83:
    s_mov_b32 m0, s101
    s_branch adaLN_cond__grouped_kv_mqa__dense_activation_silu__prompt_kernel_kvb82
adaLN_cond__grouped_kv_mqa__dense_activation_silu__prompt_kernel_kvs84:
    s_mov_b32 s101, m0
    s_add_u32 m0, s48, 28896
    v_add_u32 v241, 28672, v2
adaLN_cond__grouped_kv_mqa__dense_activation_silu__prompt_kernel_kvl85:
    global_load_lds_dwordx4 v241, s[52:53] offset:0 sc1
    global_load_lds_dwordx4 v241, s[52:53] offset:1024 sc1
    s_waitcnt vmcnt(0)
    ds_read_b128 v[136:139], v4 offset:28896
    ds_read_b128 v[140:143], v5 offset:28896
    ds_read_b128 v[144:147], v6 offset:28896
    s_waitcnt lgkmcnt(0)
    v_max3_u32 v240, v136, v140, v144
    v_cmp_eq_u32 vcc, -1, v240
    s_cbranch_vccz adaLN_cond__grouped_kv_mqa__dense_activation_silu__prompt_kernel_ok87
    s_add_u32 s96, s96, 1
    s_cmp_lt_u32 s96, 131072
    s_cbranch_scc1 adaLN_cond__grouped_kv_mqa__dense_activation_silu__prompt_kernel_kvl85
adaLN_cond__grouped_kv_mqa__dense_activation_silu__prompt_kernel_ok87:
    s_mov_b32 m0, s101
    s_branch adaLN_cond__grouped_kv_mqa__dense_activation_silu__prompt_kernel_kvb86
adaLN_cond__grouped_kv_mqa__dense_activation_silu__prompt_kernel_kvs88:
    s_mov_b32 s101, m0
    s_add_u32 m0, s48, 30960
    v_add_u32 v241, 30720, v2
adaLN_cond__grouped_kv_mqa__dense_activation_silu__prompt_kernel_kvl89:
    global_load_lds_dwordx4 v241, s[52:53] offset:0 sc1
    global_load_lds_dwordx4 v241, s[52:53] offset:1024 sc1
    s_waitcnt vmcnt(0)
    ds_read_b128 v[148:151], v4 offset:30960
    ds_read_b128 v[152:155], v5 offset:30960
    ds_read_b128 v[156:159], v6 offset:30960
    s_waitcnt lgkmcnt(0)
    v_max3_u32 v240, v148, v152, v156
    v_cmp_eq_u32 vcc, -1, v240
    s_cbranch_vccz adaLN_cond__grouped_kv_mqa__dense_activation_silu__prompt_kernel_ok91
    s_add_u32 s96, s96, 1
    s_cmp_lt_u32 s96, 131072
    s_cbranch_scc1 adaLN_cond__grouped_kv_mqa__dense_activation_silu__prompt_kernel_kvl89
adaLN_cond__grouped_kv_mqa__dense_activation_silu__prompt_kernel_ok91:
    s_mov_b32 m0, s101
    s_branch adaLN_cond__grouped_kv_mqa__dense_activation_silu__prompt_kernel_kvb90
adaLN_cond__grouped_kv_mqa__dense_activation_silu__prompt_kernel_st92:
    global_load_dword v124, v128, s[28:29] sc1
    s_waitcnt vmcnt(0)
    v_cmp_eq_u32 vcc, -1, v124
    s_cbranch_vccz adaLN_cond__grouped_kv_mqa__dense_activation_silu__prompt_kernel_ok94
    s_add_u32 s96, s96, 1
    s_cmp_lt_u32 s96, 131072
    s_cbranch_scc1 adaLN_cond__grouped_kv_mqa__dense_activation_silu__prompt_kernel_st92
adaLN_cond__grouped_kv_mqa__dense_activation_silu__prompt_kernel_ok94:
    s_branch adaLN_cond__grouped_kv_mqa__dense_activation_silu__prompt_kernel_bk93
adaLN_cond__grouped_kv_mqa__dense_activation_silu__prompt_kernel_st95:
    global_load_dwordx4 v[108:111], v102, s[28:29] sc1
    global_load_dwordx4 v[112:115], v103, s[28:29] sc1
    global_load_dword v116, v104, s[28:29] sc1
    global_load_dword v117, v105, s[28:29] sc1
    s_waitcnt vmcnt(0)
    v_max_u32 v242, v108, v109
    v_max3_u32 v242, v242, v110, v111
    v_max3_u32 v242, v242, v112, v113
    v_max3_u32 v242, v242, v114, v115
    v_max3_u32 v242, v242, v116, v117
    v_cmp_eq_u32 vcc, -1, v242
    s_cbranch_vccz adaLN_cond__grouped_kv_mqa__dense_activation_silu__prompt_kernel_ok97
    s_add_u32 s96, s96, 1
    s_cmp_lt_u32 s96, 131072
    s_cbranch_scc1 adaLN_cond__grouped_kv_mqa__dense_activation_silu__prompt_kernel_st95
adaLN_cond__grouped_kv_mqa__dense_activation_silu__prompt_kernel_ok97:
    s_branch adaLN_cond__grouped_kv_mqa__dense_activation_silu__prompt_kernel_bk96
adaLN_cond__grouped_kv_mqa__dense_activation_silu__prompt_kernel_st98:
    global_load_dword v134, v133, s[28:29] sc1
    s_waitcnt vmcnt(0)
    v_cmp_eq_u32 vcc, -1, v134
    s_cbranch_vccz adaLN_cond__grouped_kv_mqa__dense_activation_silu__prompt_kernel_ok100
    s_add_u32 s96, s96, 1
    s_cmp_lt_u32 s96, 131072
    s_cbranch_scc1 adaLN_cond__grouped_kv_mqa__dense_activation_silu__prompt_kernel_st98
adaLN_cond__grouped_kv_mqa__dense_activation_silu__prompt_kernel_ok100:
    s_branch adaLN_cond__grouped_kv_mqa__dense_activation_silu__prompt_kernel_bk99
adaLN_cond__grouped_kv_mqa__dense_activation_silu__prompt_kernel_alt101:
    global_store_dwordx4 v13, v[72:75], s[50:51] sc1
    global_store_dwordx4 v13, v[72:75], s[6:7] sc1
    global_store_dwordx4 v13, v[72:75], s[8:9] sc1
    global_store_dwordx4 v13, v[72:75], s[10:11] sc1
    global_store_dwordx2 v98, v[72:73], s[12:13] sc1
    global_store_dwordx4 v96, v[72:75], s[18:19] offset:0 sc1
    global_store_dwordx4 v96, v[72:75], s[18:19] offset:1024 sc1
    global_store_dwordx4 v97, v[72:75], s[18:19] offset:0 sc1
    global_store_dwordx4 v97, v[72:75], s[18:19] offset:1024 sc1
    global_store_dwordx4 v96, v[72:75], s[20:21] offset:0 sc1
    global_store_dwordx4 v96, v[72:75], s[20:21] offset:1024 sc1
    global_store_dwordx4 v97, v[72:75], s[20:21] offset:0 sc1
    global_store_dwordx4 v97, v[72:75], s[20:21] offset:1024 sc1
    s_waitcnt vmcnt(0)
    global_store_dword v15, v1, s[28:29] offset:-4096 sc1
    s_branch adaLN_cond__grouped_kv_mqa__dense_activation_silu__prompt_kernel_bk102
adaLN_cond__grouped_kv_mqa__dense_activation_silu__prompt_kernel_st103:
    global_load_dword v134, v133, s[28:29] offset:-4096 sc1
    s_waitcnt vmcnt(0)
    v_cmp_eq_u32 vcc, -1, v134
    s_cbranch_vccz adaLN_cond__grouped_kv_mqa__dense_activation_silu__prompt_kernel_ok105
    s_add_u32 s96, s96, 1
    s_cmp_lt_u32 s96, 131072
    s_cbranch_scc1 adaLN_cond__grouped_kv_mqa__dense_activation_silu__prompt_kernel_st103
adaLN_cond__grouped_kv_mqa__dense_activation_silu__prompt_kernel_ok105:
    s_branch adaLN_cond__grouped_kv_mqa__dense_activation_silu__prompt_kernel_bk104
adaLN_cond__grouped_kv_mqa__dense_activation_silu__prompt_kernel_obad106:
    s_or_b32 s97, s97, 1
    v_add_u32 v236, 147456, v13
    global_store_dwordx4 v236, v[224:227], s[50:51] sc1
    v_mov_b32 v228, 0xfffefffe
    v_mov_b32 v229, 0xfffefffe
    v_mov_b32 v230, 0xfffefffe
    v_mov_b32 v231, 0xfffefffe
    global_store_dwordx4 v13, v[228:231], s[50:51] sc1
    s_nop 1
    s_branch adaLN_cond__grouped_kv_mqa__dense_activation_silu__prompt_kernel_obk107
adaLN_cond__grouped_kv_mqa__dense_activation_silu__prompt_kernel_alt108:
    s_cbranch_vccnz adaLN_cond__grouped_kv_mqa__dense_activation_silu__prompt_kernel_obad106
    global_store_dwordx4 v13, v[228:231], s[50:51] sc1
    s_nop 1
    s_branch adaLN_cond__grouped_kv_mqa__dense_activation_silu__prompt_kernel_obk107
adaLN_cond__grouped_kv_mqa__dense_activation_silu__prompt_kernel_st109:
    global_load_dwordx4 v[224:227], v15, s[50:51] offset:-4096 sc1
    global_load_dwordx4 v[228:231], v15, s[50:51] offset:-3072 sc1
    global_load_dwordx4 v[232:235], v15, s[50:51] offset:-2048 sc1
    global_load_dwordx4 v[236:239], v15, s[50:51] offset:-1024 sc1
    global_load_dwordx4 v[240:243], v15, s[50:51] offset:0 sc1
    global_load_dwordx4 v[244:247], v15, s[50:51] offset:1024 sc1
    global_load_dwordx4 v[248:251], v15, s[50:51] offset:2048 sc1
    global_load_dwordx4 v[252:255], v15, s[50:51] offset:3072 sc1
    s_waitcnt vmcnt(0)
    v_max_u32 v14, v224, v228
    v_max3_u32 v14, v14, v232, v236
    v_max3_u32 v14, v14, v240, v244
    v_max3_u32 v14, v14, v248, v252
    v_cmp_eq_u32 vcc, -1, v14
    s_cbranch_vccz adaLN_cond__grouped_kv_mqa__dense_activation_silu__prompt_kernel_ok111
    s_add_u32 s96, s96, 1
    s_cmp_lt_u32 s96, 131072
    s_cbranch_scc1 adaLN_cond__grouped_kv_mqa__dense_activation_silu__prompt_kernel_st109
adaLN_cond__grouped_kv_mqa__dense_activation_silu__prompt_kernel_ok111:
    s_branch adaLN_cond__grouped_kv_mqa__dense_activation_silu__prompt_kernel_bk110
adaLN_cond__grouped_kv_mqa__dense_activation_silu__prompt_kernel_dbad112:
    ds_write_b32 v9, v9 offset:6156
    ds_write_b32 v10, v9 offset:6156
    ds_write_b32 v11, v9 offset:6156
    ds_write_b32 v12, v9 offset:6156
    s_waitcnt vmcnt(0)
    s_branch adaLN_cond__grouped_kv_mqa__dense_activation_silu__prompt_kernel_dbk113
adaLN_cond__grouped_kv_mqa__dense_activation_silu__prompt_kernel_alt114:
    s_cbranch_vccnz adaLN_cond__grouped_kv_mqa__dense_activation_silu__prompt_kernel_dbad112
    global_store_dwordx4 v13, v[240:243], s[8:9] sc1
    global_store_dword v253, v232, s[12:13] sc1
    s_nop 1
    s_branch adaLN_cond__grouped_kv_mqa__dense_activation_silu__prompt_kernel_dbk113
adaLN_cond__grouped_kv_mqa__dense_activation_silu__prompt_kernel_st115:
adaLN_cond__grouped_kv_mqa__dense_activation_silu__prompt_kernel_lp116:
    ds_read_b32 v232, v9 offset:6156
    s_waitcnt lgkmcnt(0)
    v_cmp_ne_u32 vcc, 0, v232
    s_cbranch_vccnz adaLN_cond__grouped_kv_mqa__dense_activation_silu__prompt_kernel_bk117
    s_add_u32 m0, s48, 4096
    s_nop 0
    global_load_lds_dwordx4 v15, s[8:9] offset:-4096 sc1
    global_load_lds_dwordx4 v15, s[8:9] offset:-3072 sc1
    global_load_lds_dwordx4 v15, s[8:9] offset:-2048 sc1
    global_load_lds_dwordx4 v15, s[8:9] offset:-1024 sc1
    global_load_lds_dwordx4 v15, s[8:9] offset:0 sc1
    global_load_lds_dwordx4 v15, s[8:9] offset:1024 sc1
    global_load_lds_dwordx4 v15, s[8:9] offset:2048 sc1
    global_load_lds_dwordx4 v15, s[8:9] offset:3072 sc1
    global_load_dwordx4 v[224:227], v244, s[12:13] offset:0 sc1
    global_load_dwordx4 v[228:231], v244, s[12:13] offset:1024 sc1
    s_waitcnt vmcnt(0)
    ds_read2st64_b32 v[232:233], v4 offset0:0 offset1:4
    ds_read2st64_b32 v[234:235], v4 offset0:8 offset1:12
    ds_read2st64_b32 v[236:237], v4 offset0:16 offset1:20
    ds_read2st64_b32 v[238:239], v4 offset0:24 offset1:28
    v_add_f32 v224, v224, v226
    v_add_f32 v225, v225, v227
    v_add_f32 v228, v228, v230
    v_add_f32 v229, v229, v231
    v_add_f32 v224, v224, v228
    v_add_f32 v225, v225, v229
    s_waitcnt lgkmcnt(0)
    v_max_u32 v240, v232, v233
    v_max3_u32 v240, v240, v234, v235
    v_max3_u32 v240, v240, v236, v237
    v_max3_u32 v240, v240, v238, v239
    v_cmp_eq_u32 vcc, -1, v240
    v_cmp_u_f32 s[56:57], v224, v225
    s_or_b64 vcc, vcc, s[56:57]
    s_cbranch_vccz adaLN_cond__grouped_kv_mqa__dense_activation_silu__prompt_kernel_ok118
    s_add_u32 s96, s96, 1
    s_cmp_lt_u32 s96, 131072
    s_cbranch_scc1 adaLN_cond__grouped_kv_mqa__dense_activation_silu__prompt_kernel_lp116
adaLN_cond__grouped_kv_mqa__dense_activation_silu__prompt_kernel_ok118:
    v_permlane32_swap_b32 v224, v225
    v_add_f32 v224, v224, v225
    ds_write_b32 v245, v224 offset:22704
    s_waitcnt lgkmcnt(0)
    s_branch adaLN_cond__grouped_kv_mqa__dense_activation_silu__prompt_kernel_bk117
adaLN_cond__grouped_kv_mqa__dense_activation_silu__prompt_kernel_kvs119:
    s_mov_b32 s101, m0
    s_add_u32 m0, s48, 0
    v_add_u32 v241, 0, v2
adaLN_cond__grouped_kv_mqa__dense_activation_silu__prompt_kernel_kvl120:
    global_load_lds_dwordx4 v241, s[52:53] offset:0 sc1
    global_load_lds_dwordx4 v241, s[52:53] offset:1024 sc1
    s_waitcnt vmcnt(0)
    ds_read_b128 v[136:139], v4 offset:0
    ds_read_b128 v[140:143], v5 offset:0
    ds_read_b128 v[144:147], v6 offset:0
    s_waitcnt lgkmcnt(0)
    v_max3_u32 v240, v136, v140, v144
    v_cmp_eq_u32 vcc, -1, v240
    s_cbranch_vccz adaLN_cond__grouped_kv_mqa__dense_activation_silu__prompt_kernel_ok122
    s_add_u32 s96, s96, 1
    s_cmp_lt_u32 s96, 131072
    s_cbranch_scc1 adaLN_cond__grouped_kv_mqa__dense_activation_silu__prompt_kernel_kvl120
adaLN_cond__grouped_kv_mqa__dense_activation_silu__prompt_kernel_ok122:
    s_mov_b32 m0, s101
    s_branch adaLN_cond__grouped_kv_mqa__dense_activation_silu__prompt_kernel_kvb121
adaLN_cond__grouped_kv_mqa__dense_activation_silu__prompt_kernel_obad128:
    s_or_b32 s97, s97, 2
    s_waitcnt vmcnt(0) lgkmcnt(0)
    s_nop 15
    s_nop 7
    v_mov_b32 v133, 0xff7fffff
    v_add_u32 v132, 65536, v2
    s_mov_b32 s60, 0
    v_mov_b32 v76, 0x3f803f80
    v_mov_b32 v77, 0x3f803f80
    v_mov_b32 v78, 0x3f803f80
    v_mov_b32 v79, 0x3f803f80
    v_mov_b32 v80, 0x3f803f80
    v_mov_b32 v81, 0x3f803f80
    v_mov_b32 v82, 0x3f803f80
    v_mov_b32 v83, 0x3f803f80
    v_mov_b32 v116, 0
    v_mov_b32 v117, 0
    v_mov_b32 v118, 0
    v_mov_b32 v119, 0
    v_mov_b32 v120, 0
    v_mov_b32 v121, 0
    v_mov_b32 v122, 0
    v_mov_b32 v123, 0
    v_mov_b32 v124, 0
    v_mov_b32 v125, 0
    v_mov_b32 v126, 0
    v_mov_b32 v127, 0
    v_mov_b32 v128, 0
    v_mov_b32 v129, 0
    v_mov_b32 v130, 0
    v_mov_b32 v131, 0
adaLN_cond__grouped_kv_mqa__dense_activation_silu__prompt_kernel_fba124:
    global_load_dwordx4 v[72:75], v132, s[28:29] sc1
    s_waitcnt vmcnt(0)
    v_cmp_eq_u32 vcc, -1, v72
    s_cbranch_vccz adaLN_cond__grouped_kv_mqa__dense_activation_silu__prompt_kernel_ok126
    s_add_u32 s96, s96, 1
    s_cmp_lt_u32 s96, 131072
    s_cbranch_scc1 adaLN_cond__grouped_kv_mqa__dense_activation_silu__prompt_kernel_fba124
adaLN_cond__grouped_kv_mqa__dense_activation_silu__prompt_kernel_ok126:
    v_mfma_f32_32x32x16_bf16 v[84:99], v[72:75], v[56:59], 0
    s_nop 15
    s_nop 7
    v_max3_f32 v133, v133, v84, v85
    v_max3_f32 v133, v133, v86, v87
    v_max3_f32 v133, v133, v88, v89
    v_max3_f32 v133, v133, v90, v91
    v_max3_f32 v133, v133, v92, v93
    v_max3_f32 v133, v133, v94, v95
    v_max3_f32 v133, v133, v96, v97
    v_max3_f32 v133, v133, v98, v99
    v_add_u32 v132, 2048, v132
    s_add_u32 s60, s60, 1
    s_cmp_lt_u32 s60, 64
    s_cbranch_scc1 adaLN_cond__grouped_kv_mqa__dense_activation_silu__prompt_kernel_fba124
    v_mov_b32 v134, v133
    s_nop 1
    v_permlane32_swap_b32 v133, v134
    v_max_f32 v133, v133, v134
    v_sub_f32 v100, 0, v133
    v_sub_f32 v101, 0, v133
    v_sub_f32 v102, 0, v133
    v_sub_f32 v103, 0, v133
    v_sub_f32 v104, 0, v133
    v_sub_f32 v105, 0, v133
    v_sub_f32 v106, 0, v133
    v_sub_f32 v107, 0, v133
    v_sub_f32 v108, 0, v133
    v_sub_f32 v109, 0, v133
    v_sub_f32 v110, 0, v133
    v_sub_f32 v111, 0, v133
    v_sub_f32 v112, 0, v133
    v_sub_f32 v113, 0, v133
    v_sub_f32 v114, 0, v133
    v_sub_f32 v115, 0, v133
    v_add_u32 v132, 65536, v2
    s_mov_b32 s60, 0
adaLN_cond__grouped_kv_mqa__dense_activation_silu__prompt_kernel_fbb125:
    global_load_dwordx4 v[72:75], v132, s[28:29] sc1
    s_mov_b32 exec_lo, 0xffff0000
    s_mov_b32 exec_hi, 0xffff0000
    global_load_dwordx4 v[76:79], v132, s[28:29] offset:1024 sc1
    global_load_dwordx4 v[80:83], v132, s[28:29] offset:768 sc1
    s_mov_b64 exec, -1
    s_waitcnt vmcnt(0)
    v_max3_u32 v134, v72, v76, v80
    v_cmp_eq_u32 vcc, -1, v134
    s_cbranch_vccz adaLN_cond__grouped_kv_mqa__dense_activation_silu__prompt_kernel_ok127
    s_add_u32 s96, s96, 1
    s_cmp_lt_u32 s96, 131072
    s_cbranch_scc1 adaLN_cond__grouped_kv_mqa__dense_activation_silu__prompt_kernel_fbb125
adaLN_cond__grouped_kv_mqa__dense_activation_silu__prompt_kernel_ok127:
    v_mfma_f32_32x32x16_bf16 v[84:99], v[72:75], v[56:59], v[100:115]
    s_nop 15
    s_nop 7
    v_exp_f32 v84, v84
    v_exp_f32 v85, v85
    v_exp_f32 v86, v86
    v_exp_f32 v87, v87
    v_exp_f32 v88, v88
    v_exp_f32 v89, v89
    v_exp_f32 v90, v90
    v_exp_f32 v91, v91
    v_exp_f32 v92, v92
    v_exp_f32 v93, v93
    v_exp_f32 v94, v94
    v_exp_f32 v95, v95
    v_exp_f32 v96, v96
    v_exp_f32 v97, v97
    v_exp_f32 v98, v98
    v_exp_f32 v99, v99
    v_cvt_pk_bf16_f32 v84, v84, v85
    v_cvt_pk_bf16_f32 v85, v86, v87
    v_cvt_pk_bf16_f32 v86, v88, v89
    v_cvt_pk_bf16_f32 v87, v90, v91
    v_cvt_pk_bf16_f32 v88, v92, v93
    v_cvt_pk_bf16_f32 v89, v94, v95
    v_cvt_pk_bf16_f32 v90, v96, v97
    v_cvt_pk_bf16_f32 v91, v98, v99
    s_nop 3
    v_mfma_f32_32x32x16_bf16 v[116:131], v[76:79], v[84:87], v[116:131]
    v_mfma_f32_32x32x16_bf16 v[116:131], v[80:83], v[88:91], v[116:131]
    s_nop 15
    s_nop 7
    v_add_u32 v132, 2048, v132
    s_add_u32 s60, s60, 1
    s_cmp_lt_u32 s60, 64
    s_cbranch_scc1 adaLN_cond__grouped_kv_mqa__dense_activation_silu__prompt_kernel_fbb125
    s_nop 15
    s_nop 7
    v_rcp_f32 v116, v116
    s_nop 1
    v_mul_f32 v124, v124, v116
    v_mul_f32 v125, v125, v116
    v_mul_f32 v126, v126, v116
    v_mul_f32 v127, v127, v116
    v_mul_f32 v128, v128, v116
    v_mul_f32 v129, v129, v116
    v_mul_f32 v130, v130, v116
    v_mul_f32 v131, v131, v116
    v_cvt_pk_bf16_f32 v72, v124, v125
    v_cvt_pk_bf16_f32 v73, v126, v127
    v_cvt_pk_bf16_f32 v74, v128, v129
    v_cvt_pk_bf16_f32 v75, v130, v131
    global_store_dwordx4 v13, v[72:75], s[6:7] sc1
    s_waitcnt vmcnt(0)
    s_branch adaLN_cond__grouped_kv_mqa__dense_activation_silu__prompt_kernel_obk129
adaLN_cond__grouped_kv_mqa__dense_activation_silu__prompt_kernel_st130:
    global_load_dwordx4 v[60:63], v2, s[0:1] offset:0 sc1
    global_load_dwordx4 v[156:159], v2, s[0:1] offset:1024 sc1
    global_load_dwordx4 v[68:71], v2, s[0:1] offset:2048 sc1
    global_load_dwordx4 v[152:155], v2, s[0:1] offset:3072 sc1
    s_waitcnt vmcnt(0)
    v_add_f32 v60, v60, v156
    v_add_f32 v61, v61, v157
    v_add_f32 v62, v62, v158
    v_add_f32 v63, v63, v159
    v_add_f32 v60, v60, v62
    v_add_f32 v61, v61, v63
    v_add_f32 v156, v60, v61
    v_add_f32 v68, v68, v152
    v_add_f32 v69, v69, v153
    v_add_f32 v70, v70, v154
    v_add_f32 v71, v71, v155
    v_add_f32 v68, v68, v70
    v_add_f32 v69, v69, v71
    v_add_f32 v158, v68, v69
    v_cmp_u_f32 vcc, v156, v158
    s_cbranch_vccz adaLN_cond__grouped_kv_mqa__dense_activation_silu__prompt_kernel_ok132
    s_add_u32 s96, s96, 1
    s_cmp_lt_u32 s96, 131072
    s_cbranch_scc1 adaLN_cond__grouped_kv_mqa__dense_activation_silu__prompt_kernel_st130
adaLN_cond__grouped_kv_mqa__dense_activation_silu__prompt_kernel_ok132:
    s_branch adaLN_cond__grouped_kv_mqa__dense_activation_silu__prompt_kernel_bk131
adaLN_cond__grouped_kv_mqa__dense_activation_silu__prompt_kernel_st133:
    global_load_dwordx4 v[120:123], v15, s[6:7] offset:-4096 sc1
    global_load_dwordx4 v[124:127], v15, s[6:7] offset:-3072 sc1
    global_load_dwordx4 v[128:131], v15, s[6:7] offset:-2048 sc1
    global_load_dwordx4 v[132:135], v15, s[6:7] offset:-1024 sc1
    global_load_dwordx4 v[136:139], v15, s[6:7] offset:0 sc1
    global_load_dwordx4 v[140:143], v15, s[6:7] offset:1024 sc1
    global_load_dwordx4 v[144:147], v15, s[6:7] offset:2048 sc1
    global_load_dwordx4 v[148:151], v15, s[6:7] offset:3072 sc1
    s_waitcnt vmcnt(0)
    v_max_u32 v72, v120, v124
    v_max3_u32 v72, v72, v128, v132
    v_max3_u32 v72, v72, v136, v140
    v_max3_u32 v72, v72, v144, v148
    v_cmp_eq_u32 vcc, -1, v72
    s_cbranch_vccz adaLN_cond__grouped_kv_mqa__dense_activation_silu__prompt_kernel_ok135
    s_add_u32 s96, s96, 1
    s_cmp_lt_u32 s96, 131072
    s_cbranch_scc1 adaLN_cond__grouped_kv_mqa__dense_activation_silu__prompt_kernel_st133
adaLN_cond__grouped_kv_mqa__dense_activation_silu__prompt_kernel_ok135:
    s_branch adaLN_cond__grouped_kv_mqa__dense_activation_silu__prompt_kernel_bk134
adaLN_cond__grouped_kv_mqa__dense_activation_silu__prompt_kernel_st136:
adaLN_cond__grouped_kv_mqa__dense_activation_silu__prompt_kernel_lp137:
    s_add_u32 m0, s49, 4096
    s_nop 0
    global_load_lds_dwordx4 v15, s[10:11] offset:-4096 sc1
    global_load_lds_dwordx4 v15, s[10:11] offset:-3072 sc1
    global_load_lds_dwordx4 v15, s[10:11] offset:-2048 sc1
    global_load_lds_dwordx4 v15, s[10:11] offset:-1024 sc1
    global_load_lds_dwordx4 v15, s[10:11] offset:0 sc1
    global_load_lds_dwordx4 v15, s[10:11] offset:1024 sc1
    global_load_lds_dwordx4 v15, s[10:11] offset:2048 sc1
    s_add_u32 m0, s48, 20672
    s_nop 0
    global_load_lds_dwordx4 v15, s[10:11] offset:3072 sc1
    global_load_dwordx4 v[84:87], v6, s[12:13] offset:512 sc1
    global_load_dwordx4 v[88:91], v6, s[12:13] offset:1536 sc1
    s_waitcnt vmcnt(0)
    ds_read2st64_b32 v[92:93], v9 offset0:0 offset1:4
    ds_read2st64_b32 v[94:95], v9 offset0:8 offset1:12
    ds_read2st64_b32 v[96:97], v9 offset0:16 offset1:20
    ds_read_b32 v98, v9 offset:6144
    ds_read_b32 v99, v4 offset:23744
    v_add_f32 v84, v84, v86
    v_add_f32 v85, v85, v87
    v_add_f32 v88, v88, v90
    v_add_f32 v89, v89, v91
    v_add_f32 v84, v84, v88
    v_add_f32 v85, v85, v89
    s_waitcnt lgkmcnt(0)
    v_max_u32 v100, v92, v93
    v_max3_u32 v100, v100, v94, v95
    v_max3_u32 v100, v100, v96, v97
    v_max3_u32 v100, v100, v98, v99
    v_cmp_eq_u32 vcc, -1, v100
    v_cmp_u_f32 s[56:57], v84, v85
    s_or_b64 vcc, vcc, s[56:57]
    s_cbranch_vccz adaLN_cond__grouped_kv_mqa__dense_activation_silu__prompt_kernel_ok139
    s_add_u32 s96, s96, 1
    s_cmp_lt_u32 s96, 131072
    s_cbranch_scc1 adaLN_cond__grouped_kv_mqa__dense_activation_silu__prompt_kernel_lp137
adaLN_cond__grouped_kv_mqa__dense_activation_silu__prompt_kernel_ok139:
    v_permlane32_swap_b32 v84, v85
    v_add_f32 v84, v84, v85
    ds_write_b32 v7, v84 offset:23216
    s_waitcnt lgkmcnt(0)
    s_branch adaLN_cond__grouped_kv_mqa__dense_activation_silu__prompt_kernel_bk138
adaLN_cond__grouped_kv_mqa__dense_activation_silu__prompt_kernel_st140:
    global_load_dwordx4 a[16:19], v110, s[18:19] offset:-4096 sc1
    global_load_dwordx4 a[144:147], v110, s[18:19] offset:0 sc1
    global_load_dwordx4 a[20:23], v111, s[18:19] offset:-4096 sc1
    global_load_dwordx4 a[148:151], v111, s[18:19] offset:0 sc1
    s_waitcnt vmcnt(0)
    v_accvgpr_read_b32 v64, a16
    v_accvgpr_read_b32 v65, a144
    v_accvgpr_read_b32 v66, a20
    v_accvgpr_read_b32 v67, a148
    v_max_u32 v64, v64, v65
    v_max3_u32 v64, v64, v66, v67
    v_cmp_eq_u32 vcc, -1, v64
    s_cbranch_vccz adaLN_cond__grouped_kv_mqa__dense_activation_silu__prompt_kernel_ok142
    s_add_u32 s96, s96, 1
    s_cmp_lt_u32 s96, 131072
    s_cbranch_scc1 adaLN_cond__grouped_kv_mqa__dense_activation_silu__prompt_kernel_st140
adaLN_cond__grouped_kv_mqa__dense_activation_silu__prompt_kernel_ok142:
    s_branch adaLN_cond__grouped_kv_mqa__dense_activation_silu__prompt_kernel_bk141
adaLN_cond__grouped_kv_mqa__dense_activation_silu__prompt_kernel_st143:
    global_load_dwordx4 a[24:27], v111, s[18:19] offset:2048 sc1
    global_load_dwordx4 a[152:155], v52, s[18:19] offset:-2048 sc1
    global_load_dwordx4 a[28:31], v52, s[18:19] offset:2048 sc1
    global_load_dwordx4 a[156:159], v51, s[18:19] offset:-2048 sc1
    s_waitcnt vmcnt(0)
    v_accvgpr_read_b32 v64, a24
    v_accvgpr_read_b32 v65, a152
    v_accvgpr_read_b32 v66, a28
    v_accvgpr_read_b32 v67, a156
    v_max_u32 v64, v64, v65
    v_max3_u32 v64, v64, v66, v67
    v_cmp_eq_u32 vcc, -1, v64
    s_cbranch_vccz adaLN_cond__grouped_kv_mqa__dense_activation_silu__prompt_kernel_ok145
    s_add_u32 s96, s96, 1
    s_cmp_lt_u32 s96, 131072
    s_cbranch_scc1 adaLN_cond__grouped_kv_mqa__dense_activation_silu__prompt_kernel_st143
adaLN_cond__grouped_kv_mqa__dense_activation_silu__prompt_kernel_ok145:
    s_branch adaLN_cond__grouped_kv_mqa__dense_activation_silu__prompt_kernel_bk144
adaLN_cond__grouped_kv_mqa__dense_activation_silu__prompt_kernel_st146:
    global_load_dwordx4 a[32:35], v110, s[18:19] offset:-3072 sc1
    global_load_dwordx4 a[160:163], v110, s[18:19] offset:1024 sc1
    global_load_dwordx4 a[36:39], v111, s[18:19] offset:-3072 sc1
    global_load_dwordx4 a[164:167], v111, s[18:19] offset:1024 sc1
    global_load_dwordx4 a[40:43], v111, s[18:19] offset:3072 sc1
    global_load_dwordx4 a[168:171], v52, s[18:19] offset:-1024 sc1
    global_load_dwordx4 a[44:47], v52, s[18:19] offset:3072 sc1
    global_load_dwordx4 a[172:175], v51, s[18:19] offset:-1024 sc1
    s_waitcnt vmcnt(0)
    v_accvgpr_read_b32 v64, a32
    v_accvgpr_read_b32 v65, a160
    v_accvgpr_read_b32 v66, a36
    v_accvgpr_read_b32 v67, a164
    v_accvgpr_read_b32 v68, a40
    v_accvgpr_read_b32 v69, a168
    v_accvgpr_read_b32 v70, a44
    v_accvgpr_read_b32 v71, a172
    v_max_u32 v64, v64, v65
    v_max3_u32 v64, v64, v66, v67
    v_max3_u32 v64, v64, v68, v69
    v_max3_u32 v64, v64, v70, v71
    v_cmp_eq_u32 vcc, -1, v64
    s_cbranch_vccz adaLN_cond__grouped_kv_mqa__dense_activation_silu__prompt_kernel_ok148
    s_add_u32 s96, s96, 1
    s_cmp_lt_u32 s96, 131072
    s_cbranch_scc1 adaLN_cond__grouped_kv_mqa__dense_activation_silu__prompt_kernel_st146
adaLN_cond__grouped_kv_mqa__dense_activation_silu__prompt_kernel_ok148:
    s_branch adaLN_cond__grouped_kv_mqa__dense_activation_silu__prompt_kernel_bk147
adaLN_cond__grouped_kv_mqa__dense_activation_silu__prompt_kernel_st149:
    global_load_dwordx4 a[48:51], v110, s[18:19] offset:-2048 sc1
    global_load_dwordx4 a[176:179], v110, s[18:19] offset:2048 sc1
    global_load_dwordx4 a[52:55], v111, s[18:19] offset:-2048 sc1
    global_load_dwordx4 a[180:183], v52, s[18:19] offset:-4096 sc1
    global_load_dwordx4 a[56:59], v52, s[18:19] offset:0 sc1
    global_load_dwordx4 a[184:187], v51, s[18:19] offset:-4096 sc1
    s_waitcnt vmcnt(0)
    v_accvgpr_read_b32 v64, a48
    v_accvgpr_read_b32 v65, a176
    v_accvgpr_read_b32 v66, a52
    v_accvgpr_read_b32 v67, a180
    v_accvgpr_read_b32 v68, a56
    v_accvgpr_read_b32 v69, a184
    v_max_u32 v64, v64, v65
    v_max3_u32 v64, v64, v66, v67
    v_max3_u32 v64, v64, v68, v69
    v_cmp_eq_u32 vcc, -1, v64
    s_cbranch_vccz adaLN_cond__grouped_kv_mqa__dense_activation_silu__prompt_kernel_ok151
    s_add_u32 s96, s96, 1
    s_cmp_lt_u32 s96, 131072
    s_cbranch_scc1 adaLN_cond__grouped_kv_mqa__dense_activation_silu__prompt_kernel_st149
adaLN_cond__grouped_kv_mqa__dense_activation_silu__prompt_kernel_ok151:
    s_branch adaLN_cond__grouped_kv_mqa__dense_activation_silu__prompt_kernel_bk150
adaLN_cond__grouped_kv_mqa__dense_activation_silu__prompt_kernel_st152:
    global_load_dwordx4 a[60:63], v110, s[18:19] offset:-1024 sc1
    global_load_dwordx4 a[188:191], v110, s[18:19] offset:3072 sc1
    global_load_dwordx4 a[64:67], v111, s[18:19] offset:-1024 sc1
    global_load_dwordx4 a[192:195], v52, s[18:19] offset:-3072 sc1
    global_load_dwordx4 a[68:71], v52, s[18:19] offset:1024 sc1
    global_load_dwordx4 a[196:199], v51, s[18:19] offset:-3072 sc1
    s_waitcnt vmcnt(0)
    v_accvgpr_read_b32 v64, a60
    v_accvgpr_read_b32 v65, a188
    v_accvgpr_read_b32 v66, a64
    v_accvgpr_read_b32 v67, a192
    v_accvgpr_read_b32 v68, a68
    v_accvgpr_read_b32 v69, a196
    v_max_u32 v64, v64, v65
    v_max3_u32 v64, v64, v66, v67
    v_max3_u32 v64, v64, v68, v69
    v_cmp_eq_u32 vcc, -1, v64
    s_cbranch_vccz adaLN_cond__grouped_kv_mqa__dense_activation_silu__prompt_kernel_ok154
    s_add_u32 s96, s96, 1
    s_cmp_lt_u32 s96, 131072
    s_cbranch_scc1 adaLN_cond__grouped_kv_mqa__dense_activation_silu__prompt_kernel_st152
adaLN_cond__grouped_kv_mqa__dense_activation_silu__prompt_kernel_ok154:
    s_branch adaLN_cond__grouped_kv_mqa__dense_activation_silu__prompt_kernel_bk153
adaLN_cond__grouped_kv_mqa__dense_activation_silu__prompt_kernel_st155:
    global_load_dwordx4 a[72:75], v110, s[20:21] offset:-4096 sc1
    global_load_dwordx4 a[200:203], v110, s[20:21] offset:0 sc1
    global_load_dwordx4 a[76:79], v111, s[20:21] offset:-4096 sc1
    global_load_dwordx4 a[204:207], v111, s[20:21] offset:0 sc1
    s_waitcnt vmcnt(0)
    v_accvgpr_read_b32 v64, a72
    v_accvgpr_read_b32 v65, a200
    v_accvgpr_read_b32 v66, a76
    v_accvgpr_read_b32 v67, a204
    v_max_u32 v64, v64, v65
    v_max3_u32 v64, v64, v66, v67
    v_cmp_eq_u32 vcc, -1, v64
    s_cbranch_vccz adaLN_cond__grouped_kv_mqa__dense_activation_silu__prompt_kernel_ok157
    s_add_u32 s96, s96, 1
    s_cmp_lt_u32 s96, 131072
    s_cbranch_scc1 adaLN_cond__grouped_kv_mqa__dense_activation_silu__prompt_kernel_st155
adaLN_cond__grouped_kv_mqa__dense_activation_silu__prompt_kernel_ok157:
    s_branch adaLN_cond__grouped_kv_mqa__dense_activation_silu__prompt_kernel_bk156
adaLN_cond__grouped_kv_mqa__dense_activation_silu__prompt_kernel_st158:
    global_load_dwordx4 a[80:83], v111, s[20:21] offset:2048 sc1
    global_load_dwordx4 a[208:211], v52, s[20:21] offset:-2048 sc1
    global_load_dwordx4 a[84:87], v52, s[20:21] offset:2048 sc1
    global_load_dwordx4 a[212:215], v51, s[20:21] offset:-2048 sc1
    s_waitcnt vmcnt(0)
    v_accvgpr_read_b32 v112, a80
    v_accvgpr_read_b32 v113, a208
    v_accvgpr_read_b32 v114, a84
    v_accvgpr_read_b32 v115, a212
    v_max_u32 v112, v112, v113
    v_max3_u32 v112, v112, v114, v115
    v_cmp_eq_u32 vcc, -1, v112
    s_cbranch_vccz adaLN_cond__grouped_kv_mqa__dense_activation_silu__prompt_kernel_ok160
    s_add_u32 s96, s96, 1
    s_cmp_lt_u32 s96, 131072
    s_cbranch_scc1 adaLN_cond__grouped_kv_mqa__dense_activation_silu__prompt_kernel_st158
adaLN_cond__grouped_kv_mqa__dense_activation_silu__prompt_kernel_ok160:
    s_branch adaLN_cond__grouped_kv_mqa__dense_activation_silu__prompt_kernel_bk159
adaLN_cond__grouped_kv_mqa__dense_activation_silu__prompt_kernel_st161:
    global_load_dwordx4 a[88:91], v110, s[20:21] offset:-3072 sc1
    global_load_dwordx4 a[216:219], v110, s[20:21] offset:1024 sc1
    global_load_dwordx4 a[92:95], v111, s[20:21] offset:-3072 sc1
    global_load_dwordx4 a[220:223], v111, s[20:21] offset:1024 sc1
    global_load_dwordx4 a[96:99], v111, s[20:21] offset:3072 sc1
    global_load_dwordx4 a[224:227], v52, s[20:21] offset:-1024 sc1
    global_load_dwordx4 a[100:103], v52, s[20:21] offset:3072 sc1
    global_load_dwordx4 a[228:231], v51, s[20:21] offset:-1024 sc1
    s_waitcnt vmcnt(0)
    v_accvgpr_read_b32 v112, a88
    v_accvgpr_read_b32 v113, a216
    v_accvgpr_read_b32 v114, a92
    v_accvgpr_read_b32 v115, a220
    v_accvgpr_read_b32 v116, a96
    v_accvgpr_read_b32 v117, a224
    v_accvgpr_read_b32 v118, a100
    v_accvgpr_read_b32 v119, a228
    v_max_u32 v112, v112, v113
    v_max3_u32 v112, v112, v114, v115
    v_max3_u32 v112, v112, v116, v117
    v_max3_u32 v112, v112, v118, v119
    v_cmp_eq_u32 vcc, -1, v112
    s_cbranch_vccz adaLN_cond__grouped_kv_mqa__dense_activation_silu__prompt_kernel_ok163
    s_add_u32 s96, s96, 1
    s_cmp_lt_u32 s96, 131072
    s_cbranch_scc1 adaLN_cond__grouped_kv_mqa__dense_activation_silu__prompt_kernel_st161
adaLN_cond__grouped_kv_mqa__dense_activation_silu__prompt_kernel_ok163:
    s_branch adaLN_cond__grouped_kv_mqa__dense_activation_silu__prompt_kernel_bk162
adaLN_cond__grouped_kv_mqa__dense_activation_silu__prompt_kernel_st164:
    global_load_dwordx4 a[104:107], v110, s[20:21] offset:-2048 sc1
    global_load_dwordx4 a[232:235], v110, s[20:21] offset:2048 sc1
    global_load_dwordx4 a[108:111], v111, s[20:21] offset:-2048 sc1
    global_load_dwordx4 a[236:239], v52, s[20:21] offset:-4096 sc1
    global_load_dwordx4 a[112:115], v52, s[20:21] offset:0 sc1
    global_load_dwordx4 a[240:243], v51, s[20:21] offset:-4096 sc1
    s_waitcnt vmcnt(0)
    v_accvgpr_read_b32 v112, a104
    v_accvgpr_read_b32 v113, a232
    v_accvgpr_read_b32 v114, a108
    v_accvgpr_read_b32 v115, a236
    v_accvgpr_read_b32 v116, a112
    v_accvgpr_read_b32 v117, a240
    v_max_u32 v112, v112, v113
    v_max3_u32 v112, v112, v114, v115
    v_max3_u32 v112, v112, v116, v117
    v_cmp_eq_u32 vcc, -1, v112
    s_cbranch_vccz adaLN_cond__grouped_kv_mqa__dense_activation_silu__prompt_kernel_ok166
    s_add_u32 s96, s96, 1
    s_cmp_lt_u32 s96, 131072
    s_cbranch_scc1 adaLN_cond__grouped_kv_mqa__dense_activation_silu__prompt_kernel_st164
adaLN_cond__grouped_kv_mqa__dense_activation_silu__prompt_kernel_ok166:
    s_branch adaLN_cond__grouped_kv_mqa__dense_activation_silu__prompt_kernel_bk165
adaLN_cond__grouped_kv_mqa__dense_activation_silu__prompt_kernel_st167:
    global_load_dwordx4 a[116:119], v110, s[20:21] offset:-1024 sc1
    global_load_dwordx4 a[244:247], v110, s[20:21] offset:3072 sc1
    global_load_dwordx4 a[120:123], v111, s[20:21] offset:-1024 sc1
    global_load_dwordx4 a[248:251], v52, s[20:21] offset:-3072 sc1
    global_load_dwordx4 a[124:127], v52, s[20:21] offset:1024 sc1
    global_load_dwordx4 a[252:255], v51, s[20:21] offset:-3072 sc1
    s_waitcnt vmcnt(0)
    v_accvgpr_read_b32 v112, a116
    v_accvgpr_read_b32 v113, a244
    v_accvgpr_read_b32 v114, a120
    v_accvgpr_read_b32 v115, a248
    v_accvgpr_read_b32 v116, a124
    v_accvgpr_read_b32 v117, a252
    v_max_u32 v112, v112, v113
    v_max3_u32 v112, v112, v114, v115
    v_max3_u32 v112, v112, v116, v117
    v_cmp_eq_u32 vcc, -1, v112
    s_cbranch_vccz adaLN_cond__grouped_kv_mqa__dense_activation_silu__prompt_kernel_ok169
    s_add_u32 s96, s96, 1
    s_cmp_lt_u32 s96, 131072
    s_cbranch_scc1 adaLN_cond__grouped_kv_mqa__dense_activation_silu__prompt_kernel_st167
adaLN_cond__grouped_kv_mqa__dense_activation_silu__prompt_kernel_ok169:
    s_branch adaLN_cond__grouped_kv_mqa__dense_activation_silu__prompt_kernel_bk168
LPCEND:
adaLN_cond__grouped_kv_mqa__dense_activation_silu__prompt_kernel_slow123:
    s_nop 15
    s_nop 15
    s_waitcnt vmcnt(0) lgkmcnt(0)
    s_barrier
    v_mov_b32 v5, v14
    v_add_u32 v6, 0x8000, v14
    v_add_u32 v0, s36, v3
    s_or_b32 s97, s97, 4
    global_load_dwordx4 v[16:19], v5, s[4:5]
    global_load_dwordx4 v[20:23], v6, s[4:5]
    s_add_u32 m0, s48, 0
    s_nop 0
    global_load_lds_dwordx4 v0, s[28:29] offset:0
    global_load_lds_dwordx4 v0, s[28:29] offset:1024
    global_load_lds_dwordx4 v0, s[28:29] offset:2048
    global_load_lds_dwordx4 v0, s[28:29] offset:3072
    v_add_u32 v0, 0x1000, v0
    s_add_u32 m0, s48, 4096
    s_nop 0
    global_load_lds_dwordx4 v0, s[28:29] offset:0
    global_load_lds_dwordx4 v0, s[28:29] offset:1024
    global_load_lds_dwordx4 v0, s[28:29] offset:2048
    global_load_lds_dwordx4 v0, s[28:29] offset:3072
    v_add_u32 v0, 0x1000, v0
    s_add_u32 m0, s48, 8192
    s_nop 0
    global_load_lds_dwordx4 v0, s[28:29] offset:0
    global_load_lds_dwordx4 v0, s[28:29] offset:1024
    global_load_lds_dwordx4 v0, s[28:29] offset:2048
    global_load_lds_dwordx4 v0, s[28:29] offset:3072
    v_add_u32 v0, 0x1000, v0
    s_add_u32 m0, s48, 12288
    s_nop 0
    global_load_lds_dwordx4 v0, s[28:29] offset:0
    global_load_lds_dwordx4 v0, s[28:29] offset:1024
    global_load_lds_dwordx4 v0, s[28:29] offset:2048
    global_load_lds_dwordx4 v0, s[28:29] offset:3072
    v_add_u32 v0, 0x1000, v0
    s_add_u32 m0, s48, 16384
    s_nop 0
    global_load_lds_dwordx4 v0, s[28:29] offset:0
    global_load_lds_dwordx4 v0, s[28:29] offset:1024
    global_load_lds_dwordx4 v0, s[28:29] offset:2048
    global_load_lds_dwordx4 v0, s[28:29] offset:3072
    v_add_u32 v0, 0x1000, v0
    s_add_u32 m0, s48, 20480
    s_nop 0
    global_load_lds_dwordx4 v0, s[28:29] offset:0
    global_load_lds_dwordx4 v0, s[28:29] offset:1024
    v_add_f32 v88, v88, v96
    v_add_f32 v89, v89, v97
    v_add_f32 v90, v90, v98
    v_add_f32 v91, v91, v99
    v_add_f32 v92, v92, v100
    v_add_f32 v93, v93, v101
    v_mfma_f32_32x32x16_bf16 v[120:135], v[160:163], v[224:227], 0
    v_add_f32 v94, v94, v102
    v_add_f32 v95, v95, v103
    v_add_f32 v112, v112, v114
    v_add_f32 v88, v88, v104
    v_add_f32 v89, v89, v105
    v_add_f32 v90, v90, v106
    v_add_f32 v91, v91, v107
    v_add_f32 v92, v92, v108
    v_add_f32 v93, v93, v109
    v_add_f32 v94, v94, v110
    v_mfma_f32_32x32x16_bf16 v[136:151], v[192:195], v[224:227], 0
    v_add_f32 v95, v95, v111
    v_add_f32 v112, v112, v72
    v_rcp_f32 v113, v112
    v_subrev_u32 v114, 0x21800000, v112
    v_add_f32 v88, v88, v80
    v_add_f32 v89, v89, v81
    v_add_f32 v90, v90, v82
    v_add_f32 v91, v91, v83
    v_add_f32 v92, v92, v84
    v_mfma_f32_32x32x16_bf16 v[120:135], v[164:167], v[228:231], v[120:135]
    v_add_f32 v93, v93, v85
    v_add_f32 v94, v94, v86
    v_add_f32 v95, v95, v87
    v_cmp_lt_u32 vcc, 0x3c000000, v114
    v_mul_f32 v88, v88, v113
    v_mul_f32 v89, v89, v113
    v_mul_f32 v90, v90, v113
    v_mul_f32 v91, v91, v113
    v_mul_f32 v92, v92, v113
    v_mul_f32 v93, v93, v113
    v_mfma_f32_32x32x16_bf16 v[136:151], v[196:199], v[228:231], v[136:151]
    v_mul_f32 v94, v94, v113
    v_mul_f32 v95, v95, v113
    v_cvt_pk_bf16_f32 v116, v88, v89
    v_cvt_pk_bf16_f32 v117, v90, v91
    v_cvt_pk_bf16_f32 v118, v92, v93
    v_cvt_pk_bf16_f32 v119, v94, v95
    s_cbranch_vccnz adaLN_cond__grouped_kv_mqa__dense_activation_silu__prompt_kernel_obad170
    global_store_dwordx4 v13, v[116:119], s[6:7] sc1
adaLN_cond__grouped_kv_mqa__dense_activation_silu__prompt_kernel_obk171:
    v_add_u32 v49, s27, v2
    v_mfma_f32_32x32x16_bf16 v[120:135], v[168:171], v[232:235], v[120:135]
    v_add_u32 v50, s30, v2
    v_add_u32 v51, s31, v2
    v_lshrrev_b32 v24, 2, v1
    v_xor_b32 v24, v24, v1
    v_and_b32 v24, 4, v24
    v_cmp_eq_u32 s[54:55], 0, v24
    v_and_b32 v25, 1, v1
    v_lshrrev_b32 v26, 5, v1
    v_lshlrev_b32 v25, 8, v25
    v_lshl_add_u32 v25, v26, 4, v25
    v_mfma_f32_32x32x16_bf16 v[136:151], v[200:203], v[232:235], v[136:151]
    v_mov_b32 v27, 0x30000
    v_add_u32 v24, 33024, v25
    v_add_u32 v25, 100608, v25
    v_cndmask_b32 v47, v27, v24, s[54:55]
    v_cndmask_b32 v48, v27, v25, s[54:55]
    v_lshl_add_u32 v14, v26, 5, s48
    ds_read_b128 v[32:35], v14 offset:33536
    ds_read_b128 v[36:39], v14 offset:33552
    v_mfma_f32_32x32x16_bf16 v[120:135], v[172:175], v[236:239], v[120:135]
    ds_read_b128 v[108:111], v14 offset:33664
    ds_read_b128 v[112:115], v14 offset:33680
    v_and_b32 v40, 0x1f0, v2
    v_add_u32 v40, s43, v40
    v_mfma_f32_32x32x16_bf16 v[136:151], v[204:207], v[236:239], v[136:151]
    v_mfma_f32_32x32x16_bf16 v[120:135], v[176:179], v[240:243], v[120:135]
    v_mfma_f32_32x32x16_bf16 v[136:151], v[208:211], v[240:243], v[136:151]
    v_mfma_f32_32x32x16_bf16 v[120:135], v[180:183], v[244:247], v[120:135]
    v_mfma_f32_32x32x16_bf16 v[136:151], v[212:215], v[244:247], v[136:151]
    v_mfma_f32_32x32x16_bf16 v[120:135], v[184:187], v[248:251], v[120:135]
    v_mfma_f32_32x32x16_bf16 v[136:151], v[216:219], v[248:251], v[136:151]
    v_mfma_f32_32x32x16_bf16 v[120:135], v[188:191], v[252:255], v[120:135]
    v_mfma_f32_32x32x16_bf16 v[136:151], v[220:223], v[252:255], v[136:151]
    s_cmp_lg_u32 s97, 0
    s_cbranch_scc1 adaLN_cond__grouped_kv_mqa__dense_activation_silu__prompt_kernel_fix172
adaLN_cond__grouped_kv_mqa__dense_activation_silu__prompt_kernel_fixb173:
    ds_read_b128 v[52:55], v47 offset:0
    ds_read_b128 v[56:59], v47 offset:32
    ds_read_b128 v[60:63], v47 offset:64
    ds_read_b128 v[64:67], v47 offset:96
    ds_read_b128 v[68:71], v47 offset:128
    ds_read_b128 v[72:75], v47 offset:160
    s_nop 2
    ds_write_b128 v49, v[128:131] offset:24768
    s_waitcnt lgkmcnt(6)
    v_mfma_f32_16x16x32_bf16 v[76:79], v[52:55], a[0:3], 0
    s_waitcnt vmcnt(23)
    v_lshlrev_b32 v84, 16, v16
    v_mfma_f32_16x16x32_bf16 v[80:83], v[52:55], a[128:131], 0
    ds_read_b128 v[52:55], v47 offset:192
    v_and_b32 v85, 0xffff0000, v16
    ds_write_b128 v49, v[132:135] offset:25792
    s_waitcnt lgkmcnt(7)
    v_mfma_f32_16x16x32_bf16 v[76:79], v[56:59], a[4:7], v[76:79]
    v_lshlrev_b32 v86, 16, v17
    v_and_b32 v87, 0xffff0000, v17
    v_mfma_f32_16x16x32_bf16 v[80:83], v[56:59], a[132:135], v[80:83]
    ds_read_b128 v[56:59], v47 offset:224
    v_lshlrev_b32 v88, 16, v18
    ds_write_b128 v50, v[136:139] offset:26816
    s_waitcnt lgkmcnt(8)
    v_mfma_f32_16x16x32_bf16 v[76:79], v[60:63], a[8:11], v[76:79]
    v_and_b32 v89, 0xffff0000, v18
    v_lshlrev_b32 v90, 16, v19
    v_mfma_f32_16x16x32_bf16 v[80:83], v[60:63], a[136:139], v[80:83]
    ds_read_b128 v[60:63], v47 offset:33792
    v_and_b32 v91, 0xffff0000, v19
    ds_write_b128 v50, v[140:143] offset:27840
    s_waitcnt lgkmcnt(9)
    v_mfma_f32_16x16x32_bf16 v[76:79], v[64:67], a[12:15], v[76:79]
    v_mfma_f32_16x16x32_bf16 v[80:83], v[64:67], a[140:143], v[80:83]
    ds_read_b128 v[64:67], v47 offset:33824
    ds_write_b128 v51, v[144:147] offset:28864
    s_waitcnt lgkmcnt(10)
    v_mfma_f32_16x16x32_bf16 v[76:79], v[68:71], a[16:19], v[76:79]
    v_mfma_f32_16x16x32_bf16 v[80:83], v[68:71], a[144:147], v[80:83]
    ds_read_b128 v[68:71], v47 offset:33856
    ds_write_b128 v51, v[148:151] offset:29888
    s_waitcnt lgkmcnt(11)
    v_mfma_f32_16x16x32_bf16 v[76:79], v[72:75], a[20:23], v[76:79]
    v_mfma_f32_16x16x32_bf16 v[80:83], v[72:75], a[148:151], v[80:83]
    ds_read_b128 v[72:75], v47 offset:33888
    s_waitcnt lgkmcnt(0)
    s_barrier
    ds_read_b128 v[128:131], v4 offset:24768
    ds_read_b128 v[132:135], v4 offset:25792
    ds_read_b128 v[136:139], v4 offset:26816
    ds_read_b128 v[140:143], v4 offset:27840
    ds_read_b128 v[144:147], v4 offset:28864
    ds_read_b128 v[148:151], v4 offset:29888
    global_load_dwordx4 v[224:227], v15, s[6:7] offset:-4096 sc1
    global_load_dwordx4 v[228:231], v15, s[6:7] offset:-3072 sc1
    v_mfma_f32_16x16x32_bf16 v[76:79], v[52:55], a[24:27], v[76:79]
    v_mfma_f32_16x16x32_bf16 v[80:83], v[52:55], a[152:155], v[80:83]
    ds_read_b128 v[52:55], v47 offset:33920
    global_load_dwordx4 v[232:235], v15, s[6:7] offset:-2048 sc1
    global_load_dwordx4 v[236:239], v15, s[6:7] offset:-1024 sc1
    v_mfma_f32_16x16x32_bf16 v[76:79], v[56:59], a[28:31], v[76:79]
    v_mfma_f32_16x16x32_bf16 v[80:83], v[56:59], a[156:159], v[80:83]
    ds_read_b128 v[56:59], v47 offset:33952
    global_load_dwordx4 v[240:243], v15, s[6:7] offset:0 sc1
    global_load_dwordx4 v[244:247], v15, s[6:7] offset:1024 sc1
    v_mfma_f32_16x16x32_bf16 v[76:79], v[60:63], a[32:35], v[76:79]
    v_mfma_f32_16x16x32_bf16 v[80:83], v[60:63], a[160:163], v[80:83]
    ds_read_b128 v[60:63], v47 offset:33984
    global_load_dwordx4 v[248:251], v15, s[6:7] offset:2048 sc1
    global_load_dwordx4 v[252:255], v15, s[6:7] offset:3072 sc1
    v_mfma_f32_16x16x32_bf16 v[76:79], v[64:67], a[36:39], v[76:79]
    v_mfma_f32_16x16x32_bf16 v[80:83], v[64:67], a[164:167], v[80:83]
    ds_read_b128 v[64:67], v47 offset:34016
    s_waitcnt lgkmcnt(8)
    v_pk_add_f32 v[120:121], v[120:121], v[128:129]
    v_pk_add_f32 v[122:123], v[122:123], v[130:131]
    v_pk_add_f32 v[124:125], v[124:125], v[132:133]
    v_pk_add_f32 v[126:127], v[126:127], v[134:135]
    s_waitcnt lgkmcnt(6)
    v_pk_add_f32 v[120:121], v[120:121], v[136:137]
    v_pk_add_f32 v[122:123], v[122:123], v[138:139]
    v_pk_add_f32 v[124:125], v[124:125], v[140:141]
    v_pk_add_f32 v[126:127], v[126:127], v[142:143]
    s_waitcnt lgkmcnt(4)
    v_pk_add_f32 v[120:121], v[120:121], v[144:145]
    v_pk_add_f32 v[122:123], v[122:123], v[146:147]
    v_pk_add_f32 v[124:125], v[124:125], v[148:149]
    v_pk_add_f32 v[126:127], v[126:127], v[150:151]
    v_pk_fma_f32 v[120:121], v[120:121], v[32:33], v[84:85]
    v_pk_fma_f32 v[122:123], v[122:123], v[34:35], v[86:87]
    v_pk_fma_f32 v[124:125], v[124:125], v[36:37], v[88:89]
    v_pk_fma_f32 v[126:127], v[126:127], v[38:39], v[90:91]
    v_cvt_pk_bf16_f32 v16, v120, v121
    v_cvt_pk_bf16_f32 v17, v122, v123
    v_cvt_pk_bf16_f32 v18, v124, v125
    v_cvt_pk_bf16_f32 v19, v126, v127
    v_lshlrev_b32 v120, 16, v16
    v_and_b32 v121, 0xffff0000, v16
    v_lshlrev_b32 v122, 16, v17
    v_and_b32 v123, 0xffff0000, v17
    v_lshlrev_b32 v124, 16, v18
    v_and_b32 v125, 0xffff0000, v18
    v_lshlrev_b32 v126, 16, v19
    v_and_b32 v127, 0xffff0000, v19
    v_sub_f32 v120, v120, v7
    v_sub_f32 v121, v121, v7
    v_sub_f32 v122, v122, v7
    v_sub_f32 v123, v123, v7
    v_sub_f32 v124, v124, v7
    v_sub_f32 v125, v125, v7
    v_sub_f32 v126, v126, v7
    v_sub_f32 v127, v127, v7
    v_pk_mul_f32 v[128:129], v[120:121], v[108:109]
    v_pk_mul_f32 v[130:131], v[122:123], v[110:111]
    v_pk_mul_f32 v[132:133], v[124:125], v[112:113]
    v_pk_mul_f32 v[134:135], v[126:127], v[114:115]
    v_cvt_pk_bf16_f32 v136, v128, v129
    v_cvt_pk_bf16_f32 v137, v130, v131
    v_cvt_pk_bf16_f32 v138, v132, v133
    v_cvt_pk_bf16_f32 v139, v134, v135
    global_store_dwordx4 v13, v[136:139], s[8:9] sc1
    v_pk_mul_f32 v[140:141], v[120:121], v[120:121]
    v_pk_fma_f32 v[140:141], v[122:123], v[122:123], v[140:141]
    v_pk_fma_f32 v[140:141], v[124:125], v[124:125], v[140:141]
    v_pk_fma_f32 v[140:141], v[126:127], v[126:127], v[140:141]
    v_pk_add_f32 v[120:121], v[120:121], v[124:125]
    v_pk_add_f32 v[122:123], v[122:123], v[126:127]
    v_pk_add_f32 v[120:121], v[120:121], v[122:123]
    v_add_f32 v142, v120, v121
    v_add_f32 v143, v140, v141
    v_add_f32 v144, v120, v121
    v_add_f32 v145, v140, v141
    s_nop 0
    v_permlane32_swap_b32 v142, v144
    v_permlane32_swap_b32 v143, v145
    v_pk_add_f32 v[142:143], v[142:143], v[144:145]
    global_store_dwordx2 v40, v[142:143], s[12:13] offset:0 sc1
    s_waitcnt vmcnt(2)
    v_max_u32 v14, v224, v228
    v_max3_u32 v14, v14, v232, v236
    v_max3_u32 v14, v14, v240, v244
    v_max3_u32 v14, v14, v248, v252
    v_cmp_eq_u32 vcc, -1, v14
    s_cbranch_vccnz adaLN_cond__grouped_kv_mqa__dense_activation_silu__prompt_kernel_st174
adaLN_cond__grouped_kv_mqa__dense_activation_silu__prompt_kernel_bk175:
    v_mfma_f32_32x32x16_bf16 v[120:135], v[160:163], v[224:227], 0
    v_add_u32 v0, -4096, v15
    s_add_u32 s54, s37, 4096
    v_add_u32 v117, s54, v3
    v_and_b32 v14, 0x1f0, v2
    v_lshrrev_b32 v118, 5, v1
    v_lshl_add_u32 v14, v118, 11, v14
    v_mfma_f32_32x32x16_bf16 v[136:151], v[192:195], v[224:227], 0
    s_lshl_b32 s54, s44, 12
    v_add_u32 v14, s54, v14
    v_lshlrev_b32 v92, 16, v20
    v_and_b32 v93, 0xffff0000, v20
    v_lshlrev_b32 v94, 16, v21
    v_and_b32 v95, 0xffff0000, v21
    v_mfma_f32_32x32x16_bf16 v[120:135], v[164:167], v[228:231], v[120:135]
    global_load_dwordx4 v[152:155], v117, s[28:29] offset:-4096
    v_lshlrev_b32 v96, 16, v22
    v_and_b32 v97, 0xffff0000, v22
    v_lshlrev_b32 v98, 16, v23
    v_and_b32 v99, 0xffff0000, v23
    v_add_u32 v116, 24768, v4
    v_mfma_f32_32x32x16_bf16 v[136:151], v[196:199], v[228:231], v[136:151]
    v_and_b32 v7, 31, v1
    v_lshlrev_b32 v7, 3, v7
    v_add_u32 v7, 22704, v7
    v_lshl_add_u32 v118, v118, 2, v7
    v_add_u32 v118, s48, v118
    s_mov_b32 s62, 0
    v_mfma_f32_32x32x16_bf16 v[120:135], v[168:171], v[232:235], v[120:135]
    global_load_dwordx4 v[156:159], v117, s[28:29] offset:-3072
    s_mov_b32 s63, -1
    s_mov_b32 s55, 0x07060706
    v_mov_b32 v26, 0
    v_mov_b32 v27, 0
    v_mov_b32 v30, 0
    v_mfma_f32_32x32x16_bf16 v[136:151], v[200:203], v[232:235], v[136:151]
    v_mov_b32 v31, 0
    v_mfma_f32_32x32x16_bf16 v[120:135], v[172:175], v[236:239], v[120:135]
    global_load_dwordx4 v[160:163], v117, s[28:29] offset:-2048
    v_mfma_f32_32x32x16_bf16 v[136:151], v[204:207], v[236:239], v[136:151]
    v_mfma_f32_32x32x16_bf16 v[120:135], v[176:179], v[240:243], v[120:135]
    global_load_dwordx4 v[164:167], v117, s[28:29] offset:-1024
    v_mfma_f32_32x32x16_bf16 v[136:151], v[208:211], v[240:243], v[136:151]
    v_mfma_f32_32x32x16_bf16 v[120:135], v[180:183], v[244:247], v[120:135]
    global_load_dwordx4 v[168:171], v117, s[28:29] offset:0
    v_mfma_f32_32x32x16_bf16 v[136:151], v[212:215], v[244:247], v[136:151]
    v_mfma_f32_32x32x16_bf16 v[120:135], v[184:187], v[248:251], v[120:135]
    global_load_dwordx4 v[172:175], v117, s[28:29] offset:1024
    v_mfma_f32_32x32x16_bf16 v[136:151], v[216:219], v[248:251], v[136:151]
    v_mfma_f32_32x32x16_bf16 v[120:135], v[188:191], v[252:255], v[120:135]
    v_mfma_f32_32x32x16_bf16 v[136:151], v[220:223], v[252:255], v[136:151]
    s_nop 10
    ds_write_b128 v10, v[128:131] offset:0
    s_add_u32 m0, s48, 24768
    s_nop 0
    global_load_lds_dwordx4 v0, s[8:9] offset:0 sc1
    v_mfma_f32_16x16x32_bf16 v[76:79], v[68:71], a[40:43], v[76:79]
    v_mfma_f32_16x16x32_bf16 v[80:83], v[68:71], a[168:171], v[80:83]
    ds_read_b128 v[68:71], v48 offset:0
    ds_write_b128 v10, v[132:135] offset:1024
    global_load_lds_dwordx4 v0, s[8:9] offset:1024 sc1
    v_mfma_f32_16x16x32_bf16 v[76:79], v[72:75], a[44:47], v[76:79]
    v_mfma_f32_16x16x32_bf16 v[80:83], v[72:75], a[172:175], v[80:83]
    ds_read_b128 v[72:75], v48 offset:32
    ds_write_b128 v11, v[136:139] offset:2048
    global_load_lds_dwordx4 v0, s[8:9] offset:2048 sc1
    s_waitcnt lgkmcnt(8)
    v_mfma_f32_16x16x32_bf16 v[76:79], v[52:55], a[48:51], v[76:79]
    v_mfma_f32_16x16x32_bf16 v[80:83], v[52:55], a[176:179], v[80:83]
    ds_read_b128 v[52:55], v48 offset:64
    ds_write_b128 v11, v[140:143] offset:3072
    global_load_lds_dwordx4 v0, s[8:9] offset:3072 sc1
    s_add_u32 m0, m0, 4096
    s_waitcnt lgkmcnt(9)
    v_mfma_f32_16x16x32_bf16 v[76:79], v[56:59], a[52:55], v[76:79]
    v_mfma_f32_16x16x32_bf16 v[80:83], v[56:59], a[180:183], v[80:83]
    ds_read_b128 v[56:59], v48 offset:96
    ds_write_b128 v12, v[144:147] offset:4096
    global_load_lds_dwordx4 v15, s[8:9] offset:0 sc1
    s_waitcnt lgkmcnt(10)
    v_mfma_f32_16x16x32_bf16 v[76:79], v[60:63], a[56:59], v[76:79]
    v_mfma_f32_16x16x32_bf16 v[80:83], v[60:63], a[184:187], v[80:83]
    ds_read_b128 v[60:63], v48 offset:128
    ds_write_b128 v12, v[148:151] offset:5120
    global_load_lds_dwordx4 v15, s[8:9] offset:1024 sc1
    s_waitcnt lgkmcnt(11)
    v_mfma_f32_16x16x32_bf16 v[76:79], v[64:67], a[60:63], v[76:79]
    v_mfma_f32_16x16x32_bf16 v[80:83], v[64:67], a[188:191], v[80:83]
    ds_read_b128 v[64:67], v48 offset:160
    s_waitcnt lgkmcnt(0)
    s_barrier
    ds_read_b128 v[128:131], v9 offset:0
    ds_read_b128 v[132:135], v9 offset:1024
    ds_read_b128 v[136:139], v9 offset:2048
    ds_read_b128 v[140:143], v9 offset:3072
    ds_read_b128 v[144:147], v9 offset:4096
    ds_read_b128 v[148:151], v9 offset:5120
    global_load_lds_dwordx4 v15, s[8:9] offset:2048 sc1
    v_mfma_f32_16x16x32_bf16 v[76:79], v[68:71], a[64:67], v[76:79]
    v_mfma_f32_16x16x32_bf16 v[80:83], v[68:71], a[192:195], v[80:83]
    ds_read_b128 v[68:71], v48 offset:192
    global_load_lds_dwordx4 v15, s[8:9] offset:3072 sc1
    v_mfma_f32_16x16x32_bf16 v[76:79], v[72:75], a[68:71], v[76:79]
    v_mfma_f32_16x16x32_bf16 v[80:83], v[72:75], a[196:199], v[80:83]
    ds_read_b128 v[72:75], v48 offset:224
    global_load_dwordx4 v[84:87], v14, s[12:13] offset:0 sc1
    v_mfma_f32_16x16x32_bf16 v[76:79], v[52:55], a[72:75], v[76:79]
    v_mfma_f32_16x16x32_bf16 v[80:83], v[52:55], a[200:203], v[80:83]
    ds_read_b128 v[52:55], v48 offset:33792
    global_load_dwordx4 v[88:91], v14, s[12:13] offset:1024 sc1
    v_mfma_f32_16x16x32_bf16 v[76:79], v[56:59], a[76:79], v[76:79]
    v_mfma_f32_16x16x32_bf16 v[80:83], v[56:59], a[204:207], v[80:83]
    ds_read_b128 v[56:59], v48 offset:33824
    v_mfma_f32_16x16x32_bf16 v[76:79], v[60:63], a[80:83], v[76:79]
    v_mfma_f32_16x16x32_bf16 v[80:83], v[60:63], a[208:211], v[80:83]
    ds_read_b128 v[60:63], v48 offset:33856
    v_mfma_f32_16x16x32_bf16 v[76:79], v[64:67], a[84:87], v[76:79]
    v_mfma_f32_16x16x32_bf16 v[80:83], v[64:67], a[212:215], v[80:83]
    ds_read_b128 v[64:67], v48 offset:33888
    s_waitcnt lgkmcnt(5)
    v_mfma_f32_16x16x32_bf16 v[76:79], v[68:71], a[88:91], v[76:79]
    v_mfma_f32_16x16x32_bf16 v[80:83], v[68:71], a[216:219], v[80:83]
    ds_read_b128 v[68:71], v48 offset:33920
    v_pk_add_f32 v[120:121], v[120:121], v[128:129]
    v_pk_add_f32 v[122:123], v[122:123], v[130:131]
    v_pk_add_f32 v[124:125], v[124:125], v[132:133]
    v_pk_add_f32 v[126:127], v[126:127], v[134:135]
    v_pk_add_f32 v[120:121], v[120:121], v[136:137]
    v_pk_add_f32 v[122:123], v[122:123], v[138:139]
    v_pk_add_f32 v[124:125], v[124:125], v[140:141]
    v_pk_add_f32 v[126:127], v[126:127], v[142:143]
    v_pk_add_f32 v[120:121], v[120:121], v[144:145]
    v_pk_add_f32 v[122:123], v[122:123], v[146:147]
    v_pk_add_f32 v[124:125], v[124:125], v[148:149]
    v_pk_add_f32 v[126:127], v[126:127], v[150:151]
    v_pk_fma_f32 v[120:121], v[120:121], v[32:33], v[92:93]
    v_pk_fma_f32 v[122:123], v[122:123], v[34:35], v[94:95]
    v_pk_fma_f32 v[124:125], v[124:125], v[36:37], v[96:97]
    v_pk_fma_f32 v[126:127], v[126:127], v[38:39], v[98:99]
    v_cvt_pk_bf16_f32 v20, v120, v121
    v_cvt_pk_bf16_f32 v21, v122, v123
    v_cvt_pk_bf16_f32 v22, v124, v125
    v_cvt_pk_bf16_f32 v23, v126, v127
    v_lshlrev_b32 v120, 16, v20
    v_and_b32 v121, 0xffff0000, v20
    v_lshlrev_b32 v122, 16, v21
    v_and_b32 v123, 0xffff0000, v21
    v_lshlrev_b32 v124, 16, v22
    v_and_b32 v125, 0xffff0000, v22
    v_lshlrev_b32 v126, 16, v23
    v_and_b32 v127, 0xffff0000, v23
    v_sub_f32 v120, v120, v8
    v_sub_f32 v121, v121, v8
    v_sub_f32 v122, v122, v8
    v_sub_f32 v123, v123, v8
    v_sub_f32 v124, v124, v8
    v_sub_f32 v125, v125, v8
    v_sub_f32 v126, v126, v8
    v_sub_f32 v127, v127, v8
    v_pk_mul_f32 v[128:129], v[120:121], v[108:109]
    v_pk_mul_f32 v[130:131], v[122:123], v[110:111]
    v_pk_mul_f32 v[132:133], v[124:125], v[112:113]
    v_pk_mul_f32 v[134:135], v[126:127], v[114:115]
    v_cvt_pk_bf16_f32 v136, v128, v129
    v_cvt_pk_bf16_f32 v137, v130, v131
    v_cvt_pk_bf16_f32 v138, v132, v133
    v_cvt_pk_bf16_f32 v139, v134, v135
    global_store_dwordx4 v13, v[136:139], s[10:11] sc1
    v_pk_mul_f32 v[140:141], v[120:121], v[120:121]
    v_pk_fma_f32 v[140:141], v[122:123], v[122:123], v[140:141]
    v_pk_fma_f32 v[140:141], v[124:125], v[124:125], v[140:141]
    v_pk_fma_f32 v[140:141], v[126:127], v[126:127], v[140:141]
    v_pk_add_f32 v[120:121], v[120:121], v[124:125]
    v_pk_add_f32 v[122:123], v[122:123], v[126:127]
    v_pk_add_f32 v[120:121], v[120:121], v[122:123]
    v_add_f32 v142, v120, v121
    v_add_f32 v143, v140, v141
    v_add_f32 v144, v120, v121
    v_add_f32 v145, v140, v141
    s_nop 0
    v_permlane32_swap_b32 v142, v144
    v_permlane32_swap_b32 v143, v145
    v_pk_add_f32 v[142:143], v[142:143], v[144:145]
    global_store_dwordx2 v40, v[142:143], s[12:13] offset:512 sc1
    s_waitcnt vmcnt(2)
    ds_read2st64_b32 v[92:93], v116 offset0:0 offset1:4
    ds_read2st64_b32 v[94:95], v116 offset0:8 offset1:12
    ds_read2st64_b32 v[96:97], v116 offset0:16 offset1:20
    ds_read2st64_b32 v[98:99], v116 offset0:24 offset1:28
    s_waitcnt lgkmcnt(9)
    v_mfma_f32_16x16x32_bf16 v[76:79], v[72:75], a[92:95], v[76:79]
    v_add_f32 v84, v84, v86
    v_add_f32 v85, v85, v87
    v_mfma_f32_16x16x32_bf16 v[80:83], v[72:75], a[220:223], v[80:83]
    ds_read_b128 v[72:75], v48 offset:33952
    v_add_f32 v88, v88, v90
    s_waitcnt lgkmcnt(9)
    v_mfma_f32_16x16x32_bf16 v[76:79], v[52:55], a[96:99], v[76:79]
    v_add_f32 v89, v89, v91
    v_add_f32 v84, v84, v88
    v_mfma_f32_16x16x32_bf16 v[80:83], v[52:55], a[224:227], v[80:83]
    ds_read_b128 v[52:55], v48 offset:33984
    v_add_f32 v85, v85, v89
    s_waitcnt lgkmcnt(9)
    v_mfma_f32_16x16x32_bf16 v[76:79], v[56:59], a[100:103], v[76:79]
    v_mfma_f32_16x16x32_bf16 v[80:83], v[56:59], a[228:231], v[80:83]
    ds_read_b128 v[56:59], v48 offset:34016
    s_waitcnt lgkmcnt(3)
    v_max_u32 v100, v92, v93
    v_max3_u32 v100, v100, v94, v95
    v_max3_u32 v100, v100, v96, v97
    v_max3_u32 v100, v100, v98, v99
    v_cmp_eq_u32 vcc, -1, v100
    v_cmp_u_f32 s[56:57], v84, v85
    s_or_b64 vcc, vcc, s[56:57]
    v_mfma_f32_16x16x32_bf16 v[76:79], v[60:63], a[104:107], v[76:79]
    v_permlane32_swap_b32 v84, v85
    v_add_f32 v84, v84, v85
    v_mfma_f32_16x16x32_bf16 v[80:83], v[60:63], a[232:235], v[80:83]
    ds_write_b32 v118, v84 offset:0
    v_mfma_f32_16x16x32_bf16 v[76:79], v[64:67], a[108:111], v[76:79]
    v_mfma_f32_16x16x32_bf16 v[80:83], v[64:67], a[236:239], v[80:83]
    v_mfma_f32_16x16x32_bf16 v[76:79], v[68:71], a[112:115], v[76:79]
    v_mfma_f32_16x16x32_bf16 v[80:83], v[68:71], a[240:243], v[80:83]
    s_waitcnt lgkmcnt(3)
    v_mfma_f32_16x16x32_bf16 v[76:79], v[72:75], a[116:119], v[76:79]
    v_mfma_f32_16x16x32_bf16 v[80:83], v[72:75], a[244:247], v[80:83]
    s_waitcnt lgkmcnt(2)
    v_mfma_f32_16x16x32_bf16 v[76:79], v[52:55], a[120:123], v[76:79]
    v_mfma_f32_16x16x32_bf16 v[80:83], v[52:55], a[248:251], v[80:83]
    s_waitcnt lgkmcnt(1)
    v_mfma_f32_16x16x32_bf16 v[76:79], v[56:59], a[124:127], v[76:79]
    v_mfma_f32_16x16x32_bf16 v[80:83], v[56:59], a[252:255], v[80:83]
    v_add_u32 v46, 23744, v2
    v_add_u32 v47, 91328, v2
    v_add_u32 v48, 135168, v2
    s_cbranch_vccnz adaLN_cond__grouped_kv_mqa__dense_activation_silu__prompt_kernel_st177
adaLN_cond__grouped_kv_mqa__dense_activation_silu__prompt_kernel_bk178:
    s_waitcnt lgkmcnt(0)
    s_barrier
    ds_read_b128 v[52:55], v46 offset:1024
    ds_read_b128 v[56:59], v46 offset:2048
    ds_read_b128 v[60:63], v46 offset:3072
    ds_read_b128 v[64:67], v46 offset:4096
    ds_read_b128 v[68:71], v46 offset:5120
    ds_read_b128 v[72:75], v46 offset:6144
    ds_read2st64_b64 v[140:143], v7 offset0:0 offset1:66
    ds_read2st64_b64 v[144:147], v7 offset0:132 offset1:198
    v_cndmask_b32 v76, v76, v77, s[62:63]
    v_and_b32 v77, 0xffff0000, v76
    v_perm_b32 v24, v76, v76, s55
    v_sub_f32 v76, v76, v77
    v_cvt_pk_bf16_f32 v25, v76, 0
    v_cndmask_b32 v80, v80, v81, s[62:63]
    v_and_b32 v81, 0xffff0000, v80
    v_perm_b32 v28, v80, v80, s55
    v_sub_f32 v80, v80, v81
    v_cvt_pk_bf16_f32 v29, v80, 0
    s_waitcnt lgkmcnt(7)
    v_mfma_f32_32x32x16_bf16 v[76:91], a[0:3], v[52:55], 0
    global_load_dwordx4 v[176:179], v117, s[28:29] offset:2048
    v_add_u32 v8, s38, v2
    v_add_u32 v13, s22, v8
    v_mov_b32 v34, 0
    v_mov_b32 v35, 0
    v_mfma_f32_32x32x16_bf16 v[92:107], a[128:131], v[52:55], 0
    ds_read_b128 v[52:55], v46 offset:7168
    v_mov_b32 v38, 0
    v_mov_b32 v39, 0
    s_waitcnt lgkmcnt(1)
    v_add_f32 v140, v140, v144
    v_add_f32 v141, v141, v145
    v_mfma_f32_32x32x16_bf16 v[76:91], a[4:7], v[56:59], v[76:91]
    global_load_dwordx4 v[180:183], v117, s[28:29] offset:3072
    v_add_u32 v117, 0x2000, v117
    v_add_f32 v142, v142, v146
    v_add_f32 v143, v143, v147
    v_add_f32 v140, v140, v142
    v_mfma_f32_32x32x16_bf16 v[92:107], a[132:135], v[56:59], v[92:107]
    ds_read_b128 v[56:59], v46 offset:8192
    v_add_f32 v141, v141, v143
    v_mul_f32 v140, 0xbb000000, v140
    v_mul_f32 v141, 0x3b000000, v141
    v_fma_f32 v141, -v140, v140, v141
    v_max_f32 v141, 0, v141
    v_mfma_f32_32x32x16_bf16 v[76:91], a[8:11], v[60:63], v[76:91]
    global_load_dwordx4 v[184:187], v117, s[28:29] offset:-4096
    v_add_f32 v141, 0x3727c5ac, v141
    v_rsq_f32 v142, v141
    v_mfma_f32_32x32x16_bf16 v[92:107], a[136:139], v[60:63], v[92:107]
    ds_read_b128 v[60:63], v46 offset:34816
    v_log_f32 v41, v141
    v_mul_f32 v42, v141, v142
    v_mul_f32 v40, 0xbfb8aa3b, v142
    v_mul_f32 v41, 0.5, v41
    v_mfma_f32_32x32x16_bf16 v[76:91], a[12:15], v[64:67], v[76:91]
    s_mov_b32 m0, s49
    s_nop 0
    global_load_lds_dwordx4 v0, s[10:11] offset:0 sc1
    v_cndmask_b32 v140, v140, v42, s[62:63]
    v_and_b32 v141, 0xffff0000, v140
    v_lshrrev_b32 v33, 16, v140
    v_mfma_f32_32x32x16_bf16 v[92:107], a[140:143], v[64:67], v[92:107]
    ds_read_b128 v[64:67], v46 offset:35840
    v_sub_f32 v140, v140, v141
    v_cvt_pk_bf16_f32 v32, v141, v140
    v_mfma_f32_32x32x16_bf16 v[76:91], a[16:19], v[68:71], v[76:91]
    global_load_lds_dwordx4 v0, s[10:11] offset:1024 sc1
    v_mfma_f32_32x32x16_bf16 v[92:107], a[144:147], v[68:71], v[92:107]
    ds_read_b128 v[68:71], v46 offset:36864
    v_mfma_f32_32x32x16_bf16 v[76:91], a[20:23], v[72:75], v[76:91]
    global_load_lds_dwordx4 v0, s[10:11] offset:2048 sc1
    v_mfma_f32_32x32x16_bf16 v[92:107], a[148:151], v[72:75], v[92:107]
    ds_read_b128 v[72:75], v46 offset:37888
    s_waitcnt lgkmcnt(5)
    v_mfma_f32_32x32x16_bf16 v[76:91], a[24:27], v[52:55], v[76:91]
    global_load_lds_dwordx4 v0, s[10:11] offset:3072 sc1
    s_add_u32 m0, m0, 4096
    v_mfma_f32_32x32x16_bf16 v[92:107], a[152:155], v[52:55], v[92:107]
    ds_read_b128 v[52:55], v46 offset:38912
    s_waitcnt lgkmcnt(5)
    v_mfma_f32_32x32x16_bf16 v[76:91], a[28:31], v[56:59], v[76:91]
    global_load_lds_dwordx4 v15, s[10:11] offset:0 sc1
    v_mfma_f32_32x32x16_bf16 v[92:107], a[156:159], v[56:59], v[92:107]
    ds_read_b128 v[56:59], v46 offset:39936
    s_waitcnt lgkmcnt(5)
    v_mfma_f32_32x32x16_bf16 v[76:91], a[32:35], v[60:63], v[76:91]
    global_load_lds_dwordx4 v15, s[10:11] offset:1024 sc1
    v_mfma_f32_32x32x16_bf16 v[92:107], a[160:163], v[60:63], v[92:107]
    ds_read_b128 v[60:63], v46 offset:40960
    s_waitcnt lgkmcnt(5)
    v_mfma_f32_32x32x16_bf16 v[76:91], a[36:39], v[64:67], v[76:91]
    global_load_lds_dwordx4 v15, s[10:11] offset:2048 sc1
    s_add_u32 m0, s48, 20672
    v_mfma_f32_32x32x16_bf16 v[92:107], a[164:167], v[64:67], v[92:107]
    ds_read_b128 v[64:67], v46 offset:41984
    s_waitcnt lgkmcnt(5)
    v_mfma_f32_32x32x16_bf16 v[76:91], a[40:43], v[68:71], v[76:91]
    global_load_lds_dwordx4 v15, s[10:11] offset:3072 sc1
    v_mfma_f32_32x32x16_bf16 v[92:107], a[168:171], v[68:71], v[92:107]
    ds_read_b128 v[68:71], v47 offset:1024
    s_waitcnt lgkmcnt(5)
    v_mfma_f32_32x32x16_bf16 v[76:91], a[44:47], v[72:75], v[76:91]
    global_load_dwordx4 v[108:111], v14, s[12:13] offset:512 sc1
    v_mfma_f32_32x32x16_bf16 v[92:107], a[172:175], v[72:75], v[92:107]
    ds_read_b128 v[72:75], v47 offset:2048
    s_waitcnt lgkmcnt(5)
    v_mfma_f32_32x32x16_bf16 v[76:91], a[48:51], v[52:55], v[76:91]
    global_load_dwordx4 v[112:115], v14, s[12:13] offset:1536 sc1
    v_mfma_f32_32x32x16_bf16 v[92:107], a[176:179], v[52:55], v[92:107]
    ds_read_b128 v[52:55], v47 offset:3072
    s_waitcnt lgkmcnt(5)
    v_mfma_f32_32x32x16_bf16 v[76:91], a[52:55], v[56:59], v[76:91]
    global_load_dwordx4 v[188:191], v117, s[28:29] offset:-3072
    v_mfma_f32_32x32x16_bf16 v[92:107], a[180:183], v[56:59], v[92:107]
    ds_read_b128 v[56:59], v47 offset:4096
    s_waitcnt lgkmcnt(5)
    v_mfma_f32_32x32x16_bf16 v[76:91], a[56:59], v[60:63], v[76:91]
    global_load_dwordx4 v[192:195], v117, s[28:29] offset:-2048
    v_mfma_f32_32x32x16_bf16 v[92:107], a[184:187], v[60:63], v[92:107]
    ds_read_b128 v[60:63], v47 offset:5120
    s_waitcnt lgkmcnt(5)
    v_mfma_f32_32x32x16_bf16 v[76:91], a[60:63], v[64:67], v[76:91]
    global_load_dwordx4 v[196:199], v117, s[28:29] offset:-1024
    v_mfma_f32_32x32x16_bf16 v[92:107], a[188:191], v[64:67], v[92:107]
    ds_read_b128 v[64:67], v47 offset:6144
    s_waitcnt lgkmcnt(5)
    v_mfma_f32_32x32x16_bf16 v[76:91], a[64:67], v[68:71], v[76:91]
    global_load_dwordx4 v[200:203], v117, s[28:29] offset:0
    v_mfma_f32_32x32x16_bf16 v[92:107], a[192:195], v[68:71], v[92:107]
    ds_read_b128 v[68:71], v47 offset:7168
    s_waitcnt lgkmcnt(5)
    v_mfma_f32_32x32x16_bf16 v[76:91], a[68:71], v[72:75], v[76:91]
    global_load_dwordx4 v[204:207], v117, s[28:29] offset:1024
    v_mfma_f32_32x32x16_bf16 v[92:107], a[196:199], v[72:75], v[92:107]
    ds_read_b128 v[72:75], v47 offset:8192
    s_waitcnt lgkmcnt(5)
    v_mfma_f32_32x32x16_bf16 v[76:91], a[72:75], v[52:55], v[76:91]
    global_load_dwordx4 v[208:211], v117, s[28:29] offset:2048
    v_mfma_f32_32x32x16_bf16 v[92:107], a[200:203], v[52:55], v[92:107]
    ds_read_b128 v[52:55], v47 offset:34816
    s_waitcnt lgkmcnt(5)
    v_mfma_f32_32x32x16_bf16 v[76:91], a[76:79], v[56:59], v[76:91]
    global_load_dwordx4 v[212:215], v117, s[28:29] offset:3072
    v_add_u32 v117, 0x2000, v117
    v_mfma_f32_32x32x16_bf16 v[92:107], a[204:207], v[56:59], v[92:107]
    ds_read_b128 v[56:59], v47 offset:35840
    s_waitcnt lgkmcnt(5)
    v_mfma_f32_32x32x16_bf16 v[76:91], a[80:83], v[60:63], v[76:91]
    global_load_dwordx4 v[216:219], v117, s[28:29] offset:-4096
    s_waitcnt vmcnt(8)
    ds_read2st64_b32 v[120:121], v9 offset0:0 offset1:4
    v_mfma_f32_32x32x16_bf16 v[92:107], a[208:211], v[60:63], v[92:107]
    ds_read_b128 v[60:63], v47 offset:36864
    ds_read2st64_b32 v[122:123], v9 offset0:8 offset1:12
    ds_read2st64_b32 v[124:125], v9 offset0:16 offset1:20
    s_waitcnt lgkmcnt(8)
    v_mfma_f32_32x32x16_bf16 v[76:91], a[84:87], v[64:67], v[76:91]
    global_load_dwordx4 v[220:223], v117, s[28:29] offset:-3072
    ds_read_b32 v126, v9 offset:6144
    ds_read_b32 v127, v4 offset:23744
    v_mfma_f32_32x32x16_bf16 v[92:107], a[212:215], v[64:67], v[92:107]
    ds_read_b128 v[64:67], v47 offset:37888
    v_add_f32 v108, v108, v110
    v_add_f32 v109, v109, v111
    v_add_f32 v112, v112, v114
    v_add_f32 v113, v113, v115
    v_add_f32 v108, v108, v112
    s_waitcnt lgkmcnt(10)
    v_mfma_f32_32x32x16_bf16 v[76:91], a[88:91], v[68:71], v[76:91]
    global_load_dwordx4 v[224:227], v117, s[28:29] offset:-2048
    v_add_f32 v109, v109, v113
    s_waitcnt lgkmcnt(1)
    v_max_u32 v128, v120, v121
    v_max3_u32 v128, v128, v122, v123
    v_mfma_f32_32x32x16_bf16 v[92:107], a[216:219], v[68:71], v[92:107]
    ds_read_b128 v[68:71], v47 offset:38912
    v_max3_u32 v128, v128, v124, v125
    v_max3_u32 v128, v128, v126, v127
    v_cmp_eq_u32 vcc, -1, v128
    v_cmp_u_f32 s[56:57], v108, v109
    s_or_b64 vcc, vcc, s[56:57]
    v_mfma_f32_32x32x16_bf16 v[76:91], a[92:95], v[72:75], v[76:91]
    global_load_dwordx4 v[228:231], v117, s[28:29] offset:-1024
    v_permlane32_swap_b32 v108, v109
    v_add_f32 v108, v108, v109
    ds_write_b32 v118, v108 offset:512
    v_mfma_f32_32x32x16_bf16 v[92:107], a[220:223], v[72:75], v[92:107]
    ds_read_b128 v[72:75], v47 offset:39936
    s_cbranch_vccnz adaLN_cond__grouped_kv_mqa__dense_activation_silu__prompt_kernel_st180
adaLN_cond__grouped_kv_mqa__dense_activation_silu__prompt_kernel_bk181:
    v_mfma_f32_32x32x16_bf16 v[76:91], a[96:99], v[52:55], v[76:91]
    global_load_dwordx4 v[232:235], v117, s[28:29] offset:0
    v_mfma_f32_32x32x16_bf16 v[92:107], a[224:227], v[52:55], v[92:107]
    ds_read_b128 v[52:55], v47 offset:40960
    v_mfma_f32_32x32x16_bf16 v[76:91], a[100:103], v[56:59], v[76:91]
    global_load_dwordx4 v[236:239], v117, s[28:29] offset:1024
    s_waitcnt lgkmcnt(2)
    s_barrier
    v_mfma_f32_32x32x16_bf16 v[92:107], a[228:231], v[56:59], v[92:107]
    ds_read_b128 v[56:59], v47 offset:41984
    v_mfma_f32_32x32x16_bf16 v[76:91], a[104:107], v[60:63], v[76:91]
    global_load_dwordx4 v[240:243], v117, s[28:29] offset:2048
    v_mfma_f32_32x32x16_bf16 v[92:107], a[232:235], v[60:63], v[92:107]
    ds_read_b128 v[60:63], v48 offset:0
    v_mfma_f32_32x32x16_bf16 v[76:91], a[108:111], v[64:67], v[76:91]
    global_load_dwordx4 v[244:247], v117, s[28:29] offset:3072
    v_add_u32 v117, 0x2000, v117
    v_mfma_f32_32x32x16_bf16 v[92:107], a[236:239], v[64:67], v[92:107]
    ds_read_b128 v[64:67], v48 offset:1024
    v_mfma_f32_32x32x16_bf16 v[76:91], a[112:115], v[68:71], v[76:91]
    global_load_dwordx4 v[248:251], v117, s[28:29] offset:-4096
    v_mfma_f32_32x32x16_bf16 v[92:107], a[240:243], v[68:71], v[92:107]
    ds_read_b128 v[68:71], v48 offset:2048
    s_waitcnt lgkmcnt(5)
    v_mfma_f32_32x32x16_bf16 v[76:91], a[116:119], v[72:75], v[76:91]
    global_load_dwordx4 v[252:255], v117, s[28:29] offset:-3072
    v_mfma_f32_32x32x16_bf16 v[92:107], a[244:247], v[72:75], v[92:107]
    ds_read_b128 v[72:75], v48 offset:3072
    s_waitcnt lgkmcnt(5)
    v_mfma_f32_32x32x16_bf16 v[76:91], a[120:123], v[52:55], v[76:91]
    v_mfma_f32_32x32x16_bf16 v[92:107], a[248:251], v[52:55], v[92:107]
    ds_read_b128 v[52:55], v48 offset:4096
    s_waitcnt lgkmcnt(5)
    v_mfma_f32_32x32x16_bf16 v[76:91], a[124:127], v[56:59], v[76:91]
    v_mfma_f32_32x32x16_bf16 v[92:107], a[252:255], v[56:59], v[92:107]
    ds_read_b128 v[56:59], v48 offset:5120
    v_mfma_f32_32x32x16_bf16 v[76:91], v[24:27], v[32:35], v[76:91]
    v_mfma_f32_32x32x16_bf16 v[92:107], v[28:31], v[32:35], v[92:107]
    v_mov_b32 v150, v117
    s_waitcnt lgkmcnt(5)
    v_mfma_f32_32x32x16_bf16 v[108:123], a[0:3], v[60:63], 0
    s_mul_i32 s54, s44, 29696
    s_add_u32 s54, s54, 4096
    v_add_u32 v0, s54, v2
    v_add_u32 v15, 8192, v0
    v_mfma_f32_32x32x16_bf16 v[124:139], a[128:131], v[60:63], 0
    ds_read_b128 v[60:63], v48 offset:6144
    v_add_u32 v14, 16384, v0
    v_add_u32 v149, 24576, v0
    v_fma_f32 v140, v76, v40, v41
    v_fma_f32 v141, v77, v40, v41
    v_fma_f32 v142, v78, v40, v41
    s_waitcnt lgkmcnt(5)
    v_mfma_f32_32x32x16_bf16 v[108:123], a[4:7], v[64:67], v[108:123]
    v_fma_f32 v143, v79, v40, v41
    v_fma_f32 v144, v80, v40, v41
    v_fma_f32 v145, v81, v40, v41
    v_fma_f32 v146, v82, v40, v41
    v_fma_f32 v147, v83, v40, v41
    v_mfma_f32_32x32x16_bf16 v[124:139], a[132:135], v[64:67], v[124:139]
    ds_read_b128 v[64:67], v46 offset:0
    v_exp_f32 v140, v140
    v_exp_f32 v141, v141
    s_waitcnt lgkmcnt(5)
    v_mfma_f32_32x32x16_bf16 v[108:123], a[8:11], v[68:71], v[108:123]
    v_exp_f32 v142, v142
    v_exp_f32 v143, v143
    v_mfma_f32_32x32x16_bf16 v[124:139], a[136:139], v[68:71], v[124:139]
    ds_read_b128 v[68:71], v48 offset:7168
    v_exp_f32 v144, v144
    v_exp_f32 v145, v145
    s_waitcnt lgkmcnt(5)
    v_mfma_f32_32x32x16_bf16 v[108:123], a[12:15], v[72:75], v[108:123]
    v_exp_f32 v146, v146
    v_exp_f32 v147, v147
    v_add_f32 v140, v140, v42
    v_mfma_f32_32x32x16_bf16 v[124:139], a[140:143], v[72:75], v[124:139]
    ds_read_b128 v[72:75], v48 offset:8192
    v_add_f32 v141, v141, v42
    v_add_f32 v142, v142, v42
    v_add_f32 v143, v143, v42
    v_add_f32 v144, v144, v42
    v_add_f32 v145, v145, v42
    s_waitcnt lgkmcnt(5)
    v_mfma_f32_32x32x16_bf16 v[108:123], a[16:19], v[52:55], v[108:123]
    global_load_dwordx4 a[0:3], v150, s[28:29] offset:-2048
    v_add_f32 v146, v146, v42
    v_add_f32 v147, v147, v42
    v_rcp_f32 v140, v140
    v_mfma_f32_32x32x16_bf16 v[124:139], a[144:147], v[52:55], v[124:139]
    ds_read_b128 v[52:55], v48 offset:9216
    v_rcp_f32 v141, v141
    v_rcp_f32 v142, v142
    s_waitcnt lgkmcnt(5)
    v_mfma_f32_32x32x16_bf16 v[108:123], a[20:23], v[56:59], v[108:123]
    global_load_dwordx4 a[128:131], v150, s[28:29] offset:-1024
    s_add_u32 s55, s36, 24576
    v_add_u32 v150, s55, v3
    v_rcp_f32 v143, v143
    v_mfma_f32_32x32x16_bf16 v[124:139], a[148:151], v[56:59], v[124:139]
    ds_read_b128 v[56:59], v48 offset:10240
    v_rcp_f32 v144, v144
    v_rcp_f32 v145, v145
    s_waitcnt lgkmcnt(5)
    v_mfma_f32_32x32x16_bf16 v[108:123], a[24:27], v[60:63], v[108:123]
    global_load_dwordx4 a[4:7], v150, s[28:29] offset:-2048
    v_rcp_f32 v146, v146
    v_rcp_f32 v147, v147
    v_mfma_f32_32x32x16_bf16 v[124:139], a[152:155], v[60:63], v[124:139]
    ds_read_b128 v[60:63], v48 offset:11264
    v_mul_f32 v76, v76, v140
    v_mul_f32 v77, v77, v141
    v_mul_f32 v78, v78, v142
    v_mul_f32 v79, v79, v143
    v_mul_f32 v80, v80, v144
    s_waitcnt lgkmcnt(5)
    v_mfma_f32_32x32x16_bf16 v[108:123], a[28:31], v[64:67], v[108:123]
    global_load_dwordx4 a[132:135], v150, s[28:29] offset:-1024
    v_mul_f32 v81, v81, v145
    v_mul_f32 v82, v82, v146
    v_mul_f32 v83, v83, v147
    v_cvt_pk_bf16_f32 v76, v76, v77
    v_mfma_f32_32x32x16_bf16 v[124:139], a[156:159], v[64:67], v[124:139]
    ds_read_b128 v[64:67], v48 offset:12288
    v_cvt_pk_bf16_f32 v77, v78, v79
    v_cvt_pk_bf16_f32 v78, v80, v81
    v_cvt_pk_bf16_f32 v79, v82, v83
    global_store_dwordx4 v8, v[76:79], s[18:19] offset:0 sc1
    s_waitcnt lgkmcnt(5)
    v_mfma_f32_32x32x16_bf16 v[108:123], a[32:35], v[68:71], v[108:123]
    global_load_dwordx4 a[8:11], v150, s[28:29] offset:0
    v_fma_f32 v140, v84, v40, v41
    v_fma_f32 v141, v85, v40, v41
    v_fma_f32 v142, v86, v40, v41
    v_fma_f32 v143, v87, v40, v41
    v_mfma_f32_32x32x16_bf16 v[124:139], a[160:163], v[68:71], v[124:139]
    ds_read_b128 v[68:71], v48 offset:13312
    v_fma_f32 v144, v88, v40, v41
    v_fma_f32 v145, v89, v40, v41
    v_fma_f32 v146, v90, v40, v41
    v_fma_f32 v147, v91, v40, v41
    s_waitcnt lgkmcnt(5)
    v_mfma_f32_32x32x16_bf16 v[108:123], a[36:39], v[72:75], v[108:123]
    global_load_dwordx4 a[136:139], v150, s[28:29] offset:1024
    v_exp_f32 v140, v140
    v_exp_f32 v141, v141
    v_mfma_f32_32x32x16_bf16 v[124:139], a[164:167], v[72:75], v[124:139]
    ds_read_b128 v[72:75], v46 offset:33792
    v_exp_f32 v142, v142
    v_exp_f32 v143, v143
    s_waitcnt lgkmcnt(5)
    v_mfma_f32_32x32x16_bf16 v[108:123], a[40:43], v[52:55], v[108:123]
    global_load_dwordx4 a[12:15], v150, s[28:29] offset:2048
    v_exp_f32 v144, v144
    v_exp_f32 v145, v145
    v_mfma_f32_32x32x16_bf16 v[124:139], a[168:171], v[52:55], v[124:139]
    ds_read_b128 v[52:55], v48 offset:14336
    v_exp_f32 v146, v146
    v_exp_f32 v147, v147
    v_add_f32 v140, v140, v42
    s_waitcnt lgkmcnt(5)
    v_mfma_f32_32x32x16_bf16 v[108:123], a[44:47], v[56:59], v[108:123]
    global_load_dwordx4 a[140:143], v150, s[28:29] offset:3072
    v_add_f32 v141, v141, v42
    v_add_f32 v142, v142, v42
    v_add_f32 v143, v143, v42
    v_add_f32 v144, v144, v42
    v_mfma_f32_32x32x16_bf16 v[124:139], a[172:175], v[56:59], v[124:139]
    ds_read_b128 v[56:59], v48 offset:15360
    v_add_f32 v145, v145, v42
    v_add_f32 v146, v146, v42
    v_add_f32 v147, v147, v42
    v_rcp_f32 v140, v140
    s_waitcnt lgkmcnt(5)
    v_mfma_f32_32x32x16_bf16 v[108:123], a[48:51], v[60:63], v[108:123]
    v_rcp_f32 v141, v141
    v_rcp_f32 v142, v142
    v_mfma_f32_32x32x16_bf16 v[124:139], a[176:179], v[60:63], v[124:139]
    ds_read_b128 v[60:63], v48 offset:16384
    v_rcp_f32 v143, v143
    v_rcp_f32 v144, v144
    s_waitcnt lgkmcnt(5)
    v_mfma_f32_32x32x16_bf16 v[108:123], a[52:55], v[64:67], v[108:123]
    v_rcp_f32 v145, v145
    v_rcp_f32 v146, v146
    v_mfma_f32_32x32x16_bf16 v[124:139], a[180:183], v[64:67], v[124:139]
    ds_read_b128 v[64:67], v48 offset:17408
    v_rcp_f32 v147, v147
    v_mul_f32 v84, v84, v140
    v_mul_f32 v85, v85, v141
    v_mul_f32 v86, v86, v142
    s_waitcnt lgkmcnt(5)
    v_mfma_f32_32x32x16_bf16 v[108:123], a[56:59], v[68:71], v[108:123]
    v_mul_f32 v87, v87, v143
    v_mul_f32 v88, v88, v144
    v_mul_f32 v89, v89, v145
    v_mul_f32 v90, v90, v146
    v_mul_f32 v91, v91, v147
    v_mfma_f32_32x32x16_bf16 v[124:139], a[184:187], v[68:71], v[124:139]
    ds_read_b128 v[68:71], v48 offset:18432
    v_cvt_pk_bf16_f32 v84, v84, v85
    v_cvt_pk_bf16_f32 v85, v86, v87
    v_cvt_pk_bf16_f32 v86, v88, v89
    v_cvt_pk_bf16_f32 v87, v90, v91
    s_waitcnt lgkmcnt(5)
    v_mfma_f32_32x32x16_bf16 v[108:123], a[60:63], v[72:75], v[108:123]
    global_store_dwordx4 v8, v[84:87], s[18:19] offset:1024 sc1
    v_fma_f32 v140, v92, v40, v41
    v_fma_f32 v141, v93, v40, v41
    v_fma_f32 v142, v94, v40, v41
    v_mfma_f32_32x32x16_bf16 v[124:139], a[188:191], v[72:75], v[124:139]
    ds_read_b128 v[72:75], v48 offset:19456
    v_fma_f32 v143, v95, v40, v41
    v_fma_f32 v144, v96, v40, v41
    v_fma_f32 v145, v97, v40, v41
    v_fma_f32 v146, v98, v40, v41
    v_fma_f32 v147, v99, v40, v41
    s_waitcnt lgkmcnt(5)
    v_mfma_f32_32x32x16_bf16 v[108:123], a[64:67], v[52:55], v[108:123]
    v_exp_f32 v140, v140
    v_exp_f32 v141, v141
    v_mfma_f32_32x32x16_bf16 v[124:139], a[192:195], v[52:55], v[124:139]
    ds_read_b128 v[52:55], v48 offset:20480
    v_exp_f32 v142, v142
    v_exp_f32 v143, v143
    s_waitcnt lgkmcnt(5)
    v_mfma_f32_32x32x16_bf16 v[108:123], a[68:71], v[56:59], v[108:123]
    v_exp_f32 v144, v144
    v_exp_f32 v145, v145
    v_mfma_f32_32x32x16_bf16 v[124:139], a[196:199], v[56:59], v[124:139]
    ds_read_b128 v[56:59], v47 offset:0
    v_exp_f32 v146, v146
    v_exp_f32 v147, v147
    v_add_f32 v140, v140, v42
    s_waitcnt lgkmcnt(5)
    v_mfma_f32_32x32x16_bf16 v[108:123], a[72:75], v[60:63], v[108:123]
    v_add_f32 v141, v141, v42
    v_add_f32 v142, v142, v42
    v_add_f32 v143, v143, v42
    v_add_f32 v144, v144, v42
    v_add_f32 v145, v145, v42
    v_mfma_f32_32x32x16_bf16 v[124:139], a[200:203], v[60:63], v[124:139]
    ds_read_b128 v[60:63], v48 offset:21504
    v_add_f32 v146, v146, v42
    v_add_f32 v147, v147, v42
    v_rcp_f32 v140, v140
    s_waitcnt lgkmcnt(5)
    v_mfma_f32_32x32x16_bf16 v[108:123], a[76:79], v[64:67], v[108:123]
    v_rcp_f32 v141, v141
    v_rcp_f32 v142, v142
    v_mfma_f32_32x32x16_bf16 v[124:139], a[204:207], v[64:67], v[124:139]
    ds_read_b128 v[64:67], v48 offset:22528
    v_rcp_f32 v143, v143
    v_rcp_f32 v144, v144
    s_waitcnt lgkmcnt(5)
    v_mfma_f32_32x32x16_bf16 v[108:123], a[80:83], v[68:71], v[108:123]
    v_rcp_f32 v145, v145
    v_rcp_f32 v146, v146
    v_mfma_f32_32x32x16_bf16 v[124:139], a[208:211], v[68:71], v[124:139]
    ds_read_b128 v[68:71], v48 offset:23552
    v_rcp_f32 v147, v147
    v_mul_f32 v92, v92, v140
    v_mul_f32 v93, v93, v141
    v_mul_f32 v94, v94, v142
    s_waitcnt lgkmcnt(5)
    v_mfma_f32_32x32x16_bf16 v[108:123], a[84:87], v[72:75], v[108:123]
    v_mul_f32 v95, v95, v143
    v_mul_f32 v96, v96, v144
    v_mul_f32 v97, v97, v145
    v_mul_f32 v98, v98, v146
    v_mul_f32 v99, v99, v147
    v_mfma_f32_32x32x16_bf16 v[124:139], a[212:215], v[72:75], v[124:139]
    ds_read_b128 v[72:75], v48 offset:24576
    v_cvt_pk_bf16_f32 v92, v92, v93
    v_cvt_pk_bf16_f32 v93, v94, v95
    v_cvt_pk_bf16_f32 v94, v96, v97
    v_cvt_pk_bf16_f32 v95, v98, v99
    s_waitcnt lgkmcnt(5)
    v_mfma_f32_32x32x16_bf16 v[108:123], a[88:91], v[52:55], v[108:123]
    global_load_dwordx4 a[16:19], v0, s[18:19] offset:-4096 sc1
    global_store_dwordx4 v13, v[92:95], s[18:19] offset:0 sc1
    v_fma_f32 v140, v100, v40, v41
    v_fma_f32 v141, v101, v40, v41
    v_mfma_f32_32x32x16_bf16 v[124:139], a[216:219], v[52:55], v[124:139]
    ds_read_b128 v[52:55], v48 offset:25600
    v_fma_f32 v142, v102, v40, v41
    v_fma_f32 v143, v103, v40, v41
    v_fma_f32 v144, v104, v40, v41
    v_fma_f32 v145, v105, v40, v41
    v_fma_f32 v146, v106, v40, v41
    s_waitcnt lgkmcnt(5)
    v_mfma_f32_32x32x16_bf16 v[108:123], a[92:95], v[56:59], v[108:123]
    global_load_dwordx4 a[144:147], v0, s[18:19] offset:0 sc1
    v_fma_f32 v147, v107, v40, v41
    v_exp_f32 v140, v140
    v_mfma_f32_32x32x16_bf16 v[124:139], a[220:223], v[56:59], v[124:139]
    ds_read_b128 v[56:59], v48 offset:26624
    v_exp_f32 v141, v141
    v_exp_f32 v142, v142
    s_waitcnt lgkmcnt(5)
    v_mfma_f32_32x32x16_bf16 v[108:123], a[96:99], v[60:63], v[108:123]
    global_load_dwordx4 a[20:23], v15, s[18:19] offset:-4096 sc1
    v_exp_f32 v143, v143
    v_exp_f32 v144, v144
    v_mfma_f32_32x32x16_bf16 v[124:139], a[224:227], v[60:63], v[124:139]
    ds_read_b128 v[60:63], v48 offset:27648
    v_exp_f32 v145, v145
    v_exp_f32 v146, v146
    s_waitcnt lgkmcnt(5)
    v_mfma_f32_32x32x16_bf16 v[108:123], a[100:103], v[64:67], v[108:123]
    global_load_dwordx4 a[148:151], v15, s[18:19] offset:0 sc1
    v_exp_f32 v147, v147
    v_add_f32 v140, v140, v42
    v_add_f32 v141, v141, v42
    v_mfma_f32_32x32x16_bf16 v[124:139], a[228:231], v[64:67], v[124:139]
    ds_read_b128 v[64:67], v47 offset:33792
    v_add_f32 v142, v142, v42
    v_add_f32 v143, v143, v42
    v_add_f32 v144, v144, v42
    v_add_f32 v145, v145, v42
    v_add_f32 v146, v146, v42
    s_waitcnt lgkmcnt(5)
    v_mfma_f32_32x32x16_bf16 v[108:123], a[104:107], v[68:71], v[108:123]
    global_load_dwordx4 a[24:27], v15, s[18:19] offset:2048 sc1
    v_add_f32 v147, v147, v42
    v_rcp_f32 v140, v140
    v_mfma_f32_32x32x16_bf16 v[124:139], a[232:235], v[68:71], v[124:139]
    ds_read_b128 v[68:71], v4 offset:0
    v_rcp_f32 v141, v141
    v_rcp_f32 v142, v142
    s_waitcnt lgkmcnt(5)
    v_mfma_f32_32x32x16_bf16 v[108:123], a[108:111], v[72:75], v[108:123]
    global_load_dwordx4 a[152:155], v14, s[18:19] offset:-2048 sc1
    v_rcp_f32 v143, v143
    v_rcp_f32 v144, v144
    v_mfma_f32_32x32x16_bf16 v[124:139], a[236:239], v[72:75], v[124:139]
    ds_read_b128 v[72:75], v4 offset:4096
    v_rcp_f32 v145, v145
    v_rcp_f32 v146, v146
    s_waitcnt lgkmcnt(5)
    v_mfma_f32_32x32x16_bf16 v[108:123], a[112:115], v[52:55], v[108:123]
    global_load_dwordx4 a[28:31], v14, s[18:19] offset:2048 sc1
    v_rcp_f32 v147, v147
    v_mul_f32 v100, v100, v140
    v_mul_f32 v101, v101, v141
    v_mfma_f32_32x32x16_bf16 v[124:139], a[240:243], v[52:55], v[124:139]
    ds_read_b128 v[52:55], v4 offset:8192
    v_mul_f32 v102, v102, v142
    v_mul_f32 v103, v103, v143
    v_mul_f32 v104, v104, v144
    v_mul_f32 v105, v105, v145
    v_mul_f32 v106, v106, v146
    s_waitcnt lgkmcnt(5)
    v_mfma_f32_32x32x16_bf16 v[108:123], a[116:119], v[56:59], v[108:123]
    global_load_dwordx4 a[156:159], v149, s[18:19] offset:-2048 sc1
    v_mul_f32 v107, v107, v147
    ds_read2st64_b64 v[140:143], v7 offset0:1 offset1:67
    v_mfma_f32_32x32x16_bf16 v[124:139], a[244:247], v[56:59], v[124:139]
    ds_read_b128 v[56:59], v4 offset:12288
    ds_read2st64_b64 v[144:147], v7 offset0:133 offset1:199
    v_cvt_pk_bf16_f32 v100, v100, v101
    v_cvt_pk_bf16_f32 v101, v102, v103
    v_cvt_pk_bf16_f32 v102, v104, v105
    s_waitcnt lgkmcnt(7)
    v_mfma_f32_32x32x16_bf16 v[108:123], a[120:123], v[60:63], v[108:123]
    global_load_dwordx4 a[32:35], v0, s[18:19] offset:-3072 sc1
    v_cvt_pk_bf16_f32 v103, v106, v107
    global_store_dwordx4 v13, v[100:103], s[18:19] offset:1024 sc1
    s_waitcnt lgkmcnt(0)
    v_mfma_f32_32x32x16_bf16 v[124:139], a[248:251], v[60:63], v[124:139]
    ds_read_b128 v[60:63], v4 offset:14336
    v_add_f32 v140, v140, v144
    v_add_f32 v141, v141, v145
    v_add_f32 v142, v142, v146
    v_add_f32 v143, v143, v147
    v_add_f32 v140, v140, v142
    v_mfma_f32_32x32x16_bf16 v[108:123], a[124:127], v[64:67], v[108:123]
    global_load_dwordx4 a[160:163], v0, s[18:19] offset:1024 sc1
    v_add_f32 v141, v141, v143
    v_mul_f32 v140, 0xbb000000, v140
    v_mul_f32 v141, 0x3b000000, v141
    v_fma_f32 v141, -v140, v140, v141
    v_mfma_f32_32x32x16_bf16 v[124:139], a[252:255], v[64:67], v[124:139]
    ds_read_b128 v[64:67], v4 offset:18432
    v_max_f32 v141, 0, v141
    v_add_f32 v141, 0x3727c5ac, v141
    v_rsq_f32 v142, v141
    v_log_f32 v44, v141
    v_mul_f32 v45, v141, v142
    v_mul_f32 v43, 0xbfb8aa3b, v142
    v_mul_f32 v44, 0.5, v44
    v_cndmask_b32 v140, v140, v45, s[62:63]
    v_and_b32 v141, 0xffff0000, v140
    v_lshrrev_b32 v37, 16, v140
    v_sub_f32 v140, v140, v141
    v_cvt_pk_bf16_f32 v36, v141, v140
    s_nop 1
    v_mfma_f32_32x32x16_bf16 v[108:123], v[24:27], v[36:39], v[108:123]
    global_load_dwordx4 a[36:39], v15, s[18:19] offset:-3072 sc1
    v_mfma_f32_32x32x16_bf16 v[124:139], v[28:31], v[36:39], v[124:139]
    v_lshrrev_b32 v40, 5, v1
    v_lshl_add_u32 v40, v40, 5, s48
    s_nop 7
    v_fma_f32 v140, v108, v43, v44
    v_fma_f32 v141, v109, v43, v44
    v_fma_f32 v142, v110, v43, v44
    v_fma_f32 v143, v111, v43, v44
    v_fma_f32 v144, v112, v43, v44
    v_fma_f32 v145, v113, v43, v44
    v_fma_f32 v146, v114, v43, v44
    v_fma_f32 v147, v115, v43, v44
    v_exp_f32 v140, v140
    v_exp_f32 v141, v141
    global_load_dwordx4 a[164:167], v15, s[18:19] offset:1024 sc1
    v_exp_f32 v142, v142
    v_exp_f32 v143, v143
    v_exp_f32 v144, v144
    v_exp_f32 v145, v145
    v_exp_f32 v146, v146
    v_exp_f32 v147, v147
    v_add_f32 v140, v140, v45
    v_add_f32 v141, v141, v45
    global_load_dwordx4 a[40:43], v15, s[18:19] offset:3072 sc1
    v_add_f32 v142, v142, v45
    v_add_f32 v143, v143, v45
    v_add_f32 v144, v144, v45
    v_add_f32 v145, v145, v45
    v_add_f32 v146, v146, v45
    v_add_f32 v147, v147, v45
    v_rcp_f32 v140, v140
    v_rcp_f32 v141, v141
    v_rcp_f32 v142, v142
    v_rcp_f32 v143, v143
    global_load_dwordx4 a[168:171], v14, s[18:19] offset:-1024 sc1
    v_rcp_f32 v144, v144
    v_rcp_f32 v145, v145
    v_rcp_f32 v146, v146
    v_rcp_f32 v147, v147
    v_mul_f32 v108, v108, v140
    v_mul_f32 v109, v109, v141
    v_mul_f32 v110, v110, v142
    v_mul_f32 v111, v111, v143
    v_mul_f32 v112, v112, v144
    v_mul_f32 v113, v113, v145
    global_load_dwordx4 a[44:47], v14, s[18:19] offset:3072 sc1
    v_mul_f32 v114, v114, v146
    v_mul_f32 v115, v115, v147
    v_cvt_pk_bf16_f32 v108, v108, v109
    v_cvt_pk_bf16_f32 v109, v110, v111
    v_cvt_pk_bf16_f32 v110, v112, v113
    v_cvt_pk_bf16_f32 v111, v114, v115
    global_store_dwordx4 v8, v[108:111], s[20:21] offset:0 sc1
    ds_read_b128 v[24:27], v40 offset:33728
    ds_read_b128 v[28:31], v40 offset:33744
    s_waitcnt vmcnt(13)
    v_accvgpr_read_b32 v32, a16
    v_accvgpr_read_b32 v33, a144
    v_accvgpr_read_b32 v34, a20
    v_accvgpr_read_b32 v35, a148
    v_max_u32 v32, v32, v33
    v_max3_u32 v32, v32, v34, v35
    v_cmp_eq_u32 vcc, -1, v32
    s_cbranch_vccnz adaLN_cond__grouped_kv_mqa__dense_activation_silu__prompt_kernel_st183
adaLN_cond__grouped_kv_mqa__dense_activation_silu__prompt_kernel_bk184:
    v_mfma_f32_32x32x16_bf16 v[92:107], v[152:155], a[16:19], 0
    global_load_dwordx4 a[172:175], v149, s[18:19] offset:-1024 sc1
    v_fma_f32 v140, v116, v43, v44
    v_fma_f32 v141, v117, v43, v44
    v_fma_f32 v142, v118, v43, v44
    v_fma_f32 v143, v119, v43, v44
    v_fma_f32 v144, v120, v43, v44
    v_mfma_f32_32x32x16_bf16 v[76:91], v[68:71], a[16:19], 0
    ds_read_b128 v[68:71], v4 offset:1024
    v_fma_f32 v145, v121, v43, v44
    v_fma_f32 v146, v122, v43, v44
    v_fma_f32 v147, v123, v43, v44
    v_mfma_f32_32x32x16_bf16 v[92:107], v[168:171], a[144:147], v[92:107]
    global_load_dwordx4 a[48:51], v0, s[18:19] offset:-2048 sc1
    v_exp_f32 v140, v140
    v_exp_f32 v141, v141
    v_mfma_f32_32x32x16_bf16 v[76:91], v[72:75], a[144:147], v[76:91]
    ds_read_b128 v[72:75], v4 offset:5120
    v_exp_f32 v142, v142
    v_exp_f32 v143, v143
    v_mfma_f32_32x32x16_bf16 v[92:107], v[184:187], a[20:23], v[92:107]
    global_load_dwordx4 a[176:179], v0, s[18:19] offset:2048 sc1
    v_exp_f32 v144, v144
    v_exp_f32 v145, v145
    v_mfma_f32_32x32x16_bf16 v[76:91], v[52:55], a[20:23], v[76:91]
    ds_read_b128 v[52:55], v4 offset:9216
    s_waitcnt vmcnt(12)
    v_accvgpr_read_b32 v32, a24
    v_accvgpr_read_b32 v33, a152
    v_accvgpr_read_b32 v34, a28
    v_mfma_f32_32x32x16_bf16 v[92:107], v[200:203], a[148:151], v[92:107]
    global_load_dwordx4 a[52:55], v15, s[18:19] offset:-2048 sc1
    v_accvgpr_read_b32 v35, a156
    v_max_u32 v32, v32, v33
    v_max3_u32 v32, v32, v34, v35
    v_exp_f32 v146, v146
    v_mfma_f32_32x32x16_bf16 v[76:91], v[56:59], a[148:151], v[76:91]
    ds_read_b128 v[56:59], v4 offset:13312
    v_cmp_eq_u32 vcc, -1, v32
    s_cbranch_vccnz adaLN_cond__grouped_kv_mqa__dense_activation_silu__prompt_kernel_st186
adaLN_cond__grouped_kv_mqa__dense_activation_silu__prompt_kernel_bk187:
    v_exp_f32 v147, v147
    v_mfma_f32_32x32x16_bf16 v[92:107], v[208:211], a[24:27], v[92:107]
    global_load_dwordx4 a[180:183], v14, s[18:19] offset:-4096 sc1
    v_add_f32 v140, v140, v45
    v_add_f32 v141, v141, v45
    v_add_f32 v142, v142, v45
    v_add_f32 v143, v143, v45
    v_add_f32 v144, v144, v45
    s_waitcnt lgkmcnt(7)
    v_mfma_f32_32x32x16_bf16 v[76:91], v[60:63], a[24:27], v[76:91]
    ds_read_b128 v[60:63], v4 offset:15360
    v_add_f32 v145, v145, v45
    v_add_f32 v146, v146, v45
    v_add_f32 v147, v147, v45
    v_mfma_f32_32x32x16_bf16 v[92:107], v[224:227], a[152:155], v[92:107]
    global_load_dwordx4 a[56:59], v14, s[18:19] offset:0 sc1
    v_rcp_f32 v140, v140
    v_rcp_f32 v141, v141
    s_waitcnt lgkmcnt(7)
    v_mfma_f32_32x32x16_bf16 v[76:91], v[64:67], a[152:155], v[76:91]
    ds_read_b128 v[64:67], v4 offset:19456
    v_rcp_f32 v142, v142
    v_rcp_f32 v143, v143
    v_mfma_f32_32x32x16_bf16 v[92:107], v[240:243], a[28:31], v[92:107]
    global_load_dwordx4 a[184:187], v149, s[18:19] offset:-4096 sc1
    v_rcp_f32 v144, v144
    v_rcp_f32 v145, v145
    v_mfma_f32_32x32x16_bf16 v[76:91], a[4:7], a[28:31], v[76:91]
    s_waitcnt vmcnt(6)
    v_accvgpr_read_b32 v32, a32
    v_accvgpr_read_b32 v33, a160
    v_accvgpr_read_b32 v34, a36
    v_accvgpr_read_b32 v35, a164
    v_accvgpr_read_b32 v36, a40
    v_mfma_f32_32x32x16_bf16 v[92:107], a[0:3], a[156:159], v[92:107]
    global_load_dwordx4 a[60:63], v0, s[18:19] offset:-1024 sc1
    v_accvgpr_read_b32 v37, a168
    v_accvgpr_read_b32 v38, a44
    v_accvgpr_read_b32 v39, a172
    v_max_u32 v32, v32, v33
    v_max3_u32 v32, v32, v34, v35
    v_mfma_f32_32x32x16_bf16 v[76:91], a[12:15], a[156:159], v[76:91]
    v_max3_u32 v32, v32, v36, v37
    v_max3_u32 v32, v32, v38, v39
    v_cmp_eq_u32 vcc, -1, v32
    s_cbranch_vccnz adaLN_cond__grouped_kv_mqa__dense_activation_silu__prompt_kernel_st189
adaLN_cond__grouped_kv_mqa__dense_activation_silu__prompt_kernel_bk190:
    v_rcp_f32 v146, v146
    v_mfma_f32_32x32x16_bf16 v[92:107], v[156:159], a[32:35], v[92:107]
    global_load_dwordx4 a[188:191], v0, s[18:19] offset:3072 sc1
    v_rcp_f32 v147, v147
    v_mul_f32 v116, v116, v140
    v_mul_f32 v117, v117, v141
    v_mul_f32 v118, v118, v142
    s_waitcnt lgkmcnt(5)
    v_mfma_f32_32x32x16_bf16 v[76:91], v[68:71], a[32:35], v[76:91]
    ds_read_b128 v[68:71], v4 offset:2048
    v_mul_f32 v119, v119, v143
    v_mul_f32 v120, v120, v144
    v_mul_f32 v121, v121, v145
    v_mul_f32 v122, v122, v146
    v_mfma_f32_32x32x16_bf16 v[92:107], v[172:175], a[160:163], v[92:107]
    global_load_dwordx4 a[64:67], v15, s[18:19] offset:-1024 sc1
    v_mul_f32 v123, v123, v147
    v_cvt_pk_bf16_f32 v116, v116, v117
    v_cvt_pk_bf16_f32 v117, v118, v119
    v_cvt_pk_bf16_f32 v118, v120, v121
    v_cvt_pk_bf16_f32 v119, v122, v123
    s_waitcnt lgkmcnt(5)
    v_mfma_f32_32x32x16_bf16 v[76:91], v[72:75], a[160:163], v[76:91]
    ds_read_b128 v[72:75], v4 offset:6144
    global_store_dwordx4 v8, v[116:119], s[20:21] offset:1024 sc1
    v_fma_f32 v140, v124, v43, v44
    v_fma_f32 v141, v125, v43, v44
    v_mfma_f32_32x32x16_bf16 v[92:107], v[188:191], a[36:39], v[92:107]
    global_load_dwordx4 a[192:195], v14, s[18:19] offset:-3072 sc1
    v_fma_f32 v142, v126, v43, v44
    v_fma_f32 v143, v127, v43, v44
    v_fma_f32 v144, v128, v43, v44
    v_fma_f32 v145, v129, v43, v44
    v_fma_f32 v146, v130, v43, v44
    s_waitcnt lgkmcnt(5)
    v_mfma_f32_32x32x16_bf16 v[76:91], v[52:55], a[36:39], v[76:91]
    ds_read_b128 v[52:55], v4 offset:10240
    v_fma_f32 v147, v131, v43, v44
    v_exp_f32 v140, v140
    v_mfma_f32_32x32x16_bf16 v[92:107], v[204:207], a[164:167], v[92:107]
    global_load_dwordx4 a[68:71], v14, s[18:19] offset:1024 sc1
    v_exp_f32 v141, v141
    v_exp_f32 v142, v142
    s_waitcnt lgkmcnt(5)
    v_mfma_f32_32x32x16_bf16 v[76:91], v[56:59], a[164:167], v[76:91]
    ds_read_b128 v[56:59], v4 offset:16384
    v_exp_f32 v143, v143
    v_exp_f32 v144, v144
    v_mfma_f32_32x32x16_bf16 v[92:107], v[212:215], a[40:43], v[92:107]
    global_load_dwordx4 a[196:199], v149, s[18:19] offset:-3072 sc1
    v_exp_f32 v145, v145
    v_exp_f32 v146, v146
    s_waitcnt lgkmcnt(5)
    v_mfma_f32_32x32x16_bf16 v[76:91], v[60:63], a[40:43], v[76:91]
    ds_read_b128 v[60:63], v4 offset:20480
    v_exp_f32 v147, v147
    v_add_f32 v140, v140, v45
    v_add_f32 v141, v141, v45
    v_mfma_f32_32x32x16_bf16 v[92:107], v[228:231], a[168:171], v[92:107]
    v_add_f32 v142, v142, v45
    v_add_f32 v143, v143, v45
    v_add_f32 v144, v144, v45
    v_add_f32 v145, v145, v45
    v_add_f32 v146, v146, v45
    v_add_f32 v147, v147, v45
    s_waitcnt lgkmcnt(5)
    v_mfma_f32_32x32x16_bf16 v[76:91], v[64:67], a[168:171], v[76:91]
    ds_read_b128 v[64:67], v4 offset:3072
    v_rcp_f32 v140, v140
    v_rcp_f32 v141, v141
    v_mfma_f32_32x32x16_bf16 v[92:107], v[244:247], a[44:47], v[92:107]
    global_load_dwordx4 a[72:75], v0, s[20:21] offset:-4096 sc1
    v_rcp_f32 v142, v142
    v_rcp_f32 v143, v143
    v_mfma_f32_32x32x16_bf16 v[76:91], a[132:135], a[44:47], v[76:91]
    s_waitcnt vmcnt(8)
    v_accvgpr_read_b32 v32, a48
    v_accvgpr_read_b32 v33, a176
    v_accvgpr_read_b32 v34, a52
    v_accvgpr_read_b32 v35, a180
    v_rcp_f32 v144, v144
    v_mfma_f32_32x32x16_bf16 v[92:107], a[128:131], a[172:175], v[92:107]
    global_load_dwordx4 a[200:203], v0, s[20:21] offset:0 sc1
    v_accvgpr_read_b32 v36, a56
    v_accvgpr_read_b32 v37, a184
    v_max_u32 v32, v32, v33
    v_max3_u32 v32, v32, v34, v35
    v_mfma_f32_32x32x16_bf16 v[76:91], a[140:143], a[172:175], v[76:91]
    v_max3_u32 v32, v32, v36, v37
    v_cmp_eq_u32 vcc, -1, v32
    s_cbranch_vccnz adaLN_cond__grouped_kv_mqa__dense_activation_silu__prompt_kernel_st192
adaLN_cond__grouped_kv_mqa__dense_activation_silu__prompt_kernel_bk193:
    v_rcp_f32 v145, v145
    v_rcp_f32 v146, v146
    v_mfma_f32_32x32x16_bf16 v[92:107], v[160:163], a[48:51], v[92:107]
    global_load_dwordx4 a[76:79], v15, s[20:21] offset:-4096 sc1
    v_rcp_f32 v147, v147
    v_mul_f32 v124, v124, v140
    v_mul_f32 v125, v125, v141
    v_mul_f32 v126, v126, v142
    s_waitcnt lgkmcnt(5)
    v_mfma_f32_32x32x16_bf16 v[76:91], v[68:71], a[48:51], v[76:91]
    ds_read_b128 v[68:71], v4 offset:7168
    v_mul_f32 v127, v127, v143
    v_mul_f32 v128, v128, v144
    v_mul_f32 v129, v129, v145
    v_mul_f32 v130, v130, v146
    v_mfma_f32_32x32x16_bf16 v[92:107], v[176:179], a[176:179], v[92:107]
    global_load_dwordx4 a[204:207], v15, s[20:21] offset:0 sc1
    v_mul_f32 v131, v131, v147
    v_cvt_pk_bf16_f32 v124, v124, v125
    v_cvt_pk_bf16_f32 v125, v126, v127
    v_cvt_pk_bf16_f32 v126, v128, v129
    v_cvt_pk_bf16_f32 v127, v130, v131
    s_waitcnt lgkmcnt(5)
    v_mfma_f32_32x32x16_bf16 v[76:91], v[72:75], a[176:179], v[76:91]
    ds_read_b128 v[72:75], v4 offset:11264
    global_store_dwordx4 v13, v[124:127], s[20:21] offset:0 sc1
    v_fma_f32 v140, v132, v43, v44
    v_fma_f32 v141, v133, v43, v44
    v_mfma_f32_32x32x16_bf16 v[92:107], v[192:195], a[52:55], v[92:107]
    global_load_dwordx4 a[80:83], v15, s[20:21] offset:2048 sc1
    v_fma_f32 v142, v134, v43, v44
    v_fma_f32 v143, v135, v43, v44
    v_fma_f32 v144, v136, v43, v44
    v_fma_f32 v145, v137, v43, v44
    v_fma_f32 v146, v138, v43, v44
    s_waitcnt lgkmcnt(5)
    v_mfma_f32_32x32x16_bf16 v[76:91], v[52:55], a[52:55], v[76:91]
    ds_read_b128 v[52:55], v4 offset:17408
    v_fma_f32 v147, v139, v43, v44
    v_exp_f32 v140, v140
    v_mfma_f32_32x32x16_bf16 v[92:107], v[216:219], a[180:183], v[92:107]
    global_load_dwordx4 a[208:211], v14, s[20:21] offset:-2048 sc1
    v_exp_f32 v141, v141
    v_exp_f32 v142, v142
    s_waitcnt lgkmcnt(5)
    v_mfma_f32_32x32x16_bf16 v[76:91], v[56:59], a[180:183], v[76:91]
    ds_read_b128 v[56:59], v4 offset:21504
    v_exp_f32 v143, v143
    v_exp_f32 v144, v144
    v_mfma_f32_32x32x16_bf16 v[92:107], v[232:235], a[56:59], v[92:107]
    global_load_dwordx4 a[84:87], v14, s[20:21] offset:2048 sc1
    v_exp_f32 v145, v145
    v_exp_f32 v146, v146
    s_waitcnt lgkmcnt(5)
    v_mfma_f32_32x32x16_bf16 v[76:91], v[60:63], a[56:59], v[76:91]
    ds_read_b128 v[60:63], v4 offset:0
    s_waitcnt vmcnt(8)
    v_accvgpr_read_b32 v32, a60
    v_accvgpr_read_b32 v33, a188
    v_accvgpr_read_b32 v34, a64
    v_accvgpr_read_b32 v35, a192
    v_mfma_f32_32x32x16_bf16 v[92:107], v[248:251], a[184:187], v[92:107]
    global_load_dwordx4 a[212:215], v149, s[20:21] offset:-2048 sc1
    v_accvgpr_read_b32 v36, a68
    v_accvgpr_read_b32 v37, a196
    v_max_u32 v32, v32, v33
    v_max3_u32 v32, v32, v34, v35
    v_mfma_f32_32x32x16_bf16 v[76:91], a[8:11], a[184:187], v[76:91]
    v_max3_u32 v32, v32, v36, v37
    v_cmp_eq_u32 vcc, -1, v32
    s_cbranch_vccnz adaLN_cond__grouped_kv_mqa__dense_activation_silu__prompt_kernel_st195
adaLN_cond__grouped_kv_mqa__dense_activation_silu__prompt_kernel_bk196:
    v_exp_f32 v147, v147
    v_add_f32 v140, v140, v45
    v_add_f32 v141, v141, v45
    v_mfma_f32_32x32x16_bf16 v[92:107], v[164:167], a[60:63], v[92:107]
    global_load_dwordx4 a[88:91], v0, s[20:21] offset:-3072 sc1
    v_add_f32 v142, v142, v45
    v_add_f32 v143, v143, v45
    v_add_f32 v144, v144, v45
    v_add_f32 v145, v145, v45
    v_add_f32 v146, v146, v45
    s_waitcnt lgkmcnt(5)
    v_mfma_f32_32x32x16_bf16 v[76:91], v[64:67], a[60:63], v[76:91]
    ds_read_b128 v[64:67], v4 offset:4096
    v_add_f32 v147, v147, v45
    v_rcp_f32 v140, v140
    v_mfma_f32_32x32x16_bf16 v[92:107], v[180:183], a[188:191], v[92:107]
    global_load_dwordx4 a[216:219], v0, s[20:21] offset:1024 sc1
    v_rcp_f32 v141, v141
    v_rcp_f32 v142, v142
    s_waitcnt lgkmcnt(5)
    v_mfma_f32_32x32x16_bf16 v[76:91], v[68:71], a[188:191], v[76:91]
    ds_read_b128 v[68:71], v4 offset:8192
    v_rcp_f32 v143, v143
    v_rcp_f32 v144, v144
    v_mfma_f32_32x32x16_bf16 v[92:107], v[196:199], a[64:67], v[92:107]
    global_load_dwordx4 a[92:95], v15, s[20:21] offset:-3072 sc1
    v_rcp_f32 v145, v145
    v_rcp_f32 v146, v146
    s_waitcnt lgkmcnt(5)
    v_mfma_f32_32x32x16_bf16 v[76:91], v[72:75], a[64:67], v[76:91]
    ds_read_b128 v[72:75], v4 offset:12288
    v_rcp_f32 v147, v147
    v_mul_f32 v132, v132, v140
    v_mul_f32 v133, v133, v141
    v_mfma_f32_32x32x16_bf16 v[92:107], v[220:223], a[192:195], v[92:107]
    global_load_dwordx4 a[220:223], v15, s[20:21] offset:1024 sc1
    v_mul_f32 v134, v134, v142
    v_mul_f32 v135, v135, v143
    v_mul_f32 v136, v136, v144
    v_mul_f32 v137, v137, v145
    v_mul_f32 v138, v138, v146
    s_waitcnt lgkmcnt(5)
    v_mfma_f32_32x32x16_bf16 v[76:91], v[52:55], a[192:195], v[76:91]
    ds_read_b128 v[52:55], v4 offset:14336
    v_mul_f32 v139, v139, v147
    v_cvt_pk_bf16_f32 v132, v132, v133
    v_cvt_pk_bf16_f32 v133, v134, v135
    v_cvt_pk_bf16_f32 v134, v136, v137
    v_mfma_f32_32x32x16_bf16 v[92:107], v[236:239], a[68:71], v[92:107]
    global_load_dwordx4 a[96:99], v15, s[20:21] offset:3072 sc1
    v_cvt_pk_bf16_f32 v135, v138, v139
    global_store_dwordx4 v13, v[132:135], s[20:21] offset:1024 sc1
    s_waitcnt lgkmcnt(5)
    v_mfma_f32_32x32x16_bf16 v[76:91], v[56:59], a[68:71], v[76:91]
    ds_read_b128 v[56:59], v4 offset:18432
    v_mfma_f32_32x32x16_bf16 v[92:107], v[252:255], a[196:199], v[92:107]
    global_load_dwordx4 a[224:227], v14, s[20:21] offset:-1024 sc1
    v_mfma_f32_32x32x16_bf16 v[76:91], a[136:139], a[196:199], v[76:91]
    s_waitcnt vmcnt(12)
    v_accvgpr_read_b32 v32, a72
    v_accvgpr_read_b32 v33, a200
    v_accvgpr_read_b32 v34, a76
    v_accvgpr_read_b32 v35, a204
    v_max_u32 v32, v32, v33
    v_max3_u32 v32, v32, v34, v35
    v_cmp_eq_u32 vcc, -1, v32
    s_cbranch_vccnz adaLN_cond__grouped_kv_mqa__dense_activation_silu__prompt_kernel_st198
adaLN_cond__grouped_kv_mqa__dense_activation_silu__prompt_kernel_bk199:
    v_mfma_f32_32x32x16_bf16 v[124:139], v[152:155], a[72:75], 0
    global_load_dwordx4 a[100:103], v14, s[20:21] offset:3072 sc1
    s_nop 0
    ds_write_b128 v49, v[84:87] offset:24768
    ds_write_b128 v49, v[88:91] offset:25792
    s_waitcnt lgkmcnt(7)
    v_mfma_f32_32x32x16_bf16 v[108:123], v[60:63], a[72:75], 0
    ds_read_b128 v[60:63], v4 offset:1024
    ds_write_b128 v50, v[92:95] offset:26816
    ds_write_b128 v50, v[96:99] offset:27840
    v_mfma_f32_32x32x16_bf16 v[124:139], v[168:171], a[200:203], v[124:139]
    global_load_dwordx4 a[228:231], v149, s[20:21] offset:-1024 sc1
    ds_write_b128 v51, v[100:103] offset:28864
    ds_write_b128 v51, v[104:107] offset:29888
    s_waitcnt lgkmcnt(0)
    v_mfma_f32_32x32x16_bf16 v[108:123], v[64:67], a[200:203], v[108:123]
    ds_read_b128 v[64:67], v4 offset:5120
    s_barrier
    ds_read_b128 v[84:87], v4 offset:24768
    v_mfma_f32_32x32x16_bf16 v[124:139], v[184:187], a[76:79], v[124:139]
    global_load_dwordx4 a[104:107], v0, s[20:21] offset:-2048 sc1
    ds_read_b128 v[88:91], v4 offset:25792
    ds_read_b128 v[92:95], v4 offset:26816
    v_mfma_f32_32x32x16_bf16 v[108:123], v[68:71], a[76:79], v[108:123]
    ds_read_b128 v[68:71], v4 offset:9216
    s_waitcnt vmcnt(10)
    v_accvgpr_read_b32 v140, a80
    v_accvgpr_read_b32 v141, a208
    v_accvgpr_read_b32 v142, a84
    v_mfma_f32_32x32x16_bf16 v[124:139], v[200:203], a[204:207], v[124:139]
    global_load_dwordx4 a[232:235], v0, s[20:21] offset:2048 sc1
    v_accvgpr_read_b32 v143, a212
    v_max_u32 v140, v140, v141
    v_max3_u32 v140, v140, v142, v143
    ds_read_b128 v[96:99], v4 offset:27840
    v_mfma_f32_32x32x16_bf16 v[108:123], v[72:75], a[204:207], v[108:123]
    ds_read_b128 v[72:75], v4 offset:13312
    v_cmp_eq_u32 vcc, -1, v140
    s_cbranch_vccnz adaLN_cond__grouped_kv_mqa__dense_activation_silu__prompt_kernel_st201
adaLN_cond__grouped_kv_mqa__dense_activation_silu__prompt_kernel_bk202:
    ds_read_b128 v[100:103], v4 offset:28864
    v_mfma_f32_32x32x16_bf16 v[124:139], v[208:211], a[80:83], v[124:139]
    global_load_dwordx4 a[108:111], v15, s[20:21] offset:-2048 sc1
    ds_read_b128 v[104:107], v4 offset:29888
    v_lshlrev_b32 v32, 16, v16
    v_and_b32 v33, 0xffff0000, v16
    v_lshlrev_b32 v34, 16, v17
    v_mfma_f32_32x32x16_bf16 v[108:123], v[52:55], a[80:83], v[108:123]
    ds_read_b128 v[52:55], v4 offset:15360
    v_and_b32 v35, 0xffff0000, v17
    v_lshlrev_b32 v36, 16, v18
    v_and_b32 v37, 0xffff0000, v18
    v_lshlrev_b32 v38, 16, v19
    v_mfma_f32_32x32x16_bf16 v[124:139], v[224:227], a[208:211], v[124:139]
    global_load_dwordx4 a[236:239], v14, s[20:21] offset:-4096 sc1
    v_and_b32 v39, 0xffff0000, v19
    s_waitcnt lgkmcnt(7)
    v_add_f32 v76, v76, v84
    v_add_f32 v77, v77, v85
    v_add_f32 v78, v78, v86
    v_mfma_f32_32x32x16_bf16 v[108:123], v[56:59], a[208:211], v[108:123]
    ds_read_b128 v[56:59], v4 offset:19456
    v_add_f32 v79, v79, v87
    v_add_f32 v80, v80, v88
    v_add_f32 v81, v81, v89
    v_add_f32 v82, v82, v90
    v_mfma_f32_32x32x16_bf16 v[124:139], v[240:243], a[84:87], v[124:139]
    global_load_dwordx4 a[112:115], v14, s[20:21] offset:0 sc1
    v_add_f32 v83, v83, v91
    s_waitcnt lgkmcnt(5)
    v_add_f32 v76, v76, v92
    v_add_f32 v77, v77, v93
    v_add_f32 v78, v78, v94
    v_mfma_f32_32x32x16_bf16 v[108:123], a[4:7], a[84:87], v[108:123]
    s_waitcnt vmcnt(5)
    v_accvgpr_read_b32 v140, a88
    v_accvgpr_read_b32 v141, a216
    v_accvgpr_read_b32 v142, a92
    v_accvgpr_read_b32 v143, a220
    v_accvgpr_read_b32 v144, a96
    v_add_f32 v79, v79, v95
    v_mfma_f32_32x32x16_bf16 v[124:139], a[0:3], a[212:215], v[124:139]
    global_load_dwordx4 a[240:243], v149, s[20:21] offset:-4096 sc1
    v_accvgpr_read_b32 v145, a224
    v_accvgpr_read_b32 v146, a100
    v_accvgpr_read_b32 v147, a228
    v_max_u32 v140, v140, v141
    v_max3_u32 v140, v140, v142, v143
    v_mfma_f32_32x32x16_bf16 v[108:123], a[12:15], a[212:215], v[108:123]
    v_max3_u32 v140, v140, v144, v145
    v_max3_u32 v140, v140, v146, v147
    v_cmp_eq_u32 vcc, -1, v140
    s_cbranch_vccnz adaLN_cond__grouped_kv_mqa__dense_activation_silu__prompt_kernel_st204
adaLN_cond__grouped_kv_mqa__dense_activation_silu__prompt_kernel_bk205:
    v_add_f32 v80, v80, v96
    v_add_f32 v81, v81, v97
    v_add_f32 v82, v82, v98
    v_mfma_f32_32x32x16_bf16 v[124:139], v[156:159], a[88:91], v[124:139]
    global_load_dwordx4 a[116:119], v0, s[20:21] offset:-1024 sc1
    v_add_f32 v83, v83, v99
    s_waitcnt lgkmcnt(2)
    v_add_f32 v76, v76, v100
    v_add_f32 v77, v77, v101
    v_add_f32 v78, v78, v102
    v_mfma_f32_32x32x16_bf16 v[108:123], v[60:63], a[88:91], v[108:123]
    ds_read_b128 v[60:63], v4 offset:2048
    v_add_f32 v79, v79, v103
    v_add_f32 v80, v80, v104
    v_add_f32 v81, v81, v105
    v_add_f32 v82, v82, v106
    v_mfma_f32_32x32x16_bf16 v[124:139], v[172:175], a[216:219], v[124:139]
    global_load_dwordx4 a[244:247], v0, s[20:21] offset:3072 sc1
    v_add_f32 v83, v83, v107
    v_fma_f32 v76, v76, v24, v32
    v_fma_f32 v77, v77, v25, v33
    v_fma_f32 v78, v78, v26, v34
    v_fma_f32 v79, v79, v27, v35
    v_mfma_f32_32x32x16_bf16 v[108:123], v[64:67], a[216:219], v[108:123]
    ds_read_b128 v[64:67], v4 offset:6144
    v_fma_f32 v80, v80, v28, v36
    v_fma_f32 v81, v81, v29, v37
    v_fma_f32 v82, v82, v30, v38
    v_fma_f32 v83, v83, v31, v39
    v_mfma_f32_32x32x16_bf16 v[124:139], v[188:191], a[92:95], v[124:139]
    global_load_dwordx4 a[120:123], v15, s[20:21] offset:-1024 sc1
    v_cvt_pk_bf16_f32 v84, v76, v77
    v_cvt_pk_bf16_f32 v85, v78, v79
    v_cvt_pk_bf16_f32 v86, v80, v81
    v_cvt_pk_bf16_f32 v87, v82, v83
    v_mfma_f32_32x32x16_bf16 v[108:123], v[68:71], a[92:95], v[108:123]
    ds_read_b128 v[68:71], v4 offset:10240
    global_store_dwordx4 v5, v[84:87], s[24:25]
    v_mfma_f32_32x32x16_bf16 v[124:139], v[204:207], a[220:223], v[124:139]
    global_load_dwordx4 a[248:251], v14, s[20:21] offset:-3072 sc1
    v_mfma_f32_32x32x16_bf16 v[108:123], v[72:75], a[220:223], v[108:123]
    ds_read_b128 v[72:75], v4 offset:16384
    v_mfma_f32_32x32x16_bf16 v[124:139], v[212:215], a[96:99], v[124:139]
    global_load_dwordx4 a[124:127], v14, s[20:21] offset:1024 sc1
    s_waitcnt lgkmcnt(5)
    v_mfma_f32_32x32x16_bf16 v[108:123], v[52:55], a[96:99], v[108:123]
    ds_read_b128 v[52:55], v4 offset:20480
    v_mfma_f32_32x32x16_bf16 v[124:139], v[228:231], a[224:227], v[124:139]
    global_load_dwordx4 a[252:255], v149, s[20:21] offset:-3072 sc1
    s_waitcnt lgkmcnt(5)
    v_mfma_f32_32x32x16_bf16 v[108:123], v[56:59], a[224:227], v[108:123]
    ds_read_b128 v[56:59], v4 offset:3072
    v_mfma_f32_32x32x16_bf16 v[124:139], v[244:247], a[100:103], v[124:139]
    v_mfma_f32_32x32x16_bf16 v[108:123], a[132:135], a[100:103], v[108:123]
    s_waitcnt vmcnt(7)
    v_accvgpr_read_b32 v140, a104
    v_accvgpr_read_b32 v141, a232
    v_accvgpr_read_b32 v142, a108
    v_accvgpr_read_b32 v143, a236
    v_mfma_f32_32x32x16_bf16 v[124:139], a[128:131], a[228:231], v[124:139]
    v_accvgpr_read_b32 v144, a112
    v_accvgpr_read_b32 v145, a240
    v_max_u32 v140, v140, v141
    v_max3_u32 v140, v140, v142, v143
    v_mfma_f32_32x32x16_bf16 v[108:123], a[140:143], a[228:231], v[108:123]
    v_max3_u32 v140, v140, v144, v145
    v_cmp_eq_u32 vcc, -1, v140
    s_cbranch_vccnz adaLN_cond__grouped_kv_mqa__dense_activation_silu__prompt_kernel_st207
adaLN_cond__grouped_kv_mqa__dense_activation_silu__prompt_kernel_bk208:
    v_mfma_f32_32x32x16_bf16 v[124:139], v[160:163], a[104:107], v[124:139]
    s_waitcnt lgkmcnt(5)
    v_mfma_f32_32x32x16_bf16 v[108:123], v[60:63], a[104:107], v[108:123]
    ds_read_b128 v[60:63], v4 offset:7168
    v_mfma_f32_32x32x16_bf16 v[124:139], v[176:179], a[232:235], v[124:139]
    s_waitcnt lgkmcnt(5)
    v_mfma_f32_32x32x16_bf16 v[108:123], v[64:67], a[232:235], v[108:123]
    ds_read_b128 v[64:67], v4 offset:11264
    v_mfma_f32_32x32x16_bf16 v[124:139], v[192:195], a[108:111], v[124:139]
    s_waitcnt lgkmcnt(5)
    v_mfma_f32_32x32x16_bf16 v[108:123], v[68:71], a[108:111], v[108:123]
    ds_read_b128 v[68:71], v4 offset:17408
    v_mfma_f32_32x32x16_bf16 v[124:139], v[216:219], a[236:239], v[124:139]
    s_waitcnt lgkmcnt(5)
    v_mfma_f32_32x32x16_bf16 v[108:123], v[72:75], a[236:239], v[108:123]
    ds_read_b128 v[72:75], v4 offset:21504
    v_mfma_f32_32x32x16_bf16 v[124:139], v[232:235], a[112:115], v[124:139]
    s_waitcnt lgkmcnt(5)
    v_mfma_f32_32x32x16_bf16 v[108:123], v[52:55], a[112:115], v[108:123]
    s_waitcnt vmcnt(0)
    v_accvgpr_read_b32 v140, a116
    v_accvgpr_read_b32 v141, a244
    v_accvgpr_read_b32 v142, a120
    v_accvgpr_read_b32 v143, a248
    v_mfma_f32_32x32x16_bf16 v[124:139], v[248:251], a[240:243], v[124:139]
    v_accvgpr_read_b32 v144, a124
    v_accvgpr_read_b32 v145, a252
    v_max_u32 v140, v140, v141
    v_max3_u32 v140, v140, v142, v143
    v_mfma_f32_32x32x16_bf16 v[108:123], a[8:11], a[240:243], v[108:123]
    v_max3_u32 v140, v140, v144, v145
    v_cmp_eq_u32 vcc, -1, v140
    s_cbranch_vccnz adaLN_cond__grouped_kv_mqa__dense_activation_silu__prompt_kernel_st210
adaLN_cond__grouped_kv_mqa__dense_activation_silu__prompt_kernel_bk211:
    v_mfma_f32_32x32x16_bf16 v[124:139], v[164:167], a[116:119], v[124:139]
    s_waitcnt lgkmcnt(4)
    v_mfma_f32_32x32x16_bf16 v[108:123], v[56:59], a[116:119], v[108:123]
    v_mfma_f32_32x32x16_bf16 v[124:139], v[180:183], a[244:247], v[124:139]
    s_waitcnt lgkmcnt(3)
    v_mfma_f32_32x32x16_bf16 v[108:123], v[60:63], a[244:247], v[108:123]
    v_mfma_f32_32x32x16_bf16 v[124:139], v[196:199], a[120:123], v[124:139]
    s_waitcnt lgkmcnt(2)
    v_mfma_f32_32x32x16_bf16 v[108:123], v[64:67], a[120:123], v[108:123]
    v_mfma_f32_32x32x16_bf16 v[124:139], v[220:223], a[248:251], v[124:139]
    s_waitcnt lgkmcnt(1)
    v_mfma_f32_32x32x16_bf16 v[108:123], v[68:71], a[248:251], v[108:123]
    v_mfma_f32_32x32x16_bf16 v[124:139], v[236:239], a[124:127], v[124:139]
    s_waitcnt lgkmcnt(0)
    v_mfma_f32_32x32x16_bf16 v[108:123], v[72:75], a[124:127], v[108:123]
    v_mfma_f32_32x32x16_bf16 v[124:139], v[252:255], a[252:255], v[124:139]
    v_mfma_f32_32x32x16_bf16 v[108:123], a[136:139], a[252:255], v[108:123]
    s_nop 11
    ds_write_b128 v10, v[116:119] offset:0
    ds_write_b128 v10, v[120:123] offset:1024
    ds_write_b128 v11, v[124:127] offset:2048
    ds_write_b128 v11, v[128:131] offset:3072
    ds_write_b128 v12, v[132:135] offset:4096
    ds_write_b128 v12, v[136:139] offset:5120
    s_waitcnt lgkmcnt(0)
    s_barrier
    ds_read_b128 v[116:119], v9 offset:0
    ds_read_b128 v[120:123], v9 offset:1024
    ds_read_b128 v[124:127], v9 offset:2048
    ds_read_b128 v[128:131], v9 offset:3072
    ds_read_b128 v[132:135], v9 offset:4096
    ds_read_b128 v[136:139], v9 offset:5120
    v_lshlrev_b32 v32, 16, v20
    v_and_b32 v33, 0xffff0000, v20
    v_lshlrev_b32 v34, 16, v21
    v_and_b32 v35, 0xffff0000, v21
    v_lshlrev_b32 v36, 16, v22
    v_and_b32 v37, 0xffff0000, v22
    v_lshlrev_b32 v38, 16, v23
    v_and_b32 v39, 0xffff0000, v23
    s_waitcnt lgkmcnt(4)
    v_pk_add_f32 v[108:109], v[108:109], v[116:117]
    v_pk_add_f32 v[110:111], v[110:111], v[118:119]
    v_pk_add_f32 v[112:113], v[112:113], v[120:121]
    v_pk_add_f32 v[114:115], v[114:115], v[122:123]
    s_waitcnt lgkmcnt(2)
    v_pk_add_f32 v[108:109], v[108:109], v[124:125]
    v_pk_add_f32 v[110:111], v[110:111], v[126:127]
    v_pk_add_f32 v[112:113], v[112:113], v[128:129]
    v_pk_add_f32 v[114:115], v[114:115], v[130:131]
    s_waitcnt lgkmcnt(0)
    v_pk_add_f32 v[108:109], v[108:109], v[132:133]
    v_pk_add_f32 v[110:111], v[110:111], v[134:135]
    v_pk_add_f32 v[112:113], v[112:113], v[136:137]
    v_pk_add_f32 v[114:115], v[114:115], v[138:139]
    v_pk_fma_f32 v[108:109], v[108:109], v[24:25], v[32:33]
    v_pk_fma_f32 v[110:111], v[110:111], v[26:27], v[34:35]
    v_pk_fma_f32 v[112:113], v[112:113], v[28:29], v[36:37]
    v_pk_fma_f32 v[114:115], v[114:115], v[30:31], v[38:39]
    v_cvt_pk_bf16_f32 v116, v108, v109
    v_cvt_pk_bf16_f32 v117, v110, v111
    v_cvt_pk_bf16_f32 v118, v112, v113
    v_cvt_pk_bf16_f32 v119, v114, v115
    global_store_dwordx4 v6, v[116:119], s[24:25]
    s_branch adaLN_cond__grouped_kv_mqa__dense_activation_silu__prompt_kernel_fin2
adaLN_cond__grouped_kv_mqa__dense_activation_silu__prompt_kernel_obad170:
    s_or_b32 s97, s97, 2
    v_add_u32 v96, 180224, v13
    global_store_dwordx4 v96, v[56:59], s[50:51] sc1
    s_nop 1
    s_branch adaLN_cond__grouped_kv_mqa__dense_activation_silu__prompt_kernel_obk171
adaLN_cond__grouped_kv_mqa__dense_activation_silu__prompt_kernel_st174:
    global_load_dwordx4 v[224:227], v15, s[6:7] offset:-4096 sc1
    global_load_dwordx4 v[228:231], v15, s[6:7] offset:-3072 sc1
    global_load_dwordx4 v[232:235], v15, s[6:7] offset:-2048 sc1
    global_load_dwordx4 v[236:239], v15, s[6:7] offset:-1024 sc1
    global_load_dwordx4 v[240:243], v15, s[6:7] offset:0 sc1
    global_load_dwordx4 v[244:247], v15, s[6:7] offset:1024 sc1
    global_load_dwordx4 v[248:251], v15, s[6:7] offset:2048 sc1
    global_load_dwordx4 v[252:255], v15, s[6:7] offset:3072 sc1
    s_waitcnt vmcnt(0)
    v_max_u32 v14, v224, v228
    v_max3_u32 v14, v14, v232, v236
    v_max3_u32 v14, v14, v240, v244
    v_max3_u32 v14, v14, v248, v252
    v_cmp_eq_u32 vcc, -1, v14
    s_cbranch_vccz adaLN_cond__grouped_kv_mqa__dense_activation_silu__prompt_kernel_ok176
    s_add_u32 s96, s96, 1
    s_cmp_lt_u32 s96, 131072
    s_cbranch_scc1 adaLN_cond__grouped_kv_mqa__dense_activation_silu__prompt_kernel_st174
adaLN_cond__grouped_kv_mqa__dense_activation_silu__prompt_kernel_ok176:
    s_branch adaLN_cond__grouped_kv_mqa__dense_activation_silu__prompt_kernel_bk175
adaLN_cond__grouped_kv_mqa__dense_activation_silu__prompt_kernel_st177:
    s_add_u32 m0, s48, 24768
    s_nop 0
    global_load_lds_dwordx4 v0, s[8:9] offset:0 sc1
    global_load_lds_dwordx4 v0, s[8:9] offset:1024 sc1
    global_load_lds_dwordx4 v0, s[8:9] offset:2048 sc1
    global_load_lds_dwordx4 v0, s[8:9] offset:3072 sc1
    s_add_u32 m0, m0, 4096
    s_nop 0
    global_load_lds_dwordx4 v15, s[8:9] offset:0 sc1
    global_load_lds_dwordx4 v15, s[8:9] offset:1024 sc1
    global_load_lds_dwordx4 v15, s[8:9] offset:2048 sc1
    global_load_lds_dwordx4 v15, s[8:9] offset:3072 sc1
    global_load_dwordx4 v[84:87], v14, s[12:13] offset:0 sc1
    global_load_dwordx4 v[88:91], v14, s[12:13] offset:1024 sc1
    s_waitcnt vmcnt(0)
    ds_read2st64_b32 v[92:93], v116 offset0:0 offset1:4
    ds_read2st64_b32 v[94:95], v116 offset0:8 offset1:12
    ds_read2st64_b32 v[96:97], v116 offset0:16 offset1:20
    ds_read2st64_b32 v[98:99], v116 offset0:24 offset1:28
    v_pk_add_f32 v[84:85], v[84:85], v[86:87]
    v_pk_add_f32 v[88:89], v[88:89], v[90:91]
    v_pk_add_f32 v[84:85], v[84:85], v[88:89]
    s_waitcnt lgkmcnt(0)
    v_max_u32 v100, v92, v93
    v_max3_u32 v100, v100, v94, v95
    v_max3_u32 v100, v100, v96, v97
    v_max3_u32 v100, v100, v98, v99
    v_cmp_eq_u32 vcc, -1, v100
    v_cmp_u_f32 s[56:57], v84, v85
    s_or_b64 vcc, vcc, s[56:57]
    s_cbranch_vccz adaLN_cond__grouped_kv_mqa__dense_activation_silu__prompt_kernel_ok179
    s_add_u32 s96, s96, 1
    s_cmp_lt_u32 s96, 131072
    s_cbranch_scc1 adaLN_cond__grouped_kv_mqa__dense_activation_silu__prompt_kernel_st177
adaLN_cond__grouped_kv_mqa__dense_activation_silu__prompt_kernel_ok179:
    v_permlane32_swap_b32 v84, v85
    v_add_f32 v84, v84, v85
    ds_write_b32 v118, v84 offset:0
    s_waitcnt lgkmcnt(0)
    s_branch adaLN_cond__grouped_kv_mqa__dense_activation_silu__prompt_kernel_bk178
adaLN_cond__grouped_kv_mqa__dense_activation_silu__prompt_kernel_st180:
    s_mov_b32 m0, s49
    s_nop 0
    global_load_lds_dwordx4 v0, s[10:11] offset:0 sc1
    global_load_lds_dwordx4 v0, s[10:11] offset:1024 sc1
    global_load_lds_dwordx4 v0, s[10:11] offset:2048 sc1
    global_load_lds_dwordx4 v0, s[10:11] offset:3072 sc1
    s_add_u32 m0, m0, 4096
    s_nop 0
    global_load_lds_dwordx4 v15, s[10:11] offset:0 sc1
    global_load_lds_dwordx4 v15, s[10:11] offset:1024 sc1
    global_load_lds_dwordx4 v15, s[10:11] offset:2048 sc1
    s_add_u32 m0, s48, 20672
    s_nop 0
    global_load_lds_dwordx4 v15, s[10:11] offset:3072 sc1
    global_load_dwordx4 v[108:111], v14, s[12:13] offset:512 sc1
    global_load_dwordx4 v[112:115], v14, s[12:13] offset:1536 sc1
    s_waitcnt vmcnt(0)
    ds_read2st64_b32 v[120:121], v9 offset0:0 offset1:4
    ds_read2st64_b32 v[122:123], v9 offset0:8 offset1:12
    ds_read2st64_b32 v[124:125], v9 offset0:16 offset1:20
    ds_read_b32 v126, v9 offset:6144
    ds_read_b32 v127, v4 offset:23744
    v_pk_add_f32 v[108:109], v[108:109], v[110:111]
    v_pk_add_f32 v[112:113], v[112:113], v[114:115]
    v_pk_add_f32 v[108:109], v[108:109], v[112:113]
    s_waitcnt lgkmcnt(0)
    v_max_u32 v128, v120, v121
    v_max3_u32 v128, v128, v122, v123
    v_max3_u32 v128, v128, v124, v125
    v_max3_u32 v128, v128, v126, v127
    v_cmp_eq_u32 vcc, -1, v128
    v_cmp_u_f32 s[56:57], v108, v109
    s_or_b64 vcc, vcc, s[56:57]
    s_cbranch_vccz adaLN_cond__grouped_kv_mqa__dense_activation_silu__prompt_kernel_ok182
    s_add_u32 s96, s96, 1
    s_cmp_lt_u32 s96, 131072
    s_cbranch_scc1 adaLN_cond__grouped_kv_mqa__dense_activation_silu__prompt_kernel_st180
adaLN_cond__grouped_kv_mqa__dense_activation_silu__prompt_kernel_ok182:
    v_permlane32_swap_b32 v108, v109
    v_add_f32 v108, v108, v109
    ds_write_b32 v118, v108 offset:512
    s_waitcnt lgkmcnt(0)
    s_branch adaLN_cond__grouped_kv_mqa__dense_activation_silu__prompt_kernel_bk181
adaLN_cond__grouped_kv_mqa__dense_activation_silu__prompt_kernel_st183:
    global_load_dwordx4 a[16:19], v0, s[18:19] offset:-4096 sc1
    global_load_dwordx4 a[144:147], v0, s[18:19] offset:0 sc1
    global_load_dwordx4 a[20:23], v15, s[18:19] offset:-4096 sc1
    global_load_dwordx4 a[148:151], v15, s[18:19] offset:0 sc1
    s_waitcnt vmcnt(0)
    v_accvgpr_read_b32 v32, a16
    v_accvgpr_read_b32 v33, a144
    v_accvgpr_read_b32 v34, a20
    v_accvgpr_read_b32 v35, a148
    v_max_u32 v32, v32, v33
    v_max3_u32 v32, v32, v34, v35
    v_cmp_eq_u32 vcc, -1, v32
    s_cbranch_vccz adaLN_cond__grouped_kv_mqa__dense_activation_silu__prompt_kernel_ok185
    s_add_u32 s96, s96, 1
    s_cmp_lt_u32 s96, 131072
    s_cbranch_scc1 adaLN_cond__grouped_kv_mqa__dense_activation_silu__prompt_kernel_st183
adaLN_cond__grouped_kv_mqa__dense_activation_silu__prompt_kernel_ok185:
    s_branch adaLN_cond__grouped_kv_mqa__dense_activation_silu__prompt_kernel_bk184
adaLN_cond__grouped_kv_mqa__dense_activation_silu__prompt_kernel_st186:
    global_load_dwordx4 a[24:27], v15, s[18:19] offset:2048 sc1
    global_load_dwordx4 a[152:155], v14, s[18:19] offset:-2048 sc1
    global_load_dwordx4 a[28:31], v14, s[18:19] offset:2048 sc1
    global_load_dwordx4 a[156:159], v149, s[18:19] offset:-2048 sc1
    s_waitcnt vmcnt(0)
    v_accvgpr_read_b32 v32, a24
    v_accvgpr_read_b32 v33, a152
    v_accvgpr_read_b32 v34, a28
    v_accvgpr_read_b32 v35, a156
    v_max_u32 v32, v32, v33
    v_max3_u32 v32, v32, v34, v35
    v_cmp_eq_u32 vcc, -1, v32
    s_cbranch_vccz adaLN_cond__grouped_kv_mqa__dense_activation_silu__prompt_kernel_ok188
    s_add_u32 s96, s96, 1
    s_cmp_lt_u32 s96, 131072
    s_cbranch_scc1 adaLN_cond__grouped_kv_mqa__dense_activation_silu__prompt_kernel_st186
adaLN_cond__grouped_kv_mqa__dense_activation_silu__prompt_kernel_ok188:
    s_branch adaLN_cond__grouped_kv_mqa__dense_activation_silu__prompt_kernel_bk187
adaLN_cond__grouped_kv_mqa__dense_activation_silu__prompt_kernel_st189:
    global_load_dwordx4 a[32:35], v0, s[18:19] offset:-3072 sc1
    global_load_dwordx4 a[160:163], v0, s[18:19] offset:1024 sc1
    global_load_dwordx4 a[36:39], v15, s[18:19] offset:-3072 sc1
    global_load_dwordx4 a[164:167], v15, s[18:19] offset:1024 sc1
    global_load_dwordx4 a[40:43], v15, s[18:19] offset:3072 sc1
    global_load_dwordx4 a[168:171], v14, s[18:19] offset:-1024 sc1
    global_load_dwordx4 a[44:47], v14, s[18:19] offset:3072 sc1
    global_load_dwordx4 a[172:175], v149, s[18:19] offset:-1024 sc1
    s_waitcnt vmcnt(0)
    v_accvgpr_read_b32 v32, a32
    v_accvgpr_read_b32 v33, a160
    v_accvgpr_read_b32 v34, a36
    v_accvgpr_read_b32 v35, a164
    v_accvgpr_read_b32 v36, a40
    v_accvgpr_read_b32 v37, a168
    v_accvgpr_read_b32 v38, a44
    v_accvgpr_read_b32 v39, a172
    v_max_u32 v32, v32, v33
    v_max3_u32 v32, v32, v34, v35
    v_max3_u32 v32, v32, v36, v37
    v_max3_u32 v32, v32, v38, v39
    v_cmp_eq_u32 vcc, -1, v32
    s_cbranch_vccz adaLN_cond__grouped_kv_mqa__dense_activation_silu__prompt_kernel_ok191
    s_add_u32 s96, s96, 1
    s_cmp_lt_u32 s96, 131072
    s_cbranch_scc1 adaLN_cond__grouped_kv_mqa__dense_activation_silu__prompt_kernel_st189
adaLN_cond__grouped_kv_mqa__dense_activation_silu__prompt_kernel_ok191:
    s_branch adaLN_cond__grouped_kv_mqa__dense_activation_silu__prompt_kernel_bk190
adaLN_cond__grouped_kv_mqa__dense_activation_silu__prompt_kernel_st192:
    global_load_dwordx4 a[48:51], v0, s[18:19] offset:-2048 sc1
    global_load_dwordx4 a[176:179], v0, s[18:19] offset:2048 sc1
    global_load_dwordx4 a[52:55], v15, s[18:19] offset:-2048 sc1
    global_load_dwordx4 a[180:183], v14, s[18:19] offset:-4096 sc1
    global_load_dwordx4 a[56:59], v14, s[18:19] offset:0 sc1
    global_load_dwordx4 a[184:187], v149, s[18:19] offset:-4096 sc1
    s_waitcnt vmcnt(0)
    v_accvgpr_read_b32 v32, a48
    v_accvgpr_read_b32 v33, a176
    v_accvgpr_read_b32 v34, a52
    v_accvgpr_read_b32 v35, a180
    v_accvgpr_read_b32 v36, a56
    v_accvgpr_read_b32 v37, a184
    v_max_u32 v32, v32, v33
    v_max3_u32 v32, v32, v34, v35
    v_max3_u32 v32, v32, v36, v37
    v_cmp_eq_u32 vcc, -1, v32
    s_cbranch_vccz adaLN_cond__grouped_kv_mqa__dense_activation_silu__prompt_kernel_ok194
    s_add_u32 s96, s96, 1
    s_cmp_lt_u32 s96, 131072
    s_cbranch_scc1 adaLN_cond__grouped_kv_mqa__dense_activation_silu__prompt_kernel_st192
adaLN_cond__grouped_kv_mqa__dense_activation_silu__prompt_kernel_ok194:
    s_branch adaLN_cond__grouped_kv_mqa__dense_activation_silu__prompt_kernel_bk193
adaLN_cond__grouped_kv_mqa__dense_activation_silu__prompt_kernel_st195:
    global_load_dwordx4 a[60:63], v0, s[18:19] offset:-1024 sc1
    global_load_dwordx4 a[188:191], v0, s[18:19] offset:3072 sc1
    global_load_dwordx4 a[64:67], v15, s[18:19] offset:-1024 sc1
    global_load_dwordx4 a[192:195], v14, s[18:19] offset:-3072 sc1
    global_load_dwordx4 a[68:71], v14, s[18:19] offset:1024 sc1
    global_load_dwordx4 a[196:199], v149, s[18:19] offset:-3072 sc1
    s_waitcnt vmcnt(0)
    v_accvgpr_read_b32 v32, a60
    v_accvgpr_read_b32 v33, a188
    v_accvgpr_read_b32 v34, a64
    v_accvgpr_read_b32 v35, a192
    v_accvgpr_read_b32 v36, a68
    v_accvgpr_read_b32 v37, a196
    v_max_u32 v32, v32, v33
    v_max3_u32 v32, v32, v34, v35
    v_max3_u32 v32, v32, v36, v37
    v_cmp_eq_u32 vcc, -1, v32
    s_cbranch_vccz adaLN_cond__grouped_kv_mqa__dense_activation_silu__prompt_kernel_ok197
    s_add_u32 s96, s96, 1
    s_cmp_lt_u32 s96, 131072
    s_cbranch_scc1 adaLN_cond__grouped_kv_mqa__dense_activation_silu__prompt_kernel_st195
adaLN_cond__grouped_kv_mqa__dense_activation_silu__prompt_kernel_ok197:
    s_branch adaLN_cond__grouped_kv_mqa__dense_activation_silu__prompt_kernel_bk196
adaLN_cond__grouped_kv_mqa__dense_activation_silu__prompt_kernel_st198:
    global_load_dwordx4 a[72:75], v0, s[20:21] offset:-4096 sc1
    global_load_dwordx4 a[200:203], v0, s[20:21] offset:0 sc1
    global_load_dwordx4 a[76:79], v15, s[20:21] offset:-4096 sc1
    global_load_dwordx4 a[204:207], v15, s[20:21] offset:0 sc1
    s_waitcnt vmcnt(0)
    v_accvgpr_read_b32 v32, a72
    v_accvgpr_read_b32 v33, a200
    v_accvgpr_read_b32 v34, a76
    v_accvgpr_read_b32 v35, a204
    v_max_u32 v32, v32, v33
    v_max3_u32 v32, v32, v34, v35
    v_cmp_eq_u32 vcc, -1, v32
    s_cbranch_vccz adaLN_cond__grouped_kv_mqa__dense_activation_silu__prompt_kernel_ok200
    s_add_u32 s96, s96, 1
    s_cmp_lt_u32 s96, 131072
    s_cbranch_scc1 adaLN_cond__grouped_kv_mqa__dense_activation_silu__prompt_kernel_st198
adaLN_cond__grouped_kv_mqa__dense_activation_silu__prompt_kernel_ok200:
    s_branch adaLN_cond__grouped_kv_mqa__dense_activation_silu__prompt_kernel_bk199
adaLN_cond__grouped_kv_mqa__dense_activation_silu__prompt_kernel_st201:
    global_load_dwordx4 a[80:83], v15, s[20:21] offset:2048 sc1
    global_load_dwordx4 a[208:211], v14, s[20:21] offset:-2048 sc1
    global_load_dwordx4 a[84:87], v14, s[20:21] offset:2048 sc1
    global_load_dwordx4 a[212:215], v149, s[20:21] offset:-2048 sc1
    s_waitcnt vmcnt(0)
    v_accvgpr_read_b32 v140, a80
    v_accvgpr_read_b32 v141, a208
    v_accvgpr_read_b32 v142, a84
    v_accvgpr_read_b32 v143, a212
    v_max_u32 v140, v140, v141
    v_max3_u32 v140, v140, v142, v143
    v_cmp_eq_u32 vcc, -1, v140
    s_cbranch_vccz adaLN_cond__grouped_kv_mqa__dense_activation_silu__prompt_kernel_ok203
    s_add_u32 s96, s96, 1
    s_cmp_lt_u32 s96, 131072
    s_cbranch_scc1 adaLN_cond__grouped_kv_mqa__dense_activation_silu__prompt_kernel_st201
adaLN_cond__grouped_kv_mqa__dense_activation_silu__prompt_kernel_ok203:
    s_branch adaLN_cond__grouped_kv_mqa__dense_activation_silu__prompt_kernel_bk202
adaLN_cond__grouped_kv_mqa__dense_activation_silu__prompt_kernel_st204:
    global_load_dwordx4 a[88:91], v0, s[20:21] offset:-3072 sc1
    global_load_dwordx4 a[216:219], v0, s[20:21] offset:1024 sc1
    global_load_dwordx4 a[92:95], v15, s[20:21] offset:-3072 sc1
    global_load_dwordx4 a[220:223], v15, s[20:21] offset:1024 sc1
    global_load_dwordx4 a[96:99], v15, s[20:21] offset:3072 sc1
    global_load_dwordx4 a[224:227], v14, s[20:21] offset:-1024 sc1
    global_load_dwordx4 a[100:103], v14, s[20:21] offset:3072 sc1
    global_load_dwordx4 a[228:231], v149, s[20:21] offset:-1024 sc1
    s_waitcnt vmcnt(0)
    v_accvgpr_read_b32 v140, a88
    v_accvgpr_read_b32 v141, a216
    v_accvgpr_read_b32 v142, a92
    v_accvgpr_read_b32 v143, a220
    v_accvgpr_read_b32 v144, a96
    v_accvgpr_read_b32 v145, a224
    v_accvgpr_read_b32 v146, a100
    v_accvgpr_read_b32 v147, a228
    v_max_u32 v140, v140, v141
    v_max3_u32 v140, v140, v142, v143
    v_max3_u32 v140, v140, v144, v145
    v_max3_u32 v140, v140, v146, v147
    v_cmp_eq_u32 vcc, -1, v140
    s_cbranch_vccz adaLN_cond__grouped_kv_mqa__dense_activation_silu__prompt_kernel_ok206
    s_add_u32 s96, s96, 1
    s_cmp_lt_u32 s96, 131072
    s_cbranch_scc1 adaLN_cond__grouped_kv_mqa__dense_activation_silu__prompt_kernel_st204
adaLN_cond__grouped_kv_mqa__dense_activation_silu__prompt_kernel_ok206:
    s_branch adaLN_cond__grouped_kv_mqa__dense_activation_silu__prompt_kernel_bk205
adaLN_cond__grouped_kv_mqa__dense_activation_silu__prompt_kernel_st207:
    global_load_dwordx4 a[104:107], v0, s[20:21] offset:-2048 sc1
    global_load_dwordx4 a[232:235], v0, s[20:21] offset:2048 sc1
    global_load_dwordx4 a[108:111], v15, s[20:21] offset:-2048 sc1
    global_load_dwordx4 a[236:239], v14, s[20:21] offset:-4096 sc1
    global_load_dwordx4 a[112:115], v14, s[20:21] offset:0 sc1
    global_load_dwordx4 a[240:243], v149, s[20:21] offset:-4096 sc1
    s_waitcnt vmcnt(0)
    v_accvgpr_read_b32 v140, a104
    v_accvgpr_read_b32 v141, a232
    v_accvgpr_read_b32 v142, a108
    v_accvgpr_read_b32 v143, a236
    v_accvgpr_read_b32 v144, a112
    v_accvgpr_read_b32 v145, a240
    v_max_u32 v140, v140, v141
    v_max3_u32 v140, v140, v142, v143
    v_max3_u32 v140, v140, v144, v145
    v_cmp_eq_u32 vcc, -1, v140
    s_cbranch_vccz adaLN_cond__grouped_kv_mqa__dense_activation_silu__prompt_kernel_ok209
    s_add_u32 s96, s96, 1
    s_cmp_lt_u32 s96, 131072
    s_cbranch_scc1 adaLN_cond__grouped_kv_mqa__dense_activation_silu__prompt_kernel_st207
adaLN_cond__grouped_kv_mqa__dense_activation_silu__prompt_kernel_ok209:
    s_branch adaLN_cond__grouped_kv_mqa__dense_activation_silu__prompt_kernel_bk208
adaLN_cond__grouped_kv_mqa__dense_activation_silu__prompt_kernel_st210:
    global_load_dwordx4 a[116:119], v0, s[20:21] offset:-1024 sc1
    global_load_dwordx4 a[244:247], v0, s[20:21] offset:3072 sc1
    global_load_dwordx4 a[120:123], v15, s[20:21] offset:-1024 sc1
    global_load_dwordx4 a[248:251], v14, s[20:21] offset:-3072 sc1
    global_load_dwordx4 a[124:127], v14, s[20:21] offset:1024 sc1
    global_load_dwordx4 a[252:255], v149, s[20:21] offset:-3072 sc1
    s_waitcnt vmcnt(0)
    v_accvgpr_read_b32 v140, a116
    v_accvgpr_read_b32 v141, a244
    v_accvgpr_read_b32 v142, a120
    v_accvgpr_read_b32 v143, a248
    v_accvgpr_read_b32 v144, a124
    v_accvgpr_read_b32 v145, a252
    v_max_u32 v140, v140, v141
    v_max3_u32 v140, v140, v142, v143
    v_max3_u32 v140, v140, v144, v145
    v_cmp_eq_u32 vcc, -1, v140
    s_cbranch_vccz adaLN_cond__grouped_kv_mqa__dense_activation_silu__prompt_kernel_ok212
    s_add_u32 s96, s96, 1
    s_cmp_lt_u32 s96, 131072
    s_cbranch_scc1 adaLN_cond__grouped_kv_mqa__dense_activation_silu__prompt_kernel_st210
adaLN_cond__grouped_kv_mqa__dense_activation_silu__prompt_kernel_ok212:
    s_branch adaLN_cond__grouped_kv_mqa__dense_activation_silu__prompt_kernel_bk211
adaLN_cond__grouped_kv_mqa__dense_activation_silu__prompt_kernel_fix172:
    s_waitcnt vmcnt(0) lgkmcnt(0)
    s_nop 15
    s_nop 7
    s_mov_b32 s56, 0
adaLN_cond__grouped_kv_mqa__dense_activation_silu__prompt_kernel_fbtt213:
    s_bitcmp1_b32 s97, s56
    s_cbranch_scc0 adaLN_cond__grouped_kv_mqa__dense_activation_silu__prompt_kernel_fbnx214
    s_lshl_b32 s57, s56, 15
    v_add_u32 v62, s57, v13
    v_add_u32 v63, 147456, v62
    global_load_dwordx4 v[24:27], v63, s[50:51] sc1
    v_mov_b32 v61, 0xff7fffff
    v_add_u32 v60, 65536, v2
    s_mov_b32 s57, 0
    v_mov_b32 v52, 0x3f803f80
    v_mov_b32 v53, 0x3f803f80
    v_mov_b32 v54, 0x3f803f80
    v_mov_b32 v55, 0x3f803f80
    v_mov_b32 v56, 0x3f803f80
    v_mov_b32 v57, 0x3f803f80
    v_mov_b32 v58, 0x3f803f80
    v_mov_b32 v59, 0x3f803f80
    v_mov_b32 v120, 0
    v_mov_b32 v121, 0
    v_mov_b32 v122, 0
    v_mov_b32 v123, 0
    v_mov_b32 v124, 0
    v_mov_b32 v125, 0
    v_mov_b32 v126, 0
    v_mov_b32 v127, 0
    v_mov_b32 v128, 0
    v_mov_b32 v129, 0
    v_mov_b32 v130, 0
    v_mov_b32 v131, 0
    v_mov_b32 v132, 0
    v_mov_b32 v133, 0
    v_mov_b32 v134, 0
    v_mov_b32 v135, 0
adaLN_cond__grouped_kv_mqa__dense_activation_silu__prompt_kernel_fba215:
    global_load_dwordx4 v[28:31], v60, s[28:29] sc1
    s_waitcnt vmcnt(0)
    v_cmp_eq_u32 vcc, -1, v28
    s_cbranch_vccz adaLN_cond__grouped_kv_mqa__dense_activation_silu__prompt_kernel_ok217
    s_add_u32 s96, s96, 1
    s_cmp_lt_u32 s96, 131072
    s_cbranch_scc1 adaLN_cond__grouped_kv_mqa__dense_activation_silu__prompt_kernel_fba215
adaLN_cond__grouped_kv_mqa__dense_activation_silu__prompt_kernel_ok217:
    v_mfma_f32_32x32x16_bf16 v[64:79], v[28:31], v[24:27], 0
    s_nop 15
    s_nop 7
    v_max3_f32 v61, v61, v64, v65
    v_max3_f32 v61, v61, v66, v67
    v_max3_f32 v61, v61, v68, v69
    v_max3_f32 v61, v61, v70, v71
    v_max3_f32 v61, v61, v72, v73
    v_max3_f32 v61, v61, v74, v75
    v_max3_f32 v61, v61, v76, v77
    v_max3_f32 v61, v61, v78, v79
    v_add_u32 v60, 2048, v60
    s_add_u32 s57, s57, 1
    s_cmp_lt_u32 s57, 64
    s_cbranch_scc1 adaLN_cond__grouped_kv_mqa__dense_activation_silu__prompt_kernel_fba215
    v_mov_b32 v63, v61
    s_nop 1
    v_permlane32_swap_b32 v61, v63
    v_max_f32 v61, v61, v63
    v_sub_f32 v80, 0, v61
    v_sub_f32 v81, 0, v61
    v_sub_f32 v82, 0, v61
    v_sub_f32 v83, 0, v61
    v_sub_f32 v84, 0, v61
    v_sub_f32 v85, 0, v61
    v_sub_f32 v86, 0, v61
    v_sub_f32 v87, 0, v61
    v_sub_f32 v88, 0, v61
    v_sub_f32 v89, 0, v61
    v_sub_f32 v90, 0, v61
    v_sub_f32 v91, 0, v61
    v_sub_f32 v92, 0, v61
    v_sub_f32 v93, 0, v61
    v_sub_f32 v94, 0, v61
    v_sub_f32 v95, 0, v61
    v_add_u32 v60, 65536, v2
    s_mov_b32 s57, 0
adaLN_cond__grouped_kv_mqa__dense_activation_silu__prompt_kernel_fbb216:
    global_load_dwordx4 v[28:31], v60, s[28:29] sc1
    s_mov_b32 exec_lo, 0xffff0000
    s_mov_b32 exec_hi, 0xffff0000
    global_load_dwordx4 v[52:55], v60, s[28:29] offset:1024 sc1
    global_load_dwordx4 v[56:59], v60, s[28:29] offset:768 sc1
    s_mov_b64 exec, -1
    s_waitcnt vmcnt(0)
    v_max3_u32 v63, v28, v52, v56
    v_cmp_eq_u32 vcc, -1, v63
    s_cbranch_vccz adaLN_cond__grouped_kv_mqa__dense_activation_silu__prompt_kernel_ok218
    s_add_u32 s96, s96, 1
    s_cmp_lt_u32 s96, 131072
    s_cbranch_scc1 adaLN_cond__grouped_kv_mqa__dense_activation_silu__prompt_kernel_fbb216
adaLN_cond__grouped_kv_mqa__dense_activation_silu__prompt_kernel_ok218:
    v_mfma_f32_32x32x16_bf16 v[64:79], v[28:31], v[24:27], v[80:95]
    s_nop 15
    s_nop 7
    v_exp_f32 v64, v64
    v_exp_f32 v65, v65
    v_exp_f32 v66, v66
    v_exp_f32 v67, v67
    v_exp_f32 v68, v68
    v_exp_f32 v69, v69
    v_exp_f32 v70, v70
    v_exp_f32 v71, v71
    v_exp_f32 v72, v72
    v_exp_f32 v73, v73
    v_exp_f32 v74, v74
    v_exp_f32 v75, v75
    v_exp_f32 v76, v76
    v_exp_f32 v77, v77
    v_exp_f32 v78, v78
    v_exp_f32 v79, v79
    v_cvt_pk_bf16_f32 v64, v64, v65
    v_cvt_pk_bf16_f32 v65, v66, v67
    v_cvt_pk_bf16_f32 v66, v68, v69
    v_cvt_pk_bf16_f32 v67, v70, v71
    v_cvt_pk_bf16_f32 v68, v72, v73
    v_cvt_pk_bf16_f32 v69, v74, v75
    v_cvt_pk_bf16_f32 v70, v76, v77
    v_cvt_pk_bf16_f32 v71, v78, v79
    s_nop 3
    v_mfma_f32_32x32x16_bf16 v[120:135], v[52:55], v[64:67], v[120:135]
    v_mfma_f32_32x32x16_bf16 v[120:135], v[56:59], v[68:71], v[120:135]
    s_nop 15
    s_nop 7
    v_add_u32 v60, 2048, v60
    s_add_u32 s57, s57, 1
    s_cmp_lt_u32 s57, 64
    s_cbranch_scc1 adaLN_cond__grouped_kv_mqa__dense_activation_silu__prompt_kernel_fbb216
    s_nop 15
    s_nop 7
    v_rcp_f32 v120, v120
    s_nop 1
    v_mul_f32 v128, v128, v120
    v_mul_f32 v129, v129, v120
    v_mul_f32 v130, v130, v120
    v_mul_f32 v131, v131, v120
    v_mul_f32 v132, v132, v120
    v_mul_f32 v133, v133, v120
    v_mul_f32 v134, v134, v120
    v_mul_f32 v135, v135, v120
    v_cvt_pk_bf16_f32 v28, v128, v129
    v_cvt_pk_bf16_f32 v29, v130, v131
    v_cvt_pk_bf16_f32 v30, v132, v133
    v_cvt_pk_bf16_f32 v31, v134, v135
    global_store_dwordx4 v62, v[28:31], s[50:51] sc1
    s_waitcnt vmcnt(0)
adaLN_cond__grouped_kv_mqa__dense_activation_silu__prompt_kernel_fbnx214:
    s_add_u32 s56, s56, 1
    s_cmp_lt_u32 s56, 2
    s_cbranch_scc1 adaLN_cond__grouped_kv_mqa__dense_activation_silu__prompt_kernel_fbtt213
adaLN_cond__grouped_kv_mqa__dense_activation_silu__prompt_kernel_fbo219:
    global_load_dwordx4 v[224:227], v15, s[50:51] offset:-4096 sc1
    global_load_dwordx4 v[228:231], v15, s[50:51] offset:-3072 sc1
    global_load_dwordx4 v[232:235], v15, s[50:51] offset:-2048 sc1
    global_load_dwordx4 v[236:239], v15, s[50:51] offset:-1024 sc1
    global_load_dwordx4 v[240:243], v15, s[50:51] offset:0 sc1
    global_load_dwordx4 v[244:247], v15, s[50:51] offset:1024 sc1
    global_load_dwordx4 v[248:251], v15, s[50:51] offset:2048 sc1
    global_load_dwordx4 v[252:255], v15, s[50:51] offset:3072 sc1
    s_waitcnt vmcnt(0)
    v_max_u32 v14, v224, v228
    v_max3_u32 v14, v14, v232, v236
    v_max3_u32 v14, v14, v240, v244
    v_max3_u32 v14, v14, v248, v252
    v_cmp_le_u32 vcc, 0xfffefffe, v14
    s_cbranch_vccz adaLN_cond__grouped_kv_mqa__dense_activation_silu__prompt_kernel_ok220
    s_add_u32 s96, s96, 1
    s_cmp_lt_u32 s96, 131072
    s_cbranch_scc1 adaLN_cond__grouped_kv_mqa__dense_activation_silu__prompt_kernel_fbo219
adaLN_cond__grouped_kv_mqa__dense_activation_silu__prompt_kernel_ok220:
    v_mfma_f32_32x32x16_bf16 v[120:135], v[160:163], v[224:227], 0
    v_mfma_f32_32x32x16_bf16 v[136:151], v[192:195], v[224:227], 0
    v_mfma_f32_32x32x16_bf16 v[120:135], v[164:167], v[228:231], v[120:135]
    v_mfma_f32_32x32x16_bf16 v[136:151], v[196:199], v[228:231], v[136:151]
    v_mfma_f32_32x32x16_bf16 v[120:135], v[168:171], v[232:235], v[120:135]
    v_mfma_f32_32x32x16_bf16 v[136:151], v[200:203], v[232:235], v[136:151]
    v_mfma_f32_32x32x16_bf16 v[120:135], v[172:175], v[236:239], v[120:135]
    v_mfma_f32_32x32x16_bf16 v[136:151], v[204:207], v[236:239], v[136:151]
    v_mfma_f32_32x32x16_bf16 v[120:135], v[176:179], v[240:243], v[120:135]
    v_mfma_f32_32x32x16_bf16 v[136:151], v[208:211], v[240:243], v[136:151]
    v_mfma_f32_32x32x16_bf16 v[120:135], v[180:183], v[244:247], v[120:135]
    v_mfma_f32_32x32x16_bf16 v[136:151], v[212:215], v[244:247], v[136:151]
    v_mfma_f32_32x32x16_bf16 v[120:135], v[184:187], v[248:251], v[120:135]
    v_mfma_f32_32x32x16_bf16 v[136:151], v[216:219], v[248:251], v[136:151]
    v_mfma_f32_32x32x16_bf16 v[120:135], v[188:191], v[252:255], v[120:135]
    v_mfma_f32_32x32x16_bf16 v[136:151], v[220:223], v[252:255], v[136:151]
    s_nop 15
    s_nop 7
    s_branch adaLN_cond__grouped_kv_mqa__dense_activation_silu__prompt_kernel_fixb173
    s_nop 0
    s_nop 0
    s_nop 0
    s_nop 0
    s_nop 0
    s_nop 0
    s_nop 0
    s_nop 0
    s_nop 0
    s_nop 0
    s_nop 0
    s_nop 0
    s_nop 0
    s_nop 0
    s_nop 0
    s_nop 0
.section .rodata,"a"
.p2align 6
.amdhsa_kernel adaLN_cond__grouped_kv_mqa__dense_activation_silu__prompt_kernel
  .amdhsa_next_free_vgpr 512
  .amdhsa_next_free_sgpr 102
  .amdhsa_accum_offset 256
  .amdhsa_group_segment_fixed_size 0
  .amdhsa_kernarg_size 104
  .amdhsa_user_sgpr_count 2
  .amdhsa_user_sgpr_kernarg_segment_ptr 1
  .amdhsa_system_sgpr_workgroup_id_x 1
.end_amdhsa_kernel
```
